```python
import torch

def _softmax(x, axis=-1):
    return torch.softmax(x, dim=axis)
def _gelu(x):
    return torch.nn.functional.gelu(x, approximate="tanh")
def _silu(x):
    return torch.nn.functional.silu(x)
def _sigmoid(x):
    return torch.sigmoid(x)
def _layernorm(x, axis=-1, eps=1e-5):
    m = x.mean(dim=axis, keepdim=True)
    v = x.var(dim=axis, keepdim=True, unbiased=False)
    return (x - m) / torch.sqrt(v + eps)
def _scatter_add(tgt, idx, src, axis=0):
    return tgt.clone().index_add_(axis, idx, src)
def _segment_sum(src, seg, n):
    out = torch.zeros((n,) + src.shape[1:], dtype=src.dtype)
    return out.index_add_(0, seg, src)
def _pad(x, pw):
    flat = tuple(v for pair in reversed(pw) for v in pair)
    return torch.nn.functional.pad(x, flat)

kernel_name = 'sequential_preLN__ssm_conv_s4__mixer_s_mlp__prompt'

def setup_inputs():

    _w = (lambda a: (lambda t: t.to(torch.bfloat16) if t.is_floating_point() else t)(torch.as_tensor(a)))
    def _A_setup():
        B, L, D, N = 1, 2048, 576, 128
        A_re = -(lambda _x: torch.exp(torch.as_tensor(_x)))((lambda *s: torch.randn(*s, dtype=torch.bfloat16) * 3.2)(D, N))
        A_im = torch.pi * (lambda *s: torch.randn(*s, dtype=torch.bfloat16) * 0.05)(D, N)
        B_re = (lambda *s: torch.randn(*s, dtype=torch.bfloat16) * 0.1)(D, N)
        B_im = (lambda *s: torch.randn(*s, dtype=torch.bfloat16) * 0.1)(D, N)
        C_re = (lambda *s: torch.randn(*s, dtype=torch.bfloat16) * 0.1)(D, N)
        C_im = (lambda *s: torch.randn(*s, dtype=torch.bfloat16) * 0.1)(D, N)
        log_dt = (lambda *s: torch.randn(*s, dtype=torch.bfloat16) * 0.05)(D) * 0.5 - 4.0
        Dskip = (lambda *s: torch.randn(*s, dtype=torch.bfloat16) * 0.05)(D)
        return {
            "u": _w((lambda *s: torch.randn(*s, dtype=torch.bfloat16) * 0.05)(B, L, D)),
            "A_re": _w(A_re),
            "A_im": _w(A_im),
            "B_re": _w(B_re),
            "B_im": _w(B_im),
            "C_re": _w(C_re),
            "C_im": _w(C_im),
            "log_dt": _w(log_dt),
            "Dskip": _w(Dskip),
        }
    _A_in = _A_setup()

    def _B_setup():
        B, S, D, F = 1, 2048, 576, 4608
        return {
            "x":  _w((lambda *s: torch.randn(*s, dtype=torch.bfloat16) * 0.05)(B, S, D)),
            "w1": _w((lambda *s: torch.randn(*s, dtype=torch.bfloat16) * 3.2)(D, D) * (D ** -0.5)),
            "w2": _w((lambda *s: torch.randn(*s, dtype=torch.bfloat16) * 3.2)(D, D) * (D ** -0.5)),
            "w3": _w((lambda *s: torch.randn(*s, dtype=torch.bfloat16) * 3.2)(D, F) * (D ** -0.5)),
            "w4": _w((lambda *s: torch.randn(*s, dtype=torch.bfloat16) * 1.6)(F, D) * (F ** -0.5)),
        }
    _B_in = _B_setup()

    return {
        "A_u": _A_in["u"],
        "A_A_re": _A_in["A_re"],
        "A_A_im": _A_in["A_im"],
        "A_B_re": _A_in["B_re"],
        "A_B_im": _A_in["B_im"],
        "A_C_re": _A_in["C_re"],
        "A_C_im": _A_in["C_im"],
        "A_log_dt": _A_in["log_dt"],
        "A_Dskip": _A_in["Dskip"],
        "B_x": _B_in["x"],
        "B_w1": _B_in["w1"],
        "B_w2": _B_in["w2"],
        "B_w3": _B_in["w3"],
        "B_w4": _B_in["w4"],
    }

def reference(A_u, A_A_re, A_A_im, A_B_re, A_B_im, A_C_re, A_C_im, A_log_dt, A_Dskip, B_x, B_w1, B_w2, B_w3, B_w4):
    def _A_ref(u, A_re, A_im, B_re, B_im, C_re, C_im, log_dt, Dskip):
        Bsz, L, D = u.shape
        dt = torch.exp(log_dt)[:, None]
        A = A_re + 1j * A_im
        Bc = B_re + 1j * B_im
        Cc = C_re + 1j * C_im
        logdA = dt * A
        dB = dt * Bc
        l = (lambda x, dt: x.to(dt))(torch.arange(L), A_re.dtype)
        P = torch.exp(logdA[:, :, None] * l[None, None, :])
        K = torch.einsum("dn,dnl,dn->dl", Cc, P, dB).real
        L2 = 2 * L
        Kp = _pad(K, ((0, 0), (0, L)))
        up = (lambda x, *d: x.permute(*d))(u, 0, 2, 1)
        up = _pad(up, ((0, 0), (0, 0), (0, L)))
        Kf = (lambda x, axes=(-2,-1): torch.fft.rfft2(x.float(), dim=axes))(Kp[:, None, :], axes=(-2, -1))
        Uf = (lambda x, axes=(-2,-1): torch.fft.rfft2(x.float(), dim=axes))(up[:, :, None, :], axes=(-2, -1))
        Yf = Uf * Kf[None, :, :, :]
        y = (lambda x, s, axes=(-2,-1): torch.fft.irfft2(x, s=s, dim=axes).to(torch.bfloat16))(Yf, (1, L2), axes=(-2, -1))[:, :, 0, :L]
        y = (lambda x, *d: x.permute(*d))(y, 0, 2, 1) + u * Dskip[None, None, :]
        return y

    def _B_ref(x, w1, w2, w3, w4):
        B, S, D = x.shape
        h = _gelu(_layernorm(x, axis=-1) @ w1)
        c = D // 4
        g0 = _pad(h[:, :, 0*c:1*c], ((0, 0), (1, 0), (0, 0)))[:, :S, :]
        g1 = _pad(h[:, :, 1*c:2*c], ((0, 0), (0, 1), (0, 0)))[:, 1:, :]
        g2 = _pad(h[:, :, 2*c:3*c], ((0, 0), (2, 0), (0, 0)))[:, :S, :]
        g3 = _pad(h[:, :, 3*c:   ], ((0, 0), (0, 2), (0, 0)))[:, 2:, :]
        hs = torch.concatenate([g0, g1, g2, g3], axis=-1) @ w2
        x1 = x + hs
        h2 = _gelu(_layernorm(x1, axis=-1) @ w3) @ w4
        return x1 + h2

    x = A_u
    h = x + _A_ref(_layernorm(x, axis=-1), A_A_re, A_A_im, A_B_re, A_B_im, A_C_re, A_C_im, A_log_dt, A_Dskip)
    h2 = h + _B_ref(_layernorm(h, axis=-1), B_w1, B_w2, B_w3, B_w4)
    return h2
```

```asm
; @launch grid=(256,1,1) block=(512,1,1) lds=163840
.amdgcn_target "amdgcn-amd-amdhsa--gfx950"
.text
.globl sequential_preLN__ssm_conv_s4__mixer_s_mlp__prompt_kernel
.p2align 8
.type sequential_preLN__ssm_conv_s4__mixer_s_mlp__prompt_kernel,@function
sequential_preLN__ssm_conv_s4__mixer_s_mlp__prompt_kernel:
    s_cmp_ge_u32 s2, 256
    s_cbranch_scc1 Lend_0_1
    s_load_dwordx16 s[52:67], s[0:1], 0
    s_load_dwordx2 s[68:69], s[0:1], 64
    s_load_dwordx2 s[50:51], s[0:1], 120
    s_load_dwordx2 s[4:5], s[0:1], 128
    s_load_dwordx4 s[40:43], s[0:1], 80
    v_and_b32 v1, 63, v0
    v_lshrrev_b32 v2, 6, v0
    s_nop 0
    v_readfirstlane_b32 s24, v2
    v_lshlrev_b32 v3, 4, v1
    s_mov_b32 s38, 0x40000
    v_lshlrev_b32 v4, 3, v1
    v_cmp_gt_u32 vcc, 48, v1
    v_mov_b32 v5, 0x7fffffff
    s_nop 0
    v_cndmask_b32 v5, v5, v4, vcc
    s_lshl_b32 s12, s2, 3
    s_add_u32 s12, s12, s24
    s_mul_i32 s12, s12, 1152
    s_mul_i32 s13, s24, 1216
    s_add_u32 s13, s13, 139264
    v_add_u32 v6, s13, v4
    s_and_b32 s39, s2, 7
    s_mul_i32 s39, s39, 18
    s_lshr_b32 s15, s2, 3
    s_add_u32 s39, s39, s15
    s_lshl_b32 s14, s39, 2
    s_lshr_b32 s15, s24, 1
    s_add_u32 s14, s14, s15
    s_lshl_b32 s15, s14, 8
    s_and_b32 s16, s24, 1
    s_lshl_b32 s16, s16, 7
    s_add_u32 s15, s15, s16
    v_lshl_add_u32 v7, v1, 1, s15
    s_lshl_b32 s15, s14, 1
    v_mov_b32 v8, s15
    v_lshlrev_b32 v9, 8, v1
    v_mov_b32 v16, 0
    s_mov_b32 s20, 0x3f803f80
    s_mov_b32 s21, 0x00003f80
    s_mov_b32 s22, 0x3f800000
    s_lshl_b32 s23, s24, 6
    s_add_u32 s23, s23, 139264
    s_waitcnt lgkmcnt(0)
    s_mov_b32 s8, s4
    s_mov_b32 s9, s5
    s_mov_b32 s10, 268435456
    s_mov_b32 s11, 0x00020000
    s_mov_b32 s28, s52
    s_mov_b32 s29, s53
    s_mov_b32 s30, 2359296
    s_mov_b32 s31, 0x00020000
    s_cmp_lg_u32 s24, 6
    s_cbranch_scc1 Lln_0_6
    s_lshl_b32 s15, s2, 11
    s_add_u32 s15, s15, 32768
    v_lshlrev_b32 v17, 7, v1
    s_mov_b64 exec, 0xffff
    buffer_store_dword v16, v17, s[8:11], s15 offen sc1
    s_mov_b64 exec, -1
Lln_0_6:
    s_lshl_b32 s15, s2, 3
    s_add_u32 s15, s15, s24
    s_cmp_lg_u32 s15, 7
    s_cbranch_scc1 Lln_0_7
    s_mov_b32 s16, 0
    buffer_store_dword v16, v9, s[8:11], s16 offen sc1
    s_mov_b32 s16, 16384
    buffer_store_dword v16, v9, s[8:11], s16 offen sc1
Lln_0_7:
    buffer_load_dwordx2 v[10:11], v5, s[28:31], s12 offen offset:0 nt
    buffer_load_dwordx2 v[12:13], v5, s[28:31], s12 offen offset:384 nt
    buffer_load_dwordx2 v[14:15], v5, s[28:31], s12 offen offset:768 nt
    s_cmp_ge_u32 s2, 144
    s_cbranch_scc1 Lln_0_8
    global_load_ushort v40, v7, s[54:55] nt
    global_load_ushort v41, v7, s[56:57] nt
    global_load_ushort v42, v7, s[58:59] nt
    global_load_ushort v43, v7, s[60:61] nt
    global_load_ushort v44, v7, s[62:63] nt
    global_load_ushort v45, v7, s[64:65] nt
    global_load_ushort v46, v8, s[66:67]
    global_load_ushort v47, v8, s[68:69]
    s_branch Lln_0_11
Lln_0_8:
    s_sub_u32 s33, s24, 6
    s_lshl_b32 s25, s33, 13
    s_add_u32 s25, s25, 98304
    s_mul_i32 s33, s33, 112
    s_add_u32 s33, s33, s2
    s_sub_u32 s33, s33, 144
    s_cmp_ge_u32 s33, 162
    s_cbranch_scc1 Lln_0_12
    s_cmp_ge_u32 s33, 81
    s_cselect_b32 s44, s42, s40
    s_cselect_b32 s45, s43, s41
    s_cselect_b32 s34, 81, 0
    s_cselect_b32 s26, 663552, 0
    s_mov_b32 s46, 663552
    s_mov_b32 s47, 0x00020000
    s_sub_u32 s36, s33, s34
    s_mul_hi_u32 s37, s36, 477218589
    s_mul_i32 s35, s37, 9
    s_sub_u32 s36, s36, s35
    s_mul_i32 s34, s37, 73728
    s_lshl_b32 s35, s36, 7
    s_add_u32 s34, s34, s35
    s_mul_i32 s36, s36, 73728
    s_lshl_b32 s37, s37, 11
    s_add_u32 s26, s26, s36
    s_add_u32 s26, s26, s37
    s_add_u32 s26, s26, 8224768
    v_lshrrev_b32 v17, 3, v1
    v_mul_u32_u24 v17, 1152, v17
    v_and_b32 v18, 7, v1
    v_lshl_add_u32 v17, v18, 4, v17
    s_add_u32 m0, s25, 0
    s_nop 0
    buffer_load_dwordx4 v17, s[44:47], s34 offen nt lds
    s_add_u32 s34, s34, 9216
    s_add_u32 m0, s25, 1024
    s_nop 0
    buffer_load_dwordx4 v17, s[44:47], s34 offen nt lds
    s_add_u32 s34, s34, 9216
    s_add_u32 m0, s25, 2048
    s_nop 0
    buffer_load_dwordx4 v17, s[44:47], s34 offen nt lds
    s_add_u32 s34, s34, 9216
    s_add_u32 m0, s25, 3072
    s_nop 0
    buffer_load_dwordx4 v17, s[44:47], s34 offen nt lds
    s_add_u32 s34, s34, 9216
    s_add_u32 m0, s25, 4096
    s_nop 0
    buffer_load_dwordx4 v17, s[44:47], s34 offen nt lds
    s_add_u32 s34, s34, 9216
    s_add_u32 m0, s25, 5120
    s_nop 0
    buffer_load_dwordx4 v17, s[44:47], s34 offen nt lds
    s_add_u32 s34, s34, 9216
    s_add_u32 m0, s25, 6144
    s_nop 0
    buffer_load_dwordx4 v17, s[44:47], s34 offen nt lds
    s_add_u32 s34, s34, 9216
    s_add_u32 m0, s25, 7168
    s_nop 0
    buffer_load_dwordx4 v17, s[44:47], s34 offen nt lds
    s_branch Lln_0_11
Lln_0_12:
    s_cmp_lg_u32 s24, 7
    s_cbranch_scc1 Lln_0_11
    s_getpc_b64 s[70:71]
Lpc_0_14:
    s_sub_u32 s70, s70, Lpc_0_14-sequential_preLN__ssm_conv_s4__mixer_s_mlp__prompt_kernel
    s_subb_u32 s71, s71, 0
    s_bfe_u32 s3, s2, 0x30003
    s_lshl_b32 s3, s3, 13
    v_lshl_add_u32 v39, v1, 7, s3
    v_xor_b32 v36, 0x8000, v39
    v_min_u32 v39, Lcode_end-sequential_preLN__ssm_conv_s4__mixer_s_mlp__prompt_kernel-4, v39
    v_min_u32 v36, Lcode_end-sequential_preLN__ssm_conv_s4__mixer_s_mlp__prompt_kernel-4, v36
    global_load_dword v38, v39, s[70:71]
    global_load_dword v39, v36, s[70:71]
Lln_0_11:
    v_bfe_u32 v17, v1, 2, 2
    v_mul_u32_u24 v17, 1216, v17
    v_lshrrev_b32 v18, 4, v1
    v_lshl_add_u32 v17, v18, 4, v17
    v_bfe_u32 v18, v1, 1, 1
    v_lshl_add_u32 v17, v18, 3, v17
    v_and_b32 v18, 1, v1
    v_xor_b32 v18, 1, v18
    v_mul_u32_u24 v18, 9728, v18
    v_add3_u32 v17, v17, v18, s23
    v_lshrrev_b32 v37, 3, v1
    v_mul_u32_u24 v37, 32896, v37
    v_and_b32 v18, 7, v1
    v_lshl_add_u32 v37, v18, 4, v37
    v_mov_b32 v18, 0
    v_mov_b32 v19, 0
    s_cmp_lg_u32 s15, 7
    s_cbranch_scc1 Lln_0_9
    v_mov_b32 v20, 1
    s_mov_b64 exec, 1
    s_waitcnt vmcnt(11)
    global_store_dword v16, v20, s[50:51] sc0 sc1
    s_mov_b64 exec, -1
    s_waitcnt vmcnt(1)
    s_branch Lln_0_10
Lln_0_9:
    s_waitcnt vmcnt(8)
    s_cmp_lt_u32 s2, 144
    s_cbranch_scc1 Lln_0_10
    s_cmp_lt_u32 s33, 162
    s_cbranch_scc1 Lln_0_10
    s_waitcnt vmcnt(2)
    s_cmp_eq_u32 s24, 7
    s_cbranch_scc1 Lln_0_10
    s_waitcnt vmcnt(0)
Lln_0_10:
    v_dot2_f32_bf16 v18, v10, s20, v18
    v_dot2_f32_bf16 v18, v11, s20, v18
    v_dot2_f32_bf16 v18, v12, s20, v18
    v_dot2_f32_bf16 v18, v13, s20, v18
    v_dot2_f32_bf16 v18, v14, s20, v18
    v_dot2_f32_bf16 v18, v15, s20, v18
    s_mov_b32 exec_hi, 0xffff
    ds_write_b64 v6, v[10:11] offset:0
    ds_write_b64 v6, v[12:13] offset:384
    ds_write_b64 v6, v[14:15] offset:768
    s_mov_b64 exec, -1
    v_add_f32_dpp v18, v18, v18 row_ror:8 row_mask:0xf bank_mask:0xf
    s_nop 1
    v_add_f32_dpp v18, v18, v18 row_ror:4 row_mask:0xf bank_mask:0xf
    s_nop 1
    v_add_f32_dpp v18, v18, v18 row_ror:2 row_mask:0xf bank_mask:0xf
    s_nop 1
    v_add_f32_dpp v18, v18, v18 row_ror:1 row_mask:0xf bank_mask:0xf
    v_mov_b32 v20, v18
    s_nop 1
    v_permlane16_swap_b32 v18, v20
    v_add_f32 v18, v18, v20
    v_mov_b32 v20, v18
    s_nop 1
    v_permlane32_swap_b32 v18, v20
    v_add_f32 v18, v18, v20
    v_mul_f32 v18, 0x3ae38e39, v18
    v_cvt_pk_bf16_f32 v20, v18, v18
    v_and_b32 v20, 0xffff0000, v20
    v_sub_f32 v18, v18, v20
    v_sub_f32 v20, 0, v20
    s_mov_b32 exec_hi, 0xffff
    v_dot2_f32_bf16 v22, v10, s21, v20
    v_dot2_f32_bf16 v23, v10, s22, v20
    v_dot2_f32_bf16 v24, v11, s21, v20
    v_dot2_f32_bf16 v25, v11, s22, v20
    v_dot2_f32_bf16 v26, v12, s21, v20
    v_dot2_f32_bf16 v27, v12, s22, v20
    v_dot2_f32_bf16 v28, v13, s21, v20
    v_dot2_f32_bf16 v29, v13, s22, v20
    v_dot2_f32_bf16 v30, v14, s21, v20
    v_dot2_f32_bf16 v31, v14, s22, v20
    v_dot2_f32_bf16 v32, v15, s21, v20
    v_dot2_f32_bf16 v33, v15, s22, v20
    v_cvt_pk_bf16_f32 v10, v22, v23
    v_cvt_pk_bf16_f32 v11, v24, v25
    v_cvt_pk_bf16_f32 v12, v26, v27
    v_cvt_pk_bf16_f32 v13, v28, v29
    v_cvt_pk_bf16_f32 v14, v30, v31
    v_cvt_pk_bf16_f32 v15, v32, v33
    v_dot2_f32_bf16 v19, v10, v10, v19
    v_dot2_f32_bf16 v19, v11, v11, v19
    v_dot2_f32_bf16 v19, v12, v12, v19
    v_dot2_f32_bf16 v19, v13, v13, v19
    v_dot2_f32_bf16 v19, v14, v14, v19
    v_dot2_f32_bf16 v19, v15, v15, v19
    v_lshlrev_b32 v22, 16, v10
    v_and_b32 v23, 0xffff0000, v10
    v_lshlrev_b32 v24, 16, v11
    v_and_b32 v25, 0xffff0000, v11
    v_lshlrev_b32 v26, 16, v12
    v_and_b32 v27, 0xffff0000, v12
    v_lshlrev_b32 v28, 16, v13
    v_and_b32 v29, 0xffff0000, v13
    v_lshlrev_b32 v30, 16, v14
    v_and_b32 v31, 0xffff0000, v14
    v_lshlrev_b32 v32, 16, v15
    v_and_b32 v33, 0xffff0000, v15
    s_mov_b64 exec, -1
    v_add_f32_dpp v19, v19, v19 row_ror:8 row_mask:0xf bank_mask:0xf
    s_nop 1
    v_add_f32_dpp v19, v19, v19 row_ror:4 row_mask:0xf bank_mask:0xf
    s_nop 1
    v_add_f32_dpp v19, v19, v19 row_ror:2 row_mask:0xf bank_mask:0xf
    s_nop 1
    v_add_f32_dpp v19, v19, v19 row_ror:1 row_mask:0xf bank_mask:0xf
    v_mov_b32 v21, v19
    s_nop 1
    v_permlane16_swap_b32 v19, v21
    v_add_f32 v19, v19, v21
    v_mov_b32 v21, v19
    s_nop 1
    v_permlane32_swap_b32 v19, v21
    v_add_f32 v19, v19, v21
    v_mul_f32 v19, 0x3ae38e39, v19
    v_fma_f32 v19, -v18, v18, v19
    v_cvt_pk_bf16_f32 v19, v19, v19
    v_and_b32 v19, 0xffff0000, v19
    v_add_f32 v19, 0x3727c5ac, v19
    v_cvt_pk_bf16_f32 v19, v19, v19
    v_and_b32 v19, 0xffff0000, v19
    v_sqrt_f32 v19, v19
    s_nop 0
    v_cvt_pk_bf16_f32 v19, v19, v19
    v_and_b32 v19, 0xffff0000, v19
    v_rcp_f32 v20, v19
    v_rcp_f32 v21, v19
    s_nop 0
    v_pk_mul_f32 v[22:23], v[22:23], v[20:21]
    v_pk_mul_f32 v[24:25], v[24:25], v[20:21]
    v_pk_mul_f32 v[26:27], v[26:27], v[20:21]
    v_pk_mul_f32 v[28:29], v[28:29], v[20:21]
    v_pk_mul_f32 v[30:31], v[30:31], v[20:21]
    v_pk_mul_f32 v[32:33], v[32:33], v[20:21]
    v_cvt_pk_bf16_f32 v10, v22, v23
    v_cvt_pk_bf16_f32 v11, v24, v25
    v_cvt_pk_bf16_f32 v12, v26, v27
    v_cvt_pk_bf16_f32 v13, v28, v29
    v_cvt_pk_bf16_f32 v14, v30, v31
    v_cvt_pk_bf16_f32 v15, v32, v33
    s_mov_b32 exec_hi, 0xffff
    ds_write_b64 v6, v[10:11] offset:9728
    ds_write_b64 v6, v[12:13] offset:10112
    ds_write_b64 v6, v[14:15] offset:10496
    s_mov_b64 exec, -1
    s_lshl_b32 s16, s2, 7
    s_mul_i32 s17, s24, 263168
    s_add_u32 s16, s16, s17
    s_add_u32 s16, s16, 1048576
    s_add_u32 s17, s16, 1579008
    s_add_u32 s18, s16, 3158016
    s_waitcnt lgkmcnt(0)
    s_barrier
    s_cmp_ge_u32 s24, 6
    s_cbranch_scc1 Llq_0_15
    ds_read_b64_tr_b16 v[22:23], v17 offset:0
    ds_read_b64_tr_b16 v[24:25], v17 offset:4864
    ds_read_b64_tr_b16 v[26:27], v17 offset:384
    ds_read_b64_tr_b16 v[28:29], v17 offset:5248
    ds_read_b64_tr_b16 v[30:31], v17 offset:768
    ds_read_b64_tr_b16 v[32:33], v17 offset:5632
    s_waitcnt lgkmcnt(4)
    buffer_store_dwordx4 v[22:25], v37, s[8:11], s16 offen sc1
    s_waitcnt lgkmcnt(2)
    buffer_store_dwordx4 v[26:29], v37, s[8:11], s17 offen sc1
    s_waitcnt lgkmcnt(0)
    buffer_store_dwordx4 v[30:33], v37, s[8:11], s18 offen sc1
    s_cmp_lg_u32 s24, 0
    s_cbranch_scc1 Llq_0_15
    v_mov_b32 v4, 0
    global_load_dword v5, v4, s[50:51] sc1
Llq_0_15:
    s_cmp_lt_u32 s2, 144
    s_cbranch_scc1 Lpack_0_2
    s_load_dwordx4 s[56:59], s[0:1], 96
    v_and_b32 v8, 3, v1
    v_bfe_u32 v14, v1, 2, 2
    s_cmp_ge_u32 s33, 162
    s_cbranch_scc1 Lpk_0_16
    v_lshrrev_b32 v10, 4, v1
    v_lshl_add_u32 v10, v10, 3, v14
    v_lshlrev_b32 v10, 7, v10
    v_lshl_add_u32 v10, v8, 3, v10
    v_add_u32 v10, s25, v10
    s_waitcnt vmcnt(0) lgkmcnt(0)
    ds_read_b64_tr_b16 v[40:41], v10 offset:0
    ds_read_b64_tr_b16 v[42:43], v10 offset:512
    ds_read_b64_tr_b16 v[44:45], v10 offset:32
    ds_read_b64_tr_b16 v[46:47], v10 offset:544
    ds_read_b64_tr_b16 v[48:49], v10 offset:64
    ds_read_b64_tr_b16 v[50:51], v10 offset:576
    ds_read_b64_tr_b16 v[52:53], v10 offset:96
    ds_read_b64_tr_b16 v[54:55], v10 offset:608
    ds_read_b64_tr_b16 v[56:57], v10 offset:4096
    ds_read_b64_tr_b16 v[58:59], v10 offset:4608
    ds_read_b64_tr_b16 v[60:61], v10 offset:4128
    ds_read_b64_tr_b16 v[62:63], v10 offset:4640
    ds_read_b64_tr_b16 v[64:65], v10 offset:4160
    ds_read_b64_tr_b16 v[66:67], v10 offset:4672
    ds_read_b64_tr_b16 v[68:69], v10 offset:4192
    ds_read_b64_tr_b16 v[70:71], v10 offset:4704
    s_waitcnt lgkmcnt(14)
    s_add_u32 s27, s26, 0
    buffer_store_dwordx4 v[40:43], v3, s[8:11], s27 offen sc1
    s_waitcnt lgkmcnt(12)
    s_add_u32 s27, s26, 18432
    buffer_store_dwordx4 v[44:47], v3, s[8:11], s27 offen sc1
    s_waitcnt lgkmcnt(10)
    s_add_u32 s27, s26, 36864
    buffer_store_dwordx4 v[48:51], v3, s[8:11], s27 offen sc1
    s_waitcnt lgkmcnt(8)
    s_add_u32 s27, s26, 55296
    buffer_store_dwordx4 v[52:55], v3, s[8:11], s27 offen sc1
    s_waitcnt lgkmcnt(6)
    s_add_u32 s27, s26, 1024
    buffer_store_dwordx4 v[56:59], v3, s[8:11], s27 offen sc1
    s_waitcnt lgkmcnt(4)
    s_add_u32 s27, s26, 19456
    buffer_store_dwordx4 v[60:63], v3, s[8:11], s27 offen sc1
    s_waitcnt lgkmcnt(2)
    s_add_u32 s27, s26, 37888
    buffer_store_dwordx4 v[64:67], v3, s[8:11], s27 offen sc1
    s_waitcnt lgkmcnt(0)
    s_add_u32 s27, s26, 56320
    buffer_store_dwordx4 v[68:71], v3, s[8:11], s27 offen sc1
    s_waitcnt vmcnt(0)
Lpk_0_16:
    s_cmp_eq_u32 s24, 7
    s_cbranch_scc1 Lpk_0_23
    s_waitcnt vmcnt(0)
Lpk_0_23:
    s_waitcnt lgkmcnt(0)
    s_barrier
    s_cmp_lg_u32 s24, 0
    s_cbranch_scc1 Lsa_0_24
    v_cmp_ne_u32 vcc, 0, v5
    s_nop 0
    s_cbranch_vccnz Lso_0_26
Lsp_0_25:
    s_sleep 2
    global_load_dword v5, v4, s[50:51] sc1
    s_sub_u32 s38, s38, 1
    s_cmp_lt_i32 s38, 0
    s_cbranch_scc1 Lso_0_26
    s_waitcnt vmcnt(0)
    v_cmp_eq_u32 vcc, 0, v5
    s_nop 0
    s_cbranch_vccnz Lsp_0_25
Lso_0_26:
    s_waitcnt vmcnt(0)
    s_and_b32 s49, s2, 7
    s_add_u32 s49, s49, 0
    s_lshl_b32 s49, s49, 8
    v_mov_b32 v4, 0
    v_mov_b32 v5, 1
    s_mov_b64 exec, 1
    buffer_atomic_add v5, v4, s[8:11], s49 offen sc0 sc1
    s_mov_b64 exec, -1
    s_waitcnt vmcnt(0)
    v_readfirstlane_b32 s3, v5
    s_nop 0
    s_cmp_lg_u32 s3, 31
    s_cbranch_scc1 Lar_0_27
    v_mov_b32 v5, 1
    s_mov_b64 exec, 1
    buffer_store_dword v5, v4, s[8:11], s49 offen offset:2048 sc1
    s_mov_b64 exec, -1
Lar_0_27:
Lsa_0_24:
    s_mov_b32 s28, s56
    s_mov_b32 s29, s57
    s_mov_b32 s30, 5308416
    s_mov_b32 s31, 0x00020000
    s_mov_b32 s44, s58
    s_mov_b32 s45, s59
    s_mov_b32 s46, 5308416
    s_mov_b32 s47, 0x00020000
    s_lshl_b32 s25, s24, 14
    v_lshrrev_b32 v6, 3, v1
    v_and_b32 v7, 7, v1
    v_mul_u32_u24 v13, 9216, v6
    v_lshl_add_u32 v13, v7, 4, v13
    s_mul_i32 s13, s24, 112
    s_add_u32 s13, s13, s2
    s_sub_u32 s13, s13, 144
    s_mul_hi_u32 s15, s13, 59652324
    s_mul_i32 s16, s15, 72
    s_sub_u32 s16, s13, s16
    s_mul_i32 s17, s15, 589824
    s_lshl_b32 s18, s16, 7
    s_add_u32 s17, s17, s18
    v_lshrrev_b32 v12, 5, v1
    v_lshl_add_u32 v12, v12, 3, v14
    v_lshlrev_b32 v12, 7, v12
    v_lshl_add_u32 v12, v8, 3, v12
    v_bfe_u32 v10, v1, 4, 1
    v_lshl_add_u32 v12, v10, 5, v12
    v_add_u32 v12, s25, v12
    v_lshlrev_b32 v15, 2, v1
    s_mul_i32 s26, s16, 73728
    s_lshl_b32 s27, s15, 12
    s_add_u32 s26, s26, s27
    s_add_u32 s26, s26, 9551872
    s_add_u32 s27, s26, 36864
    s_mul_i32 s19, s15, 18432
    s_lshl_b32 s18, s16, 8
    s_add_u32 s19, s19, s18
    s_add_u32 s19, s19, 20168704
    v_mul_u32_u24 v9, 1152, v6
    v_lshl_add_u32 v9, v7, 4, v9
    s_mul_hi_u32 s21, s13, 477218589
    s_mul_i32 s22, s21, 9
    s_sub_u32 s22, s13, s22
    s_mul_i32 s14, s21, 73728
    s_lshl_b32 s18, s22, 7
    s_add_u32 s14, s14, s18
    v_lshrrev_b32 v11, 5, v1
    v_lshlrev_b32 v11, 4, v11
    v_bfe_u32 v10, v1, 2, 3
    v_add_u32 v11, v11, v10
    v_lshlrev_b32 v11, 7, v11
    v_lshl_add_u32 v11, v8, 3, v11
    v_add_u32 v11, s25, v11
    s_mul_i32 s23, s21, 18432
    s_add_u32 s23, s23, 14860288
    s_lshl_b32 s22, s22, 2
    s_add_u32 s18, s22, 0
    s_mul_i32 s21, s18, 57
    s_lshr_b32 s21, s21, 9
    s_mul_i32 s21, s21, 1317888
    s_lshl_b32 s18, s18, 10
    s_add_u32 s18, s18, s21
    s_add_u32 s34, s23, s18
    s_add_u32 s18, s22, 1
    s_mul_i32 s21, s18, 57
    s_lshr_b32 s21, s21, 9
    s_mul_i32 s21, s21, 1317888
    s_lshl_b32 s18, s18, 10
    s_add_u32 s18, s18, s21
    s_add_u32 s35, s23, s18
    s_add_u32 s18, s22, 2
    s_mul_i32 s21, s18, 57
    s_lshr_b32 s21, s21, 9
    s_mul_i32 s21, s21, 1317888
    s_lshl_b32 s18, s18, 10
    s_add_u32 s18, s18, s21
    s_add_u32 s36, s23, s18
    s_add_u32 s18, s22, 3
    s_mul_i32 s21, s18, 57
    s_lshr_b32 s21, s21, 9
    s_mul_i32 s21, s21, 1317888
    s_lshl_b32 s18, s18, 10
    s_add_u32 s18, s18, s21
    s_add_u32 s37, s23, s18
    s_cmp_lg_u32 s24, 0
    s_cbranch_scc1 Lpk_0_19
    s_waitcnt vmcnt(0)
Lpk_0_19:
    s_barrier
Lpk_0_18:
    s_cmp_ge_u32 s13, 648
    s_cbranch_scc1 Lpk_0_20
    s_add_u32 m0, s25, 0
    s_nop 0
    buffer_load_dwordx4 v13, s[28:31], s17 offen nt lds
    s_add_u32 s17, s17, 73728
    s_add_u32 m0, s25, 1024
    s_nop 0
    buffer_load_dwordx4 v13, s[28:31], s17 offen nt lds
    s_add_u32 s17, s17, 73728
    s_add_u32 m0, s25, 2048
    s_nop 0
    buffer_load_dwordx4 v13, s[28:31], s17 offen nt lds
    s_add_u32 s17, s17, 73728
    s_add_u32 m0, s25, 3072
    s_nop 0
    buffer_load_dwordx4 v13, s[28:31], s17 offen nt lds
    s_add_u32 s17, s17, 73728
    s_add_u32 m0, s25, 4096
    s_nop 0
    buffer_load_dwordx4 v13, s[28:31], s17 offen nt lds
    s_add_u32 s17, s17, 73728
    s_add_u32 m0, s25, 5120
    s_nop 0
    buffer_load_dwordx4 v13, s[28:31], s17 offen nt lds
    s_add_u32 s17, s17, 73728
    s_add_u32 m0, s25, 6144
    s_nop 0
    buffer_load_dwordx4 v13, s[28:31], s17 offen nt lds
    s_add_u32 s17, s17, 73728
    s_add_u32 m0, s25, 7168
    s_nop 0
    buffer_load_dwordx4 v13, s[28:31], s17 offen nt lds
    s_add_u32 m0, s25, 8192
    s_nop 0
    buffer_load_dwordx4 v9, s[44:47], s14 offen nt lds
    s_add_u32 s14, s14, 9216
    s_add_u32 m0, s25, 9216
    s_nop 0
    buffer_load_dwordx4 v9, s[44:47], s14 offen nt lds
    s_add_u32 s14, s14, 9216
    s_add_u32 m0, s25, 10240
    s_nop 0
    buffer_load_dwordx4 v9, s[44:47], s14 offen nt lds
    s_add_u32 s14, s14, 9216
    s_add_u32 m0, s25, 11264
    s_nop 0
    buffer_load_dwordx4 v9, s[44:47], s14 offen nt lds
    s_add_u32 s14, s14, 9216
    s_add_u32 m0, s25, 12288
    s_nop 0
    buffer_load_dwordx4 v9, s[44:47], s14 offen nt lds
    s_add_u32 s14, s14, 9216
    s_add_u32 m0, s25, 13312
    s_nop 0
    buffer_load_dwordx4 v9, s[44:47], s14 offen nt lds
    s_add_u32 s14, s14, 9216
    s_add_u32 m0, s25, 14336
    s_nop 0
    buffer_load_dwordx4 v9, s[44:47], s14 offen nt lds
    s_add_u32 s14, s14, 9216
    s_add_u32 m0, s25, 15360
    s_nop 0
    buffer_load_dwordx4 v9, s[44:47], s14 offen nt lds
Lpk_0_20:
    s_cmp_ge_u32 s13, 648
    s_cbranch_scc1 Lpk_0_21
    v_mov_b32 v17, 0
    v_mov_b32 v18, 0
    s_waitcnt vmcnt(8)
    ds_read_b64_tr_b16 v[40:41], v12 offset:0
    ds_read_b64_tr_b16 v[42:43], v12 offset:512
    ds_read_b64_tr_b16 v[44:45], v12 offset:2048
    ds_read_b64_tr_b16 v[46:47], v12 offset:2560
    ds_read_b64_tr_b16 v[48:49], v12 offset:4096
    ds_read_b64_tr_b16 v[50:51], v12 offset:4608
    ds_read_b64_tr_b16 v[52:53], v12 offset:6144
    ds_read_b64_tr_b16 v[54:55], v12 offset:6656
    ds_read_b64_tr_b16 v[56:57], v12 offset:64
    ds_read_b64_tr_b16 v[58:59], v12 offset:576
    ds_read_b64_tr_b16 v[60:61], v12 offset:2112
    ds_read_b64_tr_b16 v[62:63], v12 offset:2624
    ds_read_b64_tr_b16 v[64:65], v12 offset:4160
    ds_read_b64_tr_b16 v[66:67], v12 offset:4672
    ds_read_b64_tr_b16 v[68:69], v12 offset:6208
    ds_read_b64_tr_b16 v[70:71], v12 offset:6720
    s_waitcnt lgkmcnt(14)
    buffer_store_dwordx4 v[40:43], v3, s[8:11], s26 offen offset:0 sc1
    v_dot2_f32_bf16 v17, v40, s20, v17
    v_dot2_f32_bf16 v17, v41, s20, v17
    v_dot2_f32_bf16 v17, v42, s20, v17
    v_dot2_f32_bf16 v17, v43, s20, v17
    s_waitcnt lgkmcnt(12)
    buffer_store_dwordx4 v[44:47], v3, s[8:11], s26 offen offset:1024 sc1
    v_dot2_f32_bf16 v17, v44, s20, v17
    v_dot2_f32_bf16 v17, v45, s20, v17
    v_dot2_f32_bf16 v17, v46, s20, v17
    v_dot2_f32_bf16 v17, v47, s20, v17
    s_waitcnt lgkmcnt(10)
    buffer_store_dwordx4 v[48:51], v3, s[8:11], s26 offen offset:2048 sc1
    v_dot2_f32_bf16 v17, v48, s20, v17
    v_dot2_f32_bf16 v17, v49, s20, v17
    v_dot2_f32_bf16 v17, v50, s20, v17
    v_dot2_f32_bf16 v17, v51, s20, v17
    s_waitcnt lgkmcnt(8)
    buffer_store_dwordx4 v[52:55], v3, s[8:11], s26 offen offset:3072 sc1
    v_dot2_f32_bf16 v17, v52, s20, v17
    v_dot2_f32_bf16 v17, v53, s20, v17
    v_dot2_f32_bf16 v17, v54, s20, v17
    v_dot2_f32_bf16 v17, v55, s20, v17
    s_waitcnt lgkmcnt(6)
    buffer_store_dwordx4 v[56:59], v3, s[8:11], s27 offen offset:0 sc1
    v_dot2_f32_bf16 v18, v56, s20, v18
    v_dot2_f32_bf16 v18, v57, s20, v18
    v_dot2_f32_bf16 v18, v58, s20, v18
    v_dot2_f32_bf16 v18, v59, s20, v18
    s_waitcnt lgkmcnt(4)
    buffer_store_dwordx4 v[60:63], v3, s[8:11], s27 offen offset:1024 sc1
    v_dot2_f32_bf16 v18, v60, s20, v18
    v_dot2_f32_bf16 v18, v61, s20, v18
    v_dot2_f32_bf16 v18, v62, s20, v18
    v_dot2_f32_bf16 v18, v63, s20, v18
    s_waitcnt lgkmcnt(2)
    buffer_store_dwordx4 v[64:67], v3, s[8:11], s27 offen offset:2048 sc1
    v_dot2_f32_bf16 v18, v64, s20, v18
    v_dot2_f32_bf16 v18, v65, s20, v18
    v_dot2_f32_bf16 v18, v66, s20, v18
    v_dot2_f32_bf16 v18, v67, s20, v18
    s_waitcnt lgkmcnt(0)
    buffer_store_dwordx4 v[68:71], v3, s[8:11], s27 offen offset:3072 sc1
    v_dot2_f32_bf16 v18, v68, s20, v18
    v_dot2_f32_bf16 v18, v69, s20, v18
    v_dot2_f32_bf16 v18, v70, s20, v18
    v_dot2_f32_bf16 v18, v71, s20, v18
    s_nop 2
    v_permlane32_swap_b32 v17, v18
    v_add_f32 v17, v17, v18
    buffer_store_dword v17, v15, s[8:11], s19 offen sc1
    s_waitcnt vmcnt(9)
    ds_read_b64_tr_b16 v[72:73], v11 offset:8192
    ds_read_b64_tr_b16 v[74:75], v11 offset:9216
    ds_read_b64_tr_b16 v[76:77], v11 offset:8224
    ds_read_b64_tr_b16 v[78:79], v11 offset:9248
    ds_read_b64_tr_b16 v[80:81], v11 offset:8256
    ds_read_b64_tr_b16 v[82:83], v11 offset:9280
    ds_read_b64_tr_b16 v[84:85], v11 offset:8288
    ds_read_b64_tr_b16 v[86:87], v11 offset:9312
    ds_read_b64_tr_b16 v[88:89], v11 offset:12288
    ds_read_b64_tr_b16 v[90:91], v11 offset:13312
    ds_read_b64_tr_b16 v[92:93], v11 offset:12320
    ds_read_b64_tr_b16 v[94:95], v11 offset:13344
    ds_read_b64_tr_b16 v[96:97], v11 offset:12352
    ds_read_b64_tr_b16 v[98:99], v11 offset:13376
    ds_read_b64_tr_b16 v[100:101], v11 offset:12384
    ds_read_b64_tr_b16 v[102:103], v11 offset:13408
    s_waitcnt lgkmcnt(14)
    buffer_store_dwordx4 v[72:75], v3, s[8:11], s34 offen sc1
    s_waitcnt lgkmcnt(12)
    buffer_store_dwordx4 v[76:79], v3, s[8:11], s35 offen sc1
    s_waitcnt lgkmcnt(10)
    buffer_store_dwordx4 v[80:83], v3, s[8:11], s36 offen sc1
    s_waitcnt lgkmcnt(8)
    buffer_store_dwordx4 v[84:87], v3, s[8:11], s37 offen sc1
    s_waitcnt lgkmcnt(6)
    s_add_u32 s34, s34, 9216
    buffer_store_dwordx4 v[88:91], v3, s[8:11], s34 offen sc1
    s_waitcnt lgkmcnt(4)
    s_add_u32 s35, s35, 9216
    buffer_store_dwordx4 v[92:95], v3, s[8:11], s35 offen sc1
    s_waitcnt lgkmcnt(2)
    s_add_u32 s36, s36, 9216
    buffer_store_dwordx4 v[96:99], v3, s[8:11], s36 offen sc1
    s_waitcnt lgkmcnt(0)
    s_add_u32 s37, s37, 9216
    buffer_store_dwordx4 v[100:103], v3, s[8:11], s37 offen sc1
Lpk_0_21:
    s_cmp_lg_u32 s24, 7
    s_cbranch_scc1 Lpk_0_17
    v_and_b32 v17, 7, v1
    v_lshlrev_b32 v17, 8, v17
    v_add_u32 v17, 2048, v17
Lpo_0_28:
    buffer_load_dword v19, v17, s[8:11], 0 offen sc1
    s_sub_u32 s38, s38, 1
    s_cmp_lt_i32 s38, 0
    s_cbranch_scc1 Lpx_0_29
    s_waitcnt vmcnt(0)
    v_cmp_eq_u32 vcc, 0, v19
    s_nop 0
    s_cbranch_vccz Lpx_0_29
    s_sleep 1
    s_branch Lpo_0_28
Lpx_0_29:
    s_waitcnt vmcnt(0)
Lpk_0_17:
    s_barrier
    s_bfe_u32 s27, s2, 0x20003
    s_mul_i32 s27, s27, 165888
    s_cmp_ge_u32 s24, 4
    s_cselect_b32 s28, 663552, 0
    s_cselect_b32 s29, 18432, 0
    s_add_u32 s27, s27, s28
    s_add_u32 s27, s27, 8372224
    s_and_b32 s28, s24, 3
    s_mul_i32 s28, s28, 5
    s_min_u32 s28, s28, 13
    s_lshl_b32 s28, s28, 10
    s_add_u32 s27, s27, s28
    s_add_u32 s29, s29, s28
    s_add_u32 m0, s29, 126976
    s_nop 0
    buffer_load_dwordx4 v3, s[8:11], s27 offen offset:0 sc1 lds
    buffer_load_dwordx4 v3, s[8:11], s27 offen offset:1024 sc1 lds
    buffer_load_dwordx4 v3, s[8:11], s27 offen offset:2048 sc1 lds
    buffer_load_dwordx4 v3, s[8:11], s27 offen offset:3072 sc1 lds
    s_add_u32 m0, s29, 131072
    s_add_u32 s27, s27, 4096
    buffer_load_dwordx4 v3, s[8:11], s27 offen offset:0 sc1 lds
    s_cmp_ge_u32 s24, 4
    s_cbranch_scc1 Lx_0_30
    s_bfe_u32 s60, s2, 0x20003
    s_mul_i32 s60, s60, 165888
    s_and_b32 s61, s24, 3
    s_mul_i32 s61, s61, 36864
    s_add_u32 s60, s60, s61
    s_cmp_ge_u32 s24, 4
    s_cselect_b32 s61, 663552, 0
    s_add_u32 s60, s60, s61
    s_add_u32 s60, s60, 8224768
    s_add_u32 s61, s60, 0
    buffer_load_dwordx4 v[112:115], v3, s[8:11], s61 offen offset:0 sc1
    buffer_load_dwordx4 v[116:119], v3, s[8:11], s61 offen offset:1024 sc1
    buffer_load_dwordx4 v[120:123], v3, s[8:11], s61 offen offset:2048 sc1
    buffer_load_dwordx4 v[124:127], v3, s[8:11], s61 offen offset:3072 sc1
    s_add_u32 s61, s60, 4096
    buffer_load_dwordx4 v[128:131], v3, s[8:11], s61 offen offset:0 sc1
    buffer_load_dwordx4 v[132:135], v3, s[8:11], s61 offen offset:1024 sc1
    buffer_load_dwordx4 v[136:139], v3, s[8:11], s61 offen offset:2048 sc1
    buffer_load_dwordx4 v[140:143], v3, s[8:11], s61 offen offset:3072 sc1
    s_add_u32 s61, s60, 8192
    buffer_load_dwordx4 v[144:147], v3, s[8:11], s61 offen offset:0 sc1
    buffer_load_dwordx4 v[148:151], v3, s[8:11], s61 offen offset:1024 sc1
    buffer_load_dwordx4 v[152:155], v3, s[8:11], s61 offen offset:2048 sc1
    buffer_load_dwordx4 v[156:159], v3, s[8:11], s61 offen offset:3072 sc1
    s_add_u32 s61, s60, 12288
    buffer_load_dwordx4 v[160:163], v3, s[8:11], s61 offen offset:0 sc1
    buffer_load_dwordx4 v[164:167], v3, s[8:11], s61 offen offset:1024 sc1
    buffer_load_dwordx4 v[168:171], v3, s[8:11], s61 offen offset:2048 sc1
    buffer_load_dwordx4 v[172:175], v3, s[8:11], s61 offen offset:3072 sc1
    s_add_u32 s61, s60, 16384
    buffer_load_dwordx4 v[176:179], v3, s[8:11], s61 offen offset:0 sc1
    buffer_load_dwordx4 v[180:183], v3, s[8:11], s61 offen offset:1024 sc1
    buffer_load_dwordx4 v[184:187], v3, s[8:11], s61 offen offset:2048 sc1
    buffer_load_dwordx4 v[188:191], v3, s[8:11], s61 offen offset:3072 sc1
    s_add_u32 s61, s60, 20480
    buffer_load_dwordx4 v[192:195], v3, s[8:11], s61 offen offset:0 sc1
    buffer_load_dwordx4 v[196:199], v3, s[8:11], s61 offen offset:1024 sc1
    buffer_load_dwordx4 v[200:203], v3, s[8:11], s61 offen offset:2048 sc1
    buffer_load_dwordx4 v[204:207], v3, s[8:11], s61 offen offset:3072 sc1
    s_add_u32 s61, s60, 24576
    buffer_load_dwordx4 v[208:211], v3, s[8:11], s61 offen offset:0 sc1
    buffer_load_dwordx4 v[212:215], v3, s[8:11], s61 offen offset:1024 sc1
    buffer_load_dwordx4 v[216:219], v3, s[8:11], s61 offen offset:2048 sc1
    buffer_load_dwordx4 v[220:223], v3, s[8:11], s61 offen offset:3072 sc1
    s_add_u32 s61, s60, 28672
    buffer_load_dwordx4 v[224:227], v3, s[8:11], s61 offen offset:0 sc1
    buffer_load_dwordx4 v[228:231], v3, s[8:11], s61 offen offset:1024 sc1
    buffer_load_dwordx4 v[232:235], v3, s[8:11], s61 offen offset:2048 sc1
    buffer_load_dwordx4 v[236:239], v3, s[8:11], s61 offen offset:3072 sc1
    s_add_u32 s61, s60, 32768
    buffer_load_dwordx4 v[240:243], v3, s[8:11], s61 offen offset:0 sc1
    buffer_load_dwordx4 v[244:247], v3, s[8:11], s61 offen offset:1024 sc1
    buffer_load_dwordx4 v[248:251], v3, s[8:11], s61 offen offset:2048 sc1
    buffer_load_dwordx4 v[252:255], v3, s[8:11], s61 offen offset:3072 sc1
Lx_0_30:
    s_waitcnt vmcnt(0)
    s_barrier
    s_cmp_lg_u32 s24, 7
    s_cbranch_scc1 Lpk_0_22
    s_mov_b32 s18, 16
    s_lshl_b32 s18, s18, 8
    v_mov_b32 v4, 0
    v_mov_b32 v5, 1
    s_mov_b64 exec, 1
    buffer_atomic_add v5, v4, s[8:11], s18 offen sc0 sc1
    s_mov_b64 exec, -1
    s_waitcnt vmcnt(0)
    v_readfirstlane_b32 s3, v5
    s_nop 0
    s_cmp_lg_u32 s3, 111
    s_cbranch_scc1 Lar_0_31
    v_mov_b32 v5, 1
    s_mov_b64 exec, 1
    buffer_store_dword v5, v4, s[8:11], s18 offen offset:256 sc1
    s_mov_b64 exec, -1
Lar_0_31:
Lpk_0_22:
    s_branch LD_0_3
Lpack_0_2:
    s_waitcnt vmcnt(3)
    s_cmp_lt_u32 s24, 6
    s_cbranch_scc1 Lkg_0_32
    s_waitcnt vmcnt(0)
Lkg_0_32:
    v_lshlrev_b32 v40, 16, v40
    v_lshlrev_b32 v41, 16, v41
    v_lshlrev_b32 v42, 16, v42
    v_lshlrev_b32 v43, 16, v43
    v_lshlrev_b32 v44, 16, v44
    v_lshlrev_b32 v45, 16, v45
    v_lshlrev_b32 v46, 16, v46
    v_lshlrev_b32 v47, 16, v47
    v_mul_f32 v46, 0x3fb8aa3b, v46
    v_exp_f32 v46, v46
    s_nop 0
    v_cvt_pk_bf16_f32 v46, v46, v46
    v_and_b32 v46, 0xffff0000, v46
    v_mul_f32 v40, v40, v46
    v_mul_f32 v41, v41, v46
    v_mul_f32 v42, v42, v46
    v_mul_f32 v43, v43, v46
    v_mul_f32 v40, 0x3fb8aa3b, v40
    v_mul_f32 v41, 0x3e22f983, v41
    v_mul_f32 v68, v44, v42
    v_fma_f32 v68, -v45, v43, v68
    v_mul_f32 v69, v44, v43
    v_fma_f32 v69, -v45, v42, -v69
    s_mul_i32 s13, s24, 17408
    v_lshl_add_u32 v12, v1, 2, s13
    v_mul_f32 v60, 0x3f800000, v40
    v_mul_f32 v61, 0x3f800000, v41
    v_exp_f32 v60, v60
    v_fract_f32 v61, v61
    v_cos_f32 v48, v61
    v_sin_f32 v49, v61
    v_mul_f32 v48, v48, v60
    v_mul_f32 v49, v49, v60
    v_mul_f32 v60, 0x41000000, v40
    v_mul_f32 v61, 0x41000000, v41
    v_exp_f32 v60, v60
    v_fract_f32 v61, v61
    v_cos_f32 v54, v61
    v_sin_f32 v55, v61
    v_mul_f32 v54, v54, v60
    v_mul_f32 v55, v55, v60
    v_mul_f32 v60, 0x43800000, v40
    v_mul_f32 v61, 0x43800000, v41
    v_exp_f32 v60, v60
    v_fract_f32 v61, v61
    v_cos_f32 v56, v61
    v_sin_f32 v57, v61
    v_mul_f32 v56, v56, v60
    v_mul_f32 v57, v57, v60
    v_pk_mul_f32 v[60:61], v[48:49], v[48:49] op_sel:[0,0] op_sel_hi:[0,1]
    s_nop 0
    v_pk_fma_f32 v[50:51], v[48:49], v[48:49], v[60:61] op_sel:[1,1,0] op_sel_hi:[1,0,1] neg_lo:[0,1,0]
    s_nop 0
    v_pk_mul_f32 v[60:61], v[50:51], v[50:51] op_sel:[0,0] op_sel_hi:[0,1]
    s_nop 0
    v_pk_fma_f32 v[52:53], v[50:51], v[50:51], v[60:61] op_sel:[1,1,0] op_sel_hi:[1,0,1] neg_lo:[0,1,0]
    s_waitcnt vmcnt(0)
    s_barrier
    s_cmp_lg_u32 s24, 0
    s_cbranch_scc1 Lsa_0_33
    v_cmp_ne_u32 vcc, 0, v5
    s_nop 0
    s_cbranch_vccnz Lso_0_35
Lsp_0_34:
    s_sleep 2
    global_load_dword v5, v4, s[50:51] sc1
    s_sub_u32 s38, s38, 1
    s_cmp_lt_i32 s38, 0
    s_cbranch_scc1 Lso_0_35
    s_waitcnt vmcnt(0)
    v_cmp_eq_u32 vcc, 0, v5
    s_nop 0
    s_cbranch_vccnz Lsp_0_34
Lso_0_35:
    s_waitcnt vmcnt(0)
    s_and_b32 s49, s2, 7
    s_add_u32 s49, s49, 0
    s_lshl_b32 s49, s49, 8
    v_mov_b32 v4, 0
    v_mov_b32 v5, 1
    s_mov_b64 exec, 1
    buffer_atomic_add v5, v4, s[8:11], s49 offen sc0 sc1
    s_mov_b64 exec, -1
Lsa_0_33:
    v_mov_b32 v70, 0x00003f80
    v_cvt_pk_bf16_f32 v71, v68, v69
    ds_write_b32 v12, v70
    ds_write_b32 v12, v71 offset:8704
    v_cvt_pk_bf16_f32 v70, v54, v55
    v_pk_mul_f32 v[62:63], v[68:69], v[48:49] op_sel:[0,0] op_sel_hi:[0,1] neg_hi:[0,1]
    ds_write_b32 v12, v70 offset:272
    v_pk_fma_f32 v[66:67], v[68:69], v[48:49], v[62:63] op_sel:[1,1,0] op_sel_hi:[1,0,1]
    s_nop 0
    v_cvt_pk_bf16_f32 v71, v66, v67
    ds_write_b32 v12, v71 offset:8976
    v_pk_mul_f32 v[60:61], v[54:55], v[54:55] op_sel:[0,0] op_sel_hi:[0,1]
    v_pk_mul_f32 v[62:63], v[66:67], v[48:49] op_sel:[0,0] op_sel_hi:[0,1] neg_hi:[0,1]
    v_pk_fma_f32 v[64:65], v[54:55], v[54:55], v[60:61] op_sel:[1,1,0] op_sel_hi:[1,0,1] neg_lo:[0,1,0]
    v_pk_fma_f32 v[66:67], v[66:67], v[48:49], v[62:63] op_sel:[1,1,0] op_sel_hi:[1,0,1]
    v_cvt_pk_bf16_f32 v70, v64, v65
    v_cvt_pk_bf16_f32 v71, v66, v67
    ds_write_b32 v12, v70 offset:544
    ds_write_b32 v12, v71 offset:9248
    v_pk_mul_f32 v[60:61], v[64:65], v[54:55] op_sel:[0,0] op_sel_hi:[0,1]
    v_pk_mul_f32 v[62:63], v[66:67], v[48:49] op_sel:[0,0] op_sel_hi:[0,1] neg_hi:[0,1]
    v_pk_fma_f32 v[64:65], v[64:65], v[54:55], v[60:61] op_sel:[1,1,0] op_sel_hi:[1,0,1] neg_lo:[0,1,0]
    v_pk_fma_f32 v[66:67], v[66:67], v[48:49], v[62:63] op_sel:[1,1,0] op_sel_hi:[1,0,1]
    v_cvt_pk_bf16_f32 v70, v64, v65
    v_cvt_pk_bf16_f32 v71, v66, v67
    ds_write_b32 v12, v70 offset:816
    ds_write_b32 v12, v71 offset:9520
    v_pk_mul_f32 v[60:61], v[64:65], v[54:55] op_sel:[0,0] op_sel_hi:[0,1]
    v_pk_mul_f32 v[62:63], v[66:67], v[48:49] op_sel:[0,0] op_sel_hi:[0,1] neg_hi:[0,1]
    v_pk_fma_f32 v[64:65], v[64:65], v[54:55], v[60:61] op_sel:[1,1,0] op_sel_hi:[1,0,1] neg_lo:[0,1,0]
    v_pk_fma_f32 v[66:67], v[66:67], v[48:49], v[62:63] op_sel:[1,1,0] op_sel_hi:[1,0,1]
    v_cvt_pk_bf16_f32 v70, v64, v65
    v_cvt_pk_bf16_f32 v71, v66, v67
    ds_write_b32 v12, v70 offset:1088
    ds_write_b32 v12, v71 offset:10880
    v_pk_mul_f32 v[60:61], v[64:65], v[54:55] op_sel:[0,0] op_sel_hi:[0,1]
    v_pk_mul_f32 v[62:63], v[66:67], v[48:49] op_sel:[0,0] op_sel_hi:[0,1] neg_hi:[0,1]
    v_pk_fma_f32 v[64:65], v[64:65], v[54:55], v[60:61] op_sel:[1,1,0] op_sel_hi:[1,0,1] neg_lo:[0,1,0]
    v_pk_fma_f32 v[66:67], v[66:67], v[48:49], v[62:63] op_sel:[1,1,0] op_sel_hi:[1,0,1]
    v_cvt_pk_bf16_f32 v70, v64, v65
    v_cvt_pk_bf16_f32 v71, v66, v67
    ds_write_b32 v12, v70 offset:1360
    ds_write_b32 v12, v71 offset:11152
    v_pk_mul_f32 v[60:61], v[64:65], v[54:55] op_sel:[0,0] op_sel_hi:[0,1]
    v_pk_mul_f32 v[62:63], v[66:67], v[48:49] op_sel:[0,0] op_sel_hi:[0,1] neg_hi:[0,1]
    v_pk_fma_f32 v[64:65], v[64:65], v[54:55], v[60:61] op_sel:[1,1,0] op_sel_hi:[1,0,1] neg_lo:[0,1,0]
    v_pk_fma_f32 v[66:67], v[66:67], v[48:49], v[62:63] op_sel:[1,1,0] op_sel_hi:[1,0,1]
    v_cvt_pk_bf16_f32 v70, v64, v65
    v_cvt_pk_bf16_f32 v71, v66, v67
    ds_write_b32 v12, v70 offset:1632
    ds_write_b32 v12, v71 offset:11424
    v_pk_mul_f32 v[60:61], v[64:65], v[54:55] op_sel:[0,0] op_sel_hi:[0,1]
    v_pk_mul_f32 v[62:63], v[66:67], v[48:49] op_sel:[0,0] op_sel_hi:[0,1] neg_hi:[0,1]
    v_pk_fma_f32 v[64:65], v[64:65], v[54:55], v[60:61] op_sel:[1,1,0] op_sel_hi:[1,0,1] neg_lo:[0,1,0]
    v_pk_fma_f32 v[66:67], v[66:67], v[48:49], v[62:63] op_sel:[1,1,0] op_sel_hi:[1,0,1]
    v_cvt_pk_bf16_f32 v70, v64, v65
    v_cvt_pk_bf16_f32 v71, v66, v67
    ds_write_b32 v12, v70 offset:1904
    ds_write_b32 v12, v71 offset:11696
    v_pk_mul_f32 v[60:61], v[64:65], v[54:55] op_sel:[0,0] op_sel_hi:[0,1]
    v_pk_mul_f32 v[62:63], v[68:69], v[56:57] op_sel:[0,0] op_sel_hi:[0,1] neg_hi:[0,1]
    v_pk_fma_f32 v[64:65], v[64:65], v[54:55], v[60:61] op_sel:[1,1,0] op_sel_hi:[1,0,1] neg_lo:[0,1,0]
    v_pk_fma_f32 v[68:69], v[68:69], v[56:57], v[62:63] op_sel:[1,1,0] op_sel_hi:[1,0,1]
    v_cvt_pk_bf16_f32 v70, v64, v65
    v_cvt_pk_bf16_f32 v71, v68, v69
    ds_write_b32 v12, v70 offset:2176
    ds_write_b32 v12, v71 offset:9792
    ds_write_b32 v12, v71 offset:10064
    v_pk_mul_f32 v[60:61], v[64:65], v[54:55] op_sel:[0,0] op_sel_hi:[0,1]
    v_pk_mul_f32 v[62:63], v[68:69], v[50:51] op_sel:[0,0] op_sel_hi:[0,1] neg_hi:[0,1]
    v_pk_fma_f32 v[64:65], v[64:65], v[54:55], v[60:61] op_sel:[1,1,0] op_sel_hi:[1,0,1] neg_lo:[0,1,0]
    v_pk_fma_f32 v[66:67], v[68:69], v[50:51], v[62:63] op_sel:[1,1,0] op_sel_hi:[1,0,1]
    v_cvt_pk_bf16_f32 v70, v64, v65
    v_cvt_pk_bf16_f32 v71, v66, v67
    ds_write_b32 v12, v70 offset:2448
    ds_write_b32 v12, v71 offset:10336
    s_cmp_lg_u32 s24, 0
    s_cbranch_scc1 Lsf_0_36
    s_waitcnt vmcnt(0)
    v_readfirstlane_b32 s3, v5
    s_nop 0
    s_cmp_lg_u32 s3, 31
    s_cbranch_scc1 Lar_0_37
    v_mov_b32 v5, 1
    s_mov_b64 exec, 1
    buffer_store_dword v5, v4, s[8:11], s49 offen offset:2048 sc1
    s_mov_b64 exec, -1
Lar_0_37:
Lsf_0_36:
    v_pk_mul_f32 v[60:61], v[64:65], v[54:55] op_sel:[0,0] op_sel_hi:[0,1]
    v_pk_mul_f32 v[62:63], v[66:67], v[50:51] op_sel:[0,0] op_sel_hi:[0,1] neg_hi:[0,1]
    v_pk_fma_f32 v[64:65], v[64:65], v[54:55], v[60:61] op_sel:[1,1,0] op_sel_hi:[1,0,1] neg_lo:[0,1,0]
    v_pk_fma_f32 v[66:67], v[66:67], v[50:51], v[62:63] op_sel:[1,1,0] op_sel_hi:[1,0,1]
    v_cvt_pk_bf16_f32 v70, v64, v65
    v_cvt_pk_bf16_f32 v71, v66, v67
    ds_write_b32 v12, v70 offset:2720
    ds_write_b32 v12, v71 offset:10608
    ds_write_b32 v12, v71 offset:11968
    ds_write_b32 v12, v71 offset:12240
    v_pk_mul_f32 v[60:61], v[64:65], v[54:55] op_sel:[0,0] op_sel_hi:[0,1]
    v_pk_mul_f32 v[62:63], v[66:67], v[50:51] op_sel:[0,0] op_sel_hi:[0,1] neg_hi:[0,1]
    v_pk_fma_f32 v[64:65], v[64:65], v[54:55], v[60:61] op_sel:[1,1,0] op_sel_hi:[1,0,1] neg_lo:[0,1,0]
    v_pk_fma_f32 v[66:67], v[66:67], v[50:51], v[62:63] op_sel:[1,1,0] op_sel_hi:[1,0,1]
    v_cvt_pk_bf16_f32 v70, v64, v65
    v_cvt_pk_bf16_f32 v71, v66, v67
    ds_write_b32 v12, v70 offset:2992
    ds_write_b32 v12, v71 offset:12512
    v_pk_mul_f32 v[60:61], v[64:65], v[54:55] op_sel:[0,0] op_sel_hi:[0,1]
    v_pk_mul_f32 v[62:63], v[66:67], v[50:51] op_sel:[0,0] op_sel_hi:[0,1] neg_hi:[0,1]
    v_pk_fma_f32 v[64:65], v[64:65], v[54:55], v[60:61] op_sel:[1,1,0] op_sel_hi:[1,0,1] neg_lo:[0,1,0]
    v_pk_fma_f32 v[66:67], v[66:67], v[50:51], v[62:63] op_sel:[1,1,0] op_sel_hi:[1,0,1]
    v_cvt_pk_bf16_f32 v70, v64, v65
    v_cvt_pk_bf16_f32 v71, v66, v67
    ds_write_b32 v12, v70 offset:3264
    ds_write_b32 v12, v71 offset:12784
    v_pk_mul_f32 v[60:61], v[64:65], v[54:55] op_sel:[0,0] op_sel_hi:[0,1]
    v_pk_mul_f32 v[62:63], v[68:69], v[56:57] op_sel:[0,0] op_sel_hi:[0,1] neg_hi:[0,1]
    v_pk_fma_f32 v[64:65], v[64:65], v[54:55], v[60:61] op_sel:[1,1,0] op_sel_hi:[1,0,1] neg_lo:[0,1,0]
    v_pk_fma_f32 v[68:69], v[68:69], v[56:57], v[62:63] op_sel:[1,1,0] op_sel_hi:[1,0,1]
    v_cvt_pk_bf16_f32 v70, v64, v65
    v_cvt_pk_bf16_f32 v71, v68, v69
    ds_write_b32 v12, v70 offset:3536
    ds_write_b32 v12, v71 offset:13056
    s_lshl_b32 s16, s2, 3
    s_add_u32 s16, s16, s24
    s_lshl_b32 s16, s16, 11
    s_add_u32 s16, s16, 25055232
    v_mov_b32 v32, -1
    v_mov_b32 v33, -1
    v_mov_b32 v34, -1
    v_mov_b32 v35, -1
    buffer_store_dwordx4 v[32:35], v3, s[8:11], s16 offen sc1
    buffer_store_dwordx4 v[32:35], v3, s[8:11], s16 offen offset:1024 sc1
    v_pk_mul_f32 v[60:61], v[64:65], v[54:55] op_sel:[0,0] op_sel_hi:[0,1]
    v_pk_mul_f32 v[62:63], v[68:69], v[52:53] op_sel:[0,0] op_sel_hi:[0,1] neg_hi:[0,1]
    v_pk_fma_f32 v[64:65], v[64:65], v[54:55], v[60:61] op_sel:[1,1,0] op_sel_hi:[1,0,1] neg_lo:[0,1,0]
    v_pk_fma_f32 v[66:67], v[68:69], v[52:53], v[62:63] op_sel:[1,1,0] op_sel_hi:[1,0,1]
    v_cvt_pk_bf16_f32 v70, v64, v65
    v_cvt_pk_bf16_f32 v71, v66, v67
    ds_write_b32 v12, v70 offset:3808
    ds_write_b32 v12, v71 offset:13328
    v_pk_mul_f32 v[60:61], v[64:65], v[54:55] op_sel:[0,0] op_sel_hi:[0,1]
    v_pk_mul_f32 v[62:63], v[66:67], v[52:53] op_sel:[0,0] op_sel_hi:[0,1] neg_hi:[0,1]
    v_pk_fma_f32 v[64:65], v[64:65], v[54:55], v[60:61] op_sel:[1,1,0] op_sel_hi:[1,0,1] neg_lo:[0,1,0]
    v_pk_fma_f32 v[66:67], v[66:67], v[52:53], v[62:63] op_sel:[1,1,0] op_sel_hi:[1,0,1]
    v_cvt_pk_bf16_f32 v70, v64, v65
    v_cvt_pk_bf16_f32 v71, v66, v67
    ds_write_b32 v12, v70 offset:4080
    ds_write_b32 v12, v71 offset:13600
    ds_write_b32 v12, v71 offset:13872
    v_pk_mul_f32 v[60:61], v[64:65], v[54:55] op_sel:[0,0] op_sel_hi:[0,1]
    v_pk_mul_f32 v[62:63], v[68:69], v[56:57] op_sel:[0,0] op_sel_hi:[0,1] neg_hi:[0,1]
    v_pk_fma_f32 v[64:65], v[64:65], v[54:55], v[60:61] op_sel:[1,1,0] op_sel_hi:[1,0,1] neg_lo:[0,1,0]
    v_pk_fma_f32 v[68:69], v[68:69], v[56:57], v[62:63] op_sel:[1,1,0] op_sel_hi:[1,0,1]
    v_cvt_pk_bf16_f32 v70, v64, v65
    v_cvt_pk_bf16_f32 v71, v68, v69
    ds_write_b32 v12, v70 offset:4352
    ds_write_b32 v12, v71 offset:14144
    v_pk_mul_f32 v[60:61], v[64:65], v[54:55] op_sel:[0,0] op_sel_hi:[0,1]
    v_pk_mul_f32 v[62:63], v[68:69], v[52:53] op_sel:[0,0] op_sel_hi:[0,1] neg_hi:[0,1]
    v_pk_fma_f32 v[64:65], v[64:65], v[54:55], v[60:61] op_sel:[1,1,0] op_sel_hi:[1,0,1] neg_lo:[0,1,0]
    v_pk_fma_f32 v[66:67], v[68:69], v[52:53], v[62:63] op_sel:[1,1,0] op_sel_hi:[1,0,1]
    v_cvt_pk_bf16_f32 v70, v64, v65
    v_cvt_pk_bf16_f32 v71, v66, v67
    ds_write_b32 v12, v70 offset:4624
    ds_write_b32 v12, v71 offset:14416
    v_pk_mul_f32 v[60:61], v[64:65], v[54:55] op_sel:[0,0] op_sel_hi:[0,1]
    v_pk_mul_f32 v[62:63], v[66:67], v[52:53] op_sel:[0,0] op_sel_hi:[0,1] neg_hi:[0,1]
    v_pk_fma_f32 v[64:65], v[64:65], v[54:55], v[60:61] op_sel:[1,1,0] op_sel_hi:[1,0,1] neg_lo:[0,1,0]
    v_pk_fma_f32 v[66:67], v[66:67], v[52:53], v[62:63] op_sel:[1,1,0] op_sel_hi:[1,0,1]
    v_cvt_pk_bf16_f32 v70, v64, v65
    v_cvt_pk_bf16_f32 v71, v66, v67
    ds_write_b32 v12, v70 offset:4896
    ds_write_b32 v12, v71 offset:14688
    ds_write_b32 v12, v71 offset:14960
    v_pk_mul_f32 v[60:61], v[64:65], v[54:55] op_sel:[0,0] op_sel_hi:[0,1]
    v_pk_mul_f32 v[62:63], v[68:69], v[56:57] op_sel:[0,0] op_sel_hi:[0,1] neg_hi:[0,1]
    v_pk_fma_f32 v[64:65], v[64:65], v[54:55], v[60:61] op_sel:[1,1,0] op_sel_hi:[1,0,1] neg_lo:[0,1,0]
    v_pk_fma_f32 v[68:69], v[68:69], v[56:57], v[62:63] op_sel:[1,1,0] op_sel_hi:[1,0,1]
    v_cvt_pk_bf16_f32 v70, v64, v65
    v_cvt_pk_bf16_f32 v71, v68, v69
    ds_write_b32 v12, v70 offset:5168
    ds_write_b32 v12, v71 offset:15232
    v_pk_mul_f32 v[60:61], v[64:65], v[54:55] op_sel:[0,0] op_sel_hi:[0,1]
    v_pk_mul_f32 v[62:63], v[68:69], v[54:55] op_sel:[0,0] op_sel_hi:[0,1] neg_hi:[0,1]
    v_pk_fma_f32 v[64:65], v[64:65], v[54:55], v[60:61] op_sel:[1,1,0] op_sel_hi:[1,0,1] neg_lo:[0,1,0]
    v_pk_fma_f32 v[66:67], v[68:69], v[54:55], v[62:63] op_sel:[1,1,0] op_sel_hi:[1,0,1]
    v_cvt_pk_bf16_f32 v70, v64, v65
    v_cvt_pk_bf16_f32 v71, v66, v67
    ds_write_b32 v12, v70 offset:5440
    ds_write_b32 v12, v71 offset:15504
    v_pk_mul_f32 v[60:61], v[64:65], v[54:55] op_sel:[0,0] op_sel_hi:[0,1]
    v_pk_mul_f32 v[62:63], v[68:69], v[56:57] op_sel:[0,0] op_sel_hi:[0,1] neg_hi:[0,1]
    v_pk_fma_f32 v[64:65], v[64:65], v[54:55], v[60:61] op_sel:[1,1,0] op_sel_hi:[1,0,1] neg_lo:[0,1,0]
    v_pk_fma_f32 v[68:69], v[68:69], v[56:57], v[62:63] op_sel:[1,1,0] op_sel_hi:[1,0,1]
    v_cvt_pk_bf16_f32 v70, v64, v65
    v_cvt_pk_bf16_f32 v71, v68, v69
    ds_write_b32 v12, v70 offset:5712
    ds_write_b32 v12, v71 offset:16320
    v_pk_mul_f32 v[60:61], v[64:65], v[54:55] op_sel:[0,0] op_sel_hi:[0,1]
    v_pk_mul_f32 v[62:63], v[68:69], v[54:55] op_sel:[0,0] op_sel_hi:[0,1] neg_hi:[0,1]
    v_pk_fma_f32 v[64:65], v[64:65], v[54:55], v[60:61] op_sel:[1,1,0] op_sel_hi:[1,0,1] neg_lo:[0,1,0]
    v_pk_fma_f32 v[66:67], v[68:69], v[54:55], v[62:63] op_sel:[1,1,0] op_sel_hi:[1,0,1]
    v_cvt_pk_bf16_f32 v70, v64, v65
    v_cvt_pk_bf16_f32 v71, v66, v67
    ds_write_b32 v12, v70 offset:5984
    ds_write_b32 v12, v71 offset:16592
    v_pk_mul_f32 v[60:61], v[64:65], v[54:55] op_sel:[0,0] op_sel_hi:[0,1]
    v_pk_mul_f32 v[62:63], v[68:69], v[56:57] op_sel:[0,0] op_sel_hi:[0,1] neg_hi:[0,1]
    v_pk_fma_f32 v[64:65], v[64:65], v[54:55], v[60:61] op_sel:[1,1,0] op_sel_hi:[1,0,1] neg_lo:[0,1,0]
    v_pk_fma_f32 v[68:69], v[68:69], v[56:57], v[62:63] op_sel:[1,1,0] op_sel_hi:[1,0,1]
    v_cvt_pk_bf16_f32 v70, v64, v65
    v_cvt_pk_bf16_f32 v71, v68, v69
    ds_write_b32 v12, v70 offset:6256
    ds_write_b32 v12, v71 offset:15776
    v_pk_mul_f32 v[60:61], v[64:65], v[54:55] op_sel:[0,0] op_sel_hi:[0,1]
    v_pk_mul_f32 v[62:63], v[68:69], v[54:55] op_sel:[0,0] op_sel_hi:[0,1] neg_hi:[0,1]
    v_pk_fma_f32 v[64:65], v[64:65], v[54:55], v[60:61] op_sel:[1,1,0] op_sel_hi:[1,0,1] neg_lo:[0,1,0]
    v_pk_fma_f32 v[66:67], v[68:69], v[54:55], v[62:63] op_sel:[1,1,0] op_sel_hi:[1,0,1]
    v_cvt_pk_bf16_f32 v70, v64, v65
    v_cvt_pk_bf16_f32 v71, v66, v67
    ds_write_b32 v12, v70 offset:6528
    ds_write_b32 v12, v71 offset:16048
    v_pk_mul_f32 v[60:61], v[64:65], v[54:55] op_sel:[0,0] op_sel_hi:[0,1]
    v_pk_mul_f32 v[62:63], v[68:69], v[56:57] op_sel:[0,0] op_sel_hi:[0,1] neg_hi:[0,1]
    v_pk_fma_f32 v[64:65], v[64:65], v[54:55], v[60:61] op_sel:[1,1,0] op_sel_hi:[1,0,1] neg_lo:[0,1,0]
    v_pk_fma_f32 v[68:69], v[68:69], v[56:57], v[62:63] op_sel:[1,1,0] op_sel_hi:[1,0,1]
    v_cvt_pk_bf16_f32 v70, v64, v65
    v_cvt_pk_bf16_f32 v71, v68, v69
    ds_write_b32 v12, v70 offset:6800
    ds_write_b32 v12, v71 offset:16864
    v_pk_mul_f32 v[60:61], v[64:65], v[54:55] op_sel:[0,0] op_sel_hi:[0,1]
    v_pk_mul_f32 v[62:63], v[68:69], v[54:55] op_sel:[0,0] op_sel_hi:[0,1] neg_hi:[0,1]
    v_pk_fma_f32 v[64:65], v[64:65], v[54:55], v[60:61] op_sel:[1,1,0] op_sel_hi:[1,0,1] neg_lo:[0,1,0]
    v_pk_fma_f32 v[66:67], v[68:69], v[54:55], v[62:63] op_sel:[1,1,0] op_sel_hi:[1,0,1]
    v_cvt_pk_bf16_f32 v70, v64, v65
    v_cvt_pk_bf16_f32 v71, v66, v67
    ds_write_b32 v12, v70 offset:7072
    ds_write_b32 v12, v71 offset:17136
    v_pk_mul_f32 v[60:61], v[64:65], v[54:55] op_sel:[0,0] op_sel_hi:[0,1]
    s_nop 0
    v_pk_fma_f32 v[64:65], v[64:65], v[54:55], v[60:61] op_sel:[1,1,0] op_sel_hi:[1,0,1] neg_lo:[0,1,0]
    s_nop 0
    v_cvt_pk_bf16_f32 v70, v64, v65
    ds_write_b32 v12, v70 offset:7344
    v_pk_mul_f32 v[60:61], v[64:65], v[54:55] op_sel:[0,0] op_sel_hi:[0,1]
    s_nop 0
    v_pk_fma_f32 v[64:65], v[64:65], v[54:55], v[60:61] op_sel:[1,1,0] op_sel_hi:[1,0,1] neg_lo:[0,1,0]
    s_nop 0
    v_cvt_pk_bf16_f32 v70, v64, v65
    ds_write_b32 v12, v70 offset:7616
    v_pk_mul_f32 v[60:61], v[64:65], v[54:55] op_sel:[0,0] op_sel_hi:[0,1]
    s_nop 0
    v_pk_fma_f32 v[64:65], v[64:65], v[54:55], v[60:61] op_sel:[1,1,0] op_sel_hi:[1,0,1] neg_lo:[0,1,0]
    s_nop 0
    v_cvt_pk_bf16_f32 v70, v64, v65
    ds_write_b32 v12, v70 offset:7888
    v_pk_mul_f32 v[60:61], v[64:65], v[54:55] op_sel:[0,0] op_sel_hi:[0,1]
    s_nop 0
    v_pk_fma_f32 v[64:65], v[64:65], v[54:55], v[60:61] op_sel:[1,1,0] op_sel_hi:[1,0,1] neg_lo:[0,1,0]
    s_nop 0
    v_cvt_pk_bf16_f32 v70, v64, v65
    ds_write_b32 v12, v70 offset:8160
    v_pk_mul_f32 v[60:61], v[64:65], v[54:55] op_sel:[0,0] op_sel_hi:[0,1]
    s_nop 0
    v_pk_fma_f32 v[64:65], v[64:65], v[54:55], v[60:61] op_sel:[1,1,0] op_sel_hi:[1,0,1] neg_lo:[0,1,0]
    s_nop 0
    v_cvt_pk_bf16_f32 v70, v64, v65
    ds_write_b32 v12, v70 offset:8432
    v_and_b32 v13, 31, v1
    v_mul_u32_u24 v13, 272, v13
    v_lshrrev_b32 v14, 5, v1
    v_lshl_add_u32 v13, v14, 4, v13
    v_add_u32 v13, s13, v13
    v_and_b32 v108, 7, v1
    v_lshlrev_b32 v108, 8, v108
    v_add_u32 v108, 2048, v108
    s_cmp_lg_u32 s24, 0
    s_cbranch_scc1 Lkg_0_38
    buffer_load_dword v110, v108, s[8:11], 0 offen sc1
Lkg_0_38:
    v_and_b32 v19, 7, v1
    v_mul_u32_u24 v19, 4624, v19
    v_lshrrev_b32 v14, 3, v1
    v_lshl_add_u32 v19, v14, 4, v19
    s_lshl_b32 s19, s24, 9
    s_add_u32 s19, s19, 67040
    v_add_u32 v19, s19, v19
    s_mul_i32 s18, s39, 32896
    s_lshl_b32 s19, s24, 12
    s_add_u32 s18, s18, s19
    s_add_u32 s18, s18, 1048576
    s_waitcnt lgkmcnt(0)
    ds_read_b128 v[112:115], v13 offset:8704
    ds_read_b128 v[116:119], v13 offset:0
    ds_read_b128 v[120:123], v13 offset:8736
    ds_read_b128 v[124:127], v13 offset:32
    ds_read_b128 v[128:131], v13 offset:8768
    ds_read_b128 v[132:135], v13 offset:64
    ds_read_b128 v[136:139], v13 offset:8800
    ds_read_b128 v[140:143], v13 offset:96
    ds_read_b128 v[144:147], v13 offset:8832
    ds_read_b128 v[148:151], v13 offset:128
    ds_read_b128 v[152:155], v13 offset:8864
    ds_read_b128 v[156:159], v13 offset:160
    ds_read_b128 v[160:163], v13 offset:8896
    ds_read_b128 v[164:167], v13 offset:192
    ds_read_b128 v[168:171], v13 offset:8928
    ds_read_b128 v[172:175], v13 offset:224
    s_waitcnt lgkmcnt(14)
    v_mfma_f32_32x32x16_bf16 v[72:87], v[112:115], v[116:119], 0
    s_waitcnt lgkmcnt(12)
    v_mfma_f32_32x32x16_bf16 v[72:87], v[120:123], v[124:127], v[72:87]
    s_waitcnt lgkmcnt(10)
    v_mfma_f32_32x32x16_bf16 v[72:87], v[128:131], v[132:135], v[72:87]
    s_waitcnt lgkmcnt(8)
    v_mfma_f32_32x32x16_bf16 v[72:87], v[136:139], v[140:143], v[72:87]
    s_waitcnt lgkmcnt(6)
    v_mfma_f32_32x32x16_bf16 v[72:87], v[144:147], v[148:151], v[72:87]
    s_waitcnt lgkmcnt(4)
    v_mfma_f32_32x32x16_bf16 v[72:87], v[152:155], v[156:159], v[72:87]
    s_waitcnt lgkmcnt(2)
    v_mfma_f32_32x32x16_bf16 v[72:87], v[160:163], v[164:167], v[72:87]
    s_waitcnt lgkmcnt(0)
    v_mfma_f32_32x32x16_bf16 v[72:87], v[168:171], v[172:175], v[72:87]
    s_lshl_b32 s15, s24, 11
    s_add_u32 s15, s15, 139264
    v_add_u32 v14, s15, v3
    s_xor_b32 s15, s15, 2048
    v_add_u32 v15, s15, v3
    s_lshr_b32 s16, s24, 1
    s_mul_i32 s16, s16, 16640
    v_sub_u32 v16, 1008, v3
    v_add_u32 v16, s16, v16
    s_bitcmp1_b32 s24, 0
    s_cbranch_scc1 Lkg_0_39
    s_nop 0
    ds_write_b128 v14, v[80:83]
    ds_write_b128 v14, v[84:87] offset:1024
    s_branch Lkg_0_40
Lkg_0_39:
    s_nop 0
    ds_write_b128 v14, v[72:75]
    ds_write_b128 v14, v[76:79] offset:1024
Lkg_0_40:
    s_cmp_lg_u32 s24, 0
    s_cbranch_scc1 Lkg_0_44
    s_waitcnt vmcnt(0)
    v_cmp_eq_u32 vcc, 0, v110
    s_nop 0
    s_cbranch_vccz Lkg_0_44
Lpo_0_45:
    buffer_load_dword v110, v108, s[8:11], 0 offen sc1
    s_sub_u32 s38, s38, 1
    s_cmp_lt_i32 s38, 0
    s_cbranch_scc1 Lpx_0_46
    s_waitcnt vmcnt(0)
    v_cmp_eq_u32 vcc, 0, v110
    s_nop 0
    s_cbranch_vccz Lpx_0_46
    s_sleep 0
    s_branch Lpo_0_45
Lpx_0_46:
    s_waitcnt vmcnt(0)
Lkg_0_44:
    s_waitcnt lgkmcnt(0)
    s_barrier
    ds_read_b128 v[20:23], v15
    ds_read_b128 v[24:27], v15 offset:1024
    buffer_load_dwordx4 v[92:95], v3, s[8:11], s18 offen offset:0 sc1
    buffer_load_dwordx4 v[96:99], v3, s[8:11], s18 offen offset:1024 sc1
    buffer_load_dwordx4 v[100:103], v3, s[8:11], s18 offen offset:2048 sc1
    buffer_load_dwordx4 v[104:107], v3, s[8:11], s18 offen offset:3072 sc1
Lkg_0_43:
    s_bitcmp1_b32 s24, 0
    s_cbranch_scc1 Lkg_0_41
    v_cmp_eq_u32 vcc, 0, v1
    s_nop 1
    v_cndmask_b32 v47, 0, v47, vcc
    v_add_f32 v72, v72, v47
    v_lshrrev_b32 v5, 2, v1
    v_mul_u32_u24 v5, 4160, v5
    v_and_b32 v6, 3, v1
    v_lshl_add_u32 v5, v6, 4, v5
    v_add_u32 v5, 4096, v5
    v_add_u32 v5, s16, v5
    v_subrev_u32 v6, 16, v1
    v_min_u32 v6, 29, v6
    s_mul_i32 s15, s24, 2312
    s_add_u32 s15, s15, 66560
    v_lshl_add_u32 v6, v6, 4, s15
    v_cmp_gt_u32 vcc, 16, v1
    s_nop 1
    v_cndmask_b32 v5, v6, v5, vcc
    v_mov_b32 v8, 0
    v_mov_b32 v9, 0
    v_mov_b32 v10, 0
    v_mov_b32 v11, 0
    ds_write_b128 v5, v[8:11]
    s_waitcnt lgkmcnt(1)
    v_add_f32 v20, v20, v72
    v_add_f32 v21, v21, v73
    v_add_f32 v22, v22, v74
    v_add_f32 v23, v23, v75
    v_add_f32 v24, v24, v76
    v_add_f32 v25, v25, v77
    v_add_f32 v26, v26, v78
    v_add_f32 v27, v27, v79
    v_cvt_pk_bf16_f32 v28, v27, v26
    v_cvt_pk_bf16_f32 v29, v25, v24
    v_cvt_pk_bf16_f32 v30, v23, v22
    v_cvt_pk_bf16_f32 v31, v21, v20
    ds_write_b128 v16, v[28:31] offset:3072
    s_branch Lkg_0_42
Lkg_0_41:
    v_and_b32 v5, 1, v1
    v_cmp_eq_u32 vcc, 1, v5
    s_waitcnt lgkmcnt(0)
    v_add_f32 v20, v20, v80
    v_add_f32 v21, v21, v81
    v_add_f32 v22, v22, v82
    v_add_f32 v23, v23, v83
    v_add_f32 v24, v24, v84
    v_add_f32 v25, v25, v85
    v_add_f32 v26, v26, v86
    v_add_f32 v27, v27, v87
    v_cndmask_b32 v5, v24, v25, vcc
    v_cndmask_b32 v6, v26, v27, vcc
    v_cvt_pk_bf16_f32 v28, v22, v22
    v_cvt_pk_bf16_f32 v29, v21, v21
    v_cvt_pk_bf16_f32 v30, v21, v20
    v_cvt_pk_bf16_f32 v31, v20, v20
    ds_write_b128 v16, v[28:31] offset:2048
    v_cvt_pk_bf16_f32 v32, v25, v25
    v_cvt_pk_bf16_f32 v33, v25, v5
    v_cvt_pk_bf16_f32 v34, v24, v24
    v_cvt_pk_bf16_f32 v35, v24, v24
    ds_write_b128 v16, v[32:35] offset:1024
    v_cvt_pk_bf16_f32 v36, v27, v27
    v_cvt_pk_bf16_f32 v37, v27, v6
    v_cvt_pk_bf16_f32 v38, v26, v26
    v_cvt_pk_bf16_f32 v39, v26, v26
    ds_write_b128 v16, v[36:39]
Lkg_0_42:
    s_and_b32 s15, s24, 1
    s_lshl_b32 s15, s15, 11
    s_add_u32 s15, s15, s16
    v_add_u32 v16, s15, v3
    s_waitcnt lgkmcnt(0)
    s_barrier
    ds_read_b128 v[20:23], v16 offset:0
    ds_read_b64 v[24:25], v16 offset:16
    ds_read_b128 v[28:31], v16 offset:1024
    ds_read_b64 v[32:33], v16 offset:1040
    s_waitcnt lgkmcnt(2)
    v_alignbit_b32 v40, v21, v20, 16
    v_alignbit_b32 v41, v22, v21, 16
    v_alignbit_b32 v42, v23, v22, 16
    v_alignbit_b32 v43, v24, v23, 16
    v_alignbit_b32 v51, v25, v24, 16
    v_mov_b32 v44, v21
    v_mov_b32 v45, v22
    v_mov_b32 v46, v23
    v_mov_b32 v47, v24
    v_mov_b32 v48, v41
    v_mov_b32 v49, v42
    v_mov_b32 v50, v43
    ds_write_b128 v16, v[40:43] offset:4160
    ds_write_b128 v16, v[44:47] offset:8320
    ds_write_b128 v16, v[48:51] offset:12480
    s_waitcnt lgkmcnt(3)
    v_alignbit_b32 v52, v29, v28, 16
    v_alignbit_b32 v53, v30, v29, 16
    v_alignbit_b32 v54, v31, v30, 16
    v_alignbit_b32 v55, v32, v31, 16
    v_alignbit_b32 v63, v33, v32, 16
    v_mov_b32 v56, v29
    v_mov_b32 v57, v30
    v_mov_b32 v58, v31
    v_mov_b32 v59, v32
    v_mov_b32 v60, v53
    v_mov_b32 v61, v54
    v_mov_b32 v62, v55
    ds_write_b128 v16, v[52:55] offset:5184
    ds_write_b128 v16, v[56:59] offset:9344
    ds_write_b128 v16, v[60:63] offset:13504
    s_and_b32 s13, s24, 3
    s_lshr_b32 s14, s24, 2
    s_mul_i32 s16, s13, 16640
    s_lshl_b32 s15, s39, 2
    s_add_u32 s15, s15, s13
    v_and_b32 v4, 15, v1
    v_lshrrev_b32 v5, 4, v1
    v_sub_u32 v6, 3, v4
    v_and_b32 v6, 3, v6
    v_mul_u32_u24 v6, 4158, v6
    v_lshl_add_u32 v6, v5, 4, v6
    v_lshlrev_b32 v7, 1, v4
    v_sub_u32 v6, v6, v7
    v_add_u32 v6, 30, v6
    v_add_u32 v6, s16, v6
    v_lshlrev_b32 v8, 5, v4
    v_lshl_add_u32 v8, v5, 3, v8
    s_mul_i32 s12, s13, 4624
    s_add_u32 s25, s12, 66560
    v_lshlrev_b32 v12, 5, v4
    v_lshl_add_u32 v12, v5, 4, v12
    v_add_u32 v12, s25, v12
    s_add_u32 s12, s12, 85536
    v_add_u32 v10, s12, v8
    s_mul_i32 s23, s15, 4224
    s_add_u32 s23, s23, 5787776
    s_bfe_u32 s60, s2, 0x20003
    s_mul_i32 s60, s60, 165888
    s_and_b32 s61, s24, 3
    s_mul_i32 s61, s61, 36864
    s_add_u32 s60, s60, s61
    s_cmp_ge_u32 s24, 4
    s_cselect_b32 s61, 663552, 0
    s_add_u32 s60, s60, s61
    s_add_u32 s60, s60, 8224768
    s_add_u32 s61, s60, 0
    buffer_load_dwordx4 v[112:115], v3, s[8:11], s61 offen offset:0 sc1
    buffer_load_dwordx4 v[116:119], v3, s[8:11], s61 offen offset:1024 sc1
    buffer_load_dwordx4 v[120:123], v3, s[8:11], s61 offen offset:2048 sc1
    buffer_load_dwordx4 v[124:127], v3, s[8:11], s61 offen offset:3072 sc1
    s_add_u32 s61, s60, 4096
    buffer_load_dwordx4 v[128:131], v3, s[8:11], s61 offen offset:0 sc1
    buffer_load_dwordx4 v[132:135], v3, s[8:11], s61 offen offset:1024 sc1
    buffer_load_dwordx4 v[136:139], v3, s[8:11], s61 offen offset:2048 sc1
    buffer_load_dwordx4 v[140:143], v3, s[8:11], s61 offen offset:3072 sc1
    s_waitcnt vmcnt(11)
    ds_write_b128 v19, v[92:95] offset:0
    s_waitcnt vmcnt(10)
    ds_write_b128 v19, v[96:99] offset:128
    s_waitcnt vmcnt(9)
    ds_write_b128 v19, v[100:103] offset:256
    s_waitcnt vmcnt(8)
    ds_write_b128 v19, v[104:107] offset:384
    s_waitcnt lgkmcnt(0)
    s_barrier
    s_cmp_lg_u32 s14, 0
    s_cbranch_scc1 Lcb_0_48
    ds_read_b64 v[20:21], v6 offset:4032
    ds_read_b64 v[22:23], v6 offset:4040
    ds_read_b128 v[80:83], v12 offset:4032
    ds_read_b128 v[76:79], v12 offset:3520
    ds_read_b128 v[72:75], v12 offset:3008
    ds_read_b128 v[68:71], v12 offset:2496
    ds_read_b128 v[64:67], v12 offset:1984
    ds_read_b128 v[60:63], v12 offset:1472
    ds_read_b128 v[56:59], v12 offset:960
    ds_read_b128 v[52:55], v12 offset:448
    ds_read_b64 v[24:25], v6 offset:3520
    ds_read_b64 v[26:27], v6 offset:3528
    ds_read_b64 v[28:29], v6 offset:3008
    ds_read_b64 v[30:31], v6 offset:3016
    ds_read_b64 v[32:33], v6 offset:2496
    ds_read_b64 v[34:35], v6 offset:2504
    ds_read_b64 v[36:37], v6 offset:1984
    ds_read_b64 v[38:39], v6 offset:1992
    ds_read_b64 v[40:41], v6 offset:1472
    ds_read_b64 v[42:43], v6 offset:1480
    ds_read_b64 v[44:45], v6 offset:960
    ds_read_b64 v[46:47], v6 offset:968
    ds_read_b64 v[48:49], v6 offset:448
    ds_read_b64 v[50:51], v6 offset:456
    s_waitcnt lgkmcnt(15)
    v_mfma_f32_16x16x32_bf16 v[96:99], v[20:23], v[80:83], 0
    v_mfma_f32_16x16x32_bf16 v[92:95], v[20:23], v[68:71], 0
    v_mfma_f32_16x16x32_bf16 v[88:91], v[20:23], v[64:67], 0
    s_waitcnt lgkmcnt(14)
    v_mfma_f32_16x16x32_bf16 v[84:87], v[20:23], v[52:55], 0
    ds_read_b64 v[20:21], v6 offset:3968
    ds_read_b64 v[22:23], v6 offset:3976
    ds_read_b128 v[80:83], v12 offset:3968
    s_waitcnt lgkmcnt(15)
    v_mfma_f32_16x16x32_bf16 v[96:99], v[24:27], v[76:79], v[96:99]
    v_mfma_f32_16x16x32_bf16 v[92:95], v[24:27], v[64:67], v[92:95]
    v_mfma_f32_16x16x32_bf16 v[88:91], v[24:27], v[60:63], v[88:91]
    ds_read_b64 v[24:25], v6 offset:3456
    ds_read_b64 v[26:27], v6 offset:3464
    ds_read_b128 v[76:79], v12 offset:3456
    s_waitcnt lgkmcnt(15)
    v_mfma_f32_16x16x32_bf16 v[96:99], v[28:31], v[72:75], v[96:99]
    v_mfma_f32_16x16x32_bf16 v[92:95], v[28:31], v[60:63], v[92:95]
    v_mfma_f32_16x16x32_bf16 v[88:91], v[28:31], v[56:59], v[88:91]
    ds_read_b64 v[28:29], v6 offset:2944
    ds_read_b64 v[30:31], v6 offset:2952
    ds_read_b128 v[72:75], v12 offset:2944
    s_waitcnt lgkmcnt(15)
    v_mfma_f32_16x16x32_bf16 v[96:99], v[32:35], v[68:71], v[96:99]
    v_mfma_f32_16x16x32_bf16 v[92:95], v[32:35], v[56:59], v[92:95]
    v_mfma_f32_16x16x32_bf16 v[88:91], v[32:35], v[52:55], v[88:91]
    ds_read_b64 v[32:33], v6 offset:2432
    ds_read_b64 v[34:35], v6 offset:2440
    ds_read_b128 v[68:71], v12 offset:2432
    v_mfma_f32_16x16x32_bf16 v[96:99], v[36:39], v[64:67], v[96:99]
    v_mfma_f32_16x16x32_bf16 v[92:95], v[36:39], v[52:55], v[92:95]
    ds_read_b64 v[36:37], v6 offset:1920
    ds_read_b64 v[38:39], v6 offset:1928
    ds_read_b128 v[64:67], v12 offset:1920
    s_waitcnt lgkmcnt(15)
    v_mfma_f32_16x16x32_bf16 v[96:99], v[40:43], v[60:63], v[96:99]
    ds_read_b64 v[40:41], v6 offset:1408
    ds_read_b64 v[42:43], v6 offset:1416
    ds_read_b128 v[60:63], v12 offset:1408
    v_mfma_f32_16x16x32_bf16 v[96:99], v[44:47], v[56:59], v[96:99]
    ds_read_b64 v[44:45], v6 offset:896
    ds_read_b64 v[46:47], v6 offset:904
    ds_read_b128 v[56:59], v12 offset:896
    v_mfma_f32_16x16x32_bf16 v[96:99], v[48:51], v[52:55], v[96:99]
    ds_read_b64 v[48:49], v6 offset:384
    ds_read_b64 v[50:51], v6 offset:392
    ds_read_b128 v[52:55], v12 offset:384
    s_bfe_u32 s27, s2, 0x20003
    s_mul_i32 s27, s27, 165888
    s_cmp_ge_u32 s24, 4
    s_cselect_b32 s28, 663552, 0
    s_cselect_b32 s29, 18432, 0
    s_add_u32 s27, s27, s28
    s_add_u32 s27, s27, 8372224
    s_and_b32 s28, s24, 3
    s_mul_i32 s28, s28, 5
    s_min_u32 s28, s28, 13
    s_lshl_b32 s28, s28, 10
    s_add_u32 s27, s27, s28
    s_add_u32 s29, s29, s28
    s_add_u32 m0, s29, 126976
    s_nop 0
    buffer_load_dwordx4 v3, s[8:11], s27 offen offset:0 sc1 lds
    buffer_load_dwordx4 v3, s[8:11], s27 offen offset:1024 sc1 lds
    buffer_load_dwordx4 v3, s[8:11], s27 offen offset:2048 sc1 lds
    buffer_load_dwordx4 v3, s[8:11], s27 offen offset:3072 sc1 lds
    s_add_u32 m0, s29, 131072
    s_add_u32 s27, s27, 4096
    buffer_load_dwordx4 v3, s[8:11], s27 offen offset:0 sc1 lds
    s_waitcnt lgkmcnt(15)
    v_mfma_f32_16x16x32_bf16 v[96:99], v[20:23], v[80:83], v[96:99]
    s_waitcnt lgkmcnt(12)
    v_mfma_f32_16x16x32_bf16 v[92:95], v[20:23], v[68:71], v[92:95]
    s_waitcnt lgkmcnt(9)
    v_mfma_f32_16x16x32_bf16 v[88:91], v[20:23], v[64:67], v[88:91]
    s_waitcnt lgkmcnt(0)
    v_mfma_f32_16x16x32_bf16 v[84:87], v[20:23], v[52:55], v[84:87]
    ds_read_b64 v[20:21], v6 offset:3904
    ds_read_b64 v[22:23], v6 offset:3912
    ds_read_b128 v[80:83], v12 offset:3904
    v_mfma_f32_16x16x32_bf16 v[96:99], v[24:27], v[76:79], v[96:99]
    v_mfma_f32_16x16x32_bf16 v[92:95], v[24:27], v[64:67], v[92:95]
    v_mfma_f32_16x16x32_bf16 v[88:91], v[24:27], v[60:63], v[88:91]
    ds_read_b64 v[24:25], v6 offset:3392
    ds_read_b64 v[26:27], v6 offset:3400
    ds_read_b128 v[76:79], v12 offset:3392
    v_mfma_f32_16x16x32_bf16 v[96:99], v[28:31], v[72:75], v[96:99]
    v_mfma_f32_16x16x32_bf16 v[92:95], v[28:31], v[60:63], v[92:95]
    v_mfma_f32_16x16x32_bf16 v[88:91], v[28:31], v[56:59], v[88:91]
    ds_read_b64 v[28:29], v6 offset:2880
    ds_read_b64 v[30:31], v6 offset:2888
    ds_read_b128 v[72:75], v12 offset:2880
    v_mfma_f32_16x16x32_bf16 v[96:99], v[32:35], v[68:71], v[96:99]
    v_mfma_f32_16x16x32_bf16 v[92:95], v[32:35], v[56:59], v[92:95]
    v_mfma_f32_16x16x32_bf16 v[88:91], v[32:35], v[52:55], v[88:91]
    ds_read_b64 v[32:33], v6 offset:2368
    ds_read_b64 v[34:35], v6 offset:2376
    ds_read_b128 v[68:71], v12 offset:2368
    v_mfma_f32_16x16x32_bf16 v[96:99], v[36:39], v[64:67], v[96:99]
    v_mfma_f32_16x16x32_bf16 v[92:95], v[36:39], v[52:55], v[92:95]
    ds_read_b64 v[36:37], v6 offset:1856
    ds_read_b64 v[38:39], v6 offset:1864
    ds_read_b128 v[64:67], v12 offset:1856
    v_mfma_f32_16x16x32_bf16 v[96:99], v[40:43], v[60:63], v[96:99]
    ds_read_b64 v[40:41], v6 offset:1344
    ds_read_b64 v[42:43], v6 offset:1352
    ds_read_b128 v[60:63], v12 offset:1344
    v_mfma_f32_16x16x32_bf16 v[96:99], v[44:47], v[56:59], v[96:99]
    ds_read_b64 v[44:45], v6 offset:832
    ds_read_b64 v[46:47], v6 offset:840
    ds_read_b128 v[56:59], v12 offset:832
    v_mfma_f32_16x16x32_bf16 v[96:99], v[48:51], v[52:55], v[96:99]
    ds_read_b64 v[48:49], v6 offset:320
    ds_read_b64 v[50:51], v6 offset:328
    ds_read_b128 v[52:55], v12 offset:320
    s_bfe_u32 s60, s2, 0x20003
    s_mul_i32 s60, s60, 165888
    s_and_b32 s61, s24, 3
    s_mul_i32 s61, s61, 36864
    s_add_u32 s60, s60, s61
    s_cmp_ge_u32 s24, 4
    s_cselect_b32 s61, 663552, 0
    s_add_u32 s60, s60, s61
    s_add_u32 s60, s60, 8224768
    s_add_u32 s61, s60, 8192
    buffer_load_dwordx4 v[144:147], v3, s[8:11], s61 offen offset:0 sc1
    buffer_load_dwordx4 v[148:151], v3, s[8:11], s61 offen offset:1024 sc1
    buffer_load_dwordx4 v[152:155], v3, s[8:11], s61 offen offset:2048 sc1
    buffer_load_dwordx4 v[156:159], v3, s[8:11], s61 offen offset:3072 sc1
    s_add_u32 s61, s60, 12288
    buffer_load_dwordx4 v[160:163], v3, s[8:11], s61 offen offset:0 sc1
    s_waitcnt lgkmcnt(15)
    v_mfma_f32_16x16x32_bf16 v[96:99], v[20:23], v[80:83], v[96:99]
    s_waitcnt lgkmcnt(12)
    v_mfma_f32_16x16x32_bf16 v[92:95], v[20:23], v[68:71], v[92:95]
    s_waitcnt lgkmcnt(9)
    v_mfma_f32_16x16x32_bf16 v[88:91], v[20:23], v[64:67], v[88:91]
    s_waitcnt lgkmcnt(0)
    v_mfma_f32_16x16x32_bf16 v[84:87], v[20:23], v[52:55], v[84:87]
    ds_read_b64 v[20:21], v6 offset:3840
    ds_read_b64 v[22:23], v6 offset:3848
    ds_read_b128 v[80:83], v12 offset:3840
    v_mfma_f32_16x16x32_bf16 v[96:99], v[24:27], v[76:79], v[96:99]
    v_mfma_f32_16x16x32_bf16 v[92:95], v[24:27], v[64:67], v[92:95]
    v_mfma_f32_16x16x32_bf16 v[88:91], v[24:27], v[60:63], v[88:91]
    ds_read_b64 v[24:25], v6 offset:3328
    ds_read_b64 v[26:27], v6 offset:3336
    ds_read_b128 v[76:79], v12 offset:3328
    v_mfma_f32_16x16x32_bf16 v[96:99], v[28:31], v[72:75], v[96:99]
    v_mfma_f32_16x16x32_bf16 v[92:95], v[28:31], v[60:63], v[92:95]
    v_mfma_f32_16x16x32_bf16 v[88:91], v[28:31], v[56:59], v[88:91]
    ds_read_b64 v[28:29], v6 offset:2816
    ds_read_b64 v[30:31], v6 offset:2824
    ds_read_b128 v[72:75], v12 offset:2816
    v_mfma_f32_16x16x32_bf16 v[96:99], v[32:35], v[68:71], v[96:99]
    v_mfma_f32_16x16x32_bf16 v[92:95], v[32:35], v[56:59], v[92:95]
    v_mfma_f32_16x16x32_bf16 v[88:91], v[32:35], v[52:55], v[88:91]
    ds_read_b64 v[32:33], v6 offset:2304
    ds_read_b64 v[34:35], v6 offset:2312
    ds_read_b128 v[68:71], v12 offset:2304
    v_mfma_f32_16x16x32_bf16 v[96:99], v[36:39], v[64:67], v[96:99]
    v_mfma_f32_16x16x32_bf16 v[92:95], v[36:39], v[52:55], v[92:95]
    ds_read_b64 v[36:37], v6 offset:1792
    ds_read_b64 v[38:39], v6 offset:1800
    ds_read_b128 v[64:67], v12 offset:1792
    v_mfma_f32_16x16x32_bf16 v[96:99], v[40:43], v[60:63], v[96:99]
    ds_read_b64 v[40:41], v6 offset:1280
    ds_read_b64 v[42:43], v6 offset:1288
    ds_read_b128 v[60:63], v12 offset:1280
    v_mfma_f32_16x16x32_bf16 v[96:99], v[44:47], v[56:59], v[96:99]
    ds_read_b64 v[44:45], v6 offset:768
    ds_read_b64 v[46:47], v6 offset:776
    ds_read_b128 v[56:59], v12 offset:768
    v_mfma_f32_16x16x32_bf16 v[96:99], v[48:51], v[52:55], v[96:99]
    ds_read_b64 v[48:49], v6 offset:256
    ds_read_b64 v[50:51], v6 offset:264
    ds_read_b128 v[52:55], v12 offset:256
    buffer_load_dwordx4 v[164:167], v3, s[8:11], s61 offen offset:1024 sc1
    buffer_load_dwordx4 v[168:171], v3, s[8:11], s61 offen offset:2048 sc1
    buffer_load_dwordx4 v[172:175], v3, s[8:11], s61 offen offset:3072 sc1
    s_add_u32 s61, s60, 16384
    buffer_load_dwordx4 v[176:179], v3, s[8:11], s61 offen offset:0 sc1
    buffer_load_dwordx4 v[180:183], v3, s[8:11], s61 offen offset:1024 sc1
    s_waitcnt lgkmcnt(15)
    v_mfma_f32_16x16x32_bf16 v[96:99], v[20:23], v[80:83], v[96:99]
    s_waitcnt lgkmcnt(12)
    v_mfma_f32_16x16x32_bf16 v[92:95], v[20:23], v[68:71], v[92:95]
    s_waitcnt lgkmcnt(9)
    v_mfma_f32_16x16x32_bf16 v[88:91], v[20:23], v[64:67], v[88:91]
    s_waitcnt lgkmcnt(0)
    v_mfma_f32_16x16x32_bf16 v[84:87], v[20:23], v[52:55], v[84:87]
    ds_read_b64 v[20:21], v6 offset:3776
    ds_read_b64 v[22:23], v6 offset:3784
    ds_read_b128 v[80:83], v12 offset:3776
    v_mfma_f32_16x16x32_bf16 v[96:99], v[24:27], v[76:79], v[96:99]
    v_mfma_f32_16x16x32_bf16 v[92:95], v[24:27], v[64:67], v[92:95]
    v_mfma_f32_16x16x32_bf16 v[88:91], v[24:27], v[60:63], v[88:91]
    ds_read_b64 v[24:25], v6 offset:3264
    ds_read_b64 v[26:27], v6 offset:3272
    ds_read_b128 v[76:79], v12 offset:3264
    v_mfma_f32_16x16x32_bf16 v[96:99], v[28:31], v[72:75], v[96:99]
    v_mfma_f32_16x16x32_bf16 v[92:95], v[28:31], v[60:63], v[92:95]
    v_mfma_f32_16x16x32_bf16 v[88:91], v[28:31], v[56:59], v[88:91]
    ds_read_b64 v[28:29], v6 offset:2752
    ds_read_b64 v[30:31], v6 offset:2760
    ds_read_b128 v[72:75], v12 offset:2752
    v_mfma_f32_16x16x32_bf16 v[96:99], v[32:35], v[68:71], v[96:99]
    v_mfma_f32_16x16x32_bf16 v[92:95], v[32:35], v[56:59], v[92:95]
    v_mfma_f32_16x16x32_bf16 v[88:91], v[32:35], v[52:55], v[88:91]
    ds_read_b64 v[32:33], v6 offset:2240
    ds_read_b64 v[34:35], v6 offset:2248
    ds_read_b128 v[68:71], v12 offset:2240
    v_mfma_f32_16x16x32_bf16 v[96:99], v[36:39], v[64:67], v[96:99]
    v_mfma_f32_16x16x32_bf16 v[92:95], v[36:39], v[52:55], v[92:95]
    ds_read_b64 v[36:37], v6 offset:1728
    ds_read_b64 v[38:39], v6 offset:1736
    ds_read_b128 v[64:67], v12 offset:1728
    v_mfma_f32_16x16x32_bf16 v[96:99], v[40:43], v[60:63], v[96:99]
    ds_read_b64 v[40:41], v6 offset:1216
    ds_read_b64 v[42:43], v6 offset:1224
    ds_read_b128 v[60:63], v12 offset:1216
    v_mfma_f32_16x16x32_bf16 v[96:99], v[44:47], v[56:59], v[96:99]
    ds_read_b64 v[44:45], v6 offset:704
    ds_read_b64 v[46:47], v6 offset:712
    ds_read_b128 v[56:59], v12 offset:704
    v_mfma_f32_16x16x32_bf16 v[96:99], v[48:51], v[52:55], v[96:99]
    ds_read_b64 v[48:49], v6 offset:192
    ds_read_b64 v[50:51], v6 offset:200
    ds_read_b128 v[52:55], v12 offset:192
    buffer_load_dwordx4 v[184:187], v3, s[8:11], s61 offen offset:2048 sc1
    buffer_load_dwordx4 v[188:191], v3, s[8:11], s61 offen offset:3072 sc1
    s_add_u32 s61, s60, 20480
    buffer_load_dwordx4 v[192:195], v3, s[8:11], s61 offen offset:0 sc1
    buffer_load_dwordx4 v[196:199], v3, s[8:11], s61 offen offset:1024 sc1
    buffer_load_dwordx4 v[200:203], v3, s[8:11], s61 offen offset:2048 sc1
    s_waitcnt lgkmcnt(15)
    v_mfma_f32_16x16x32_bf16 v[96:99], v[20:23], v[80:83], v[96:99]
    s_waitcnt lgkmcnt(12)
    v_mfma_f32_16x16x32_bf16 v[92:95], v[20:23], v[68:71], v[92:95]
    s_waitcnt lgkmcnt(9)
    v_mfma_f32_16x16x32_bf16 v[88:91], v[20:23], v[64:67], v[88:91]
    s_waitcnt lgkmcnt(0)
    v_mfma_f32_16x16x32_bf16 v[84:87], v[20:23], v[52:55], v[84:87]
    ds_read_b64 v[20:21], v6 offset:3712
    ds_read_b64 v[22:23], v6 offset:3720
    ds_read_b128 v[80:83], v12 offset:3712
    v_mfma_f32_16x16x32_bf16 v[96:99], v[24:27], v[76:79], v[96:99]
    v_mfma_f32_16x16x32_bf16 v[92:95], v[24:27], v[64:67], v[92:95]
    v_mfma_f32_16x16x32_bf16 v[88:91], v[24:27], v[60:63], v[88:91]
    ds_read_b64 v[24:25], v6 offset:3200
    ds_read_b64 v[26:27], v6 offset:3208
    ds_read_b128 v[76:79], v12 offset:3200
    v_mfma_f32_16x16x32_bf16 v[96:99], v[28:31], v[72:75], v[96:99]
    v_mfma_f32_16x16x32_bf16 v[92:95], v[28:31], v[60:63], v[92:95]
    v_mfma_f32_16x16x32_bf16 v[88:91], v[28:31], v[56:59], v[88:91]
    ds_read_b64 v[28:29], v6 offset:2688
    ds_read_b64 v[30:31], v6 offset:2696
    ds_read_b128 v[72:75], v12 offset:2688
    v_mfma_f32_16x16x32_bf16 v[96:99], v[32:35], v[68:71], v[96:99]
    v_mfma_f32_16x16x32_bf16 v[92:95], v[32:35], v[56:59], v[92:95]
    v_mfma_f32_16x16x32_bf16 v[88:91], v[32:35], v[52:55], v[88:91]
    ds_read_b64 v[32:33], v6 offset:2176
    ds_read_b64 v[34:35], v6 offset:2184
    ds_read_b128 v[68:71], v12 offset:2176
    v_mfma_f32_16x16x32_bf16 v[96:99], v[36:39], v[64:67], v[96:99]
    v_mfma_f32_16x16x32_bf16 v[92:95], v[36:39], v[52:55], v[92:95]
    ds_read_b64 v[36:37], v6 offset:1664
    ds_read_b64 v[38:39], v6 offset:1672
    ds_read_b128 v[64:67], v12 offset:1664
    v_mfma_f32_16x16x32_bf16 v[96:99], v[40:43], v[60:63], v[96:99]
    ds_read_b64 v[40:41], v6 offset:1152
    ds_read_b64 v[42:43], v6 offset:1160
    ds_read_b128 v[60:63], v12 offset:1152
    v_mfma_f32_16x16x32_bf16 v[96:99], v[44:47], v[56:59], v[96:99]
    ds_read_b64 v[44:45], v6 offset:640
    ds_read_b64 v[46:47], v6 offset:648
    ds_read_b128 v[56:59], v12 offset:640
    v_mfma_f32_16x16x32_bf16 v[96:99], v[48:51], v[52:55], v[96:99]
    ds_read_b64 v[48:49], v6 offset:128
    ds_read_b64 v[50:51], v6 offset:136
    ds_read_b128 v[52:55], v12 offset:128
    buffer_load_dwordx4 v[204:207], v3, s[8:11], s61 offen offset:3072 sc1
    s_add_u32 s61, s60, 24576
    buffer_load_dwordx4 v[208:211], v3, s[8:11], s61 offen offset:0 sc1
    buffer_load_dwordx4 v[212:215], v3, s[8:11], s61 offen offset:1024 sc1
    buffer_load_dwordx4 v[216:219], v3, s[8:11], s61 offen offset:2048 sc1
    buffer_load_dwordx4 v[220:223], v3, s[8:11], s61 offen offset:3072 sc1
    s_waitcnt lgkmcnt(15)
    v_mfma_f32_16x16x32_bf16 v[96:99], v[20:23], v[80:83], v[96:99]
    s_waitcnt lgkmcnt(12)
    v_mfma_f32_16x16x32_bf16 v[92:95], v[20:23], v[68:71], v[92:95]
    s_waitcnt lgkmcnt(9)
    v_mfma_f32_16x16x32_bf16 v[88:91], v[20:23], v[64:67], v[88:91]
    s_waitcnt lgkmcnt(0)
    v_mfma_f32_16x16x32_bf16 v[84:87], v[20:23], v[52:55], v[84:87]
    ds_read_b64 v[20:21], v6 offset:3648
    ds_read_b64 v[22:23], v6 offset:3656
    ds_read_b128 v[80:83], v12 offset:3648
    v_mfma_f32_16x16x32_bf16 v[96:99], v[24:27], v[76:79], v[96:99]
    v_mfma_f32_16x16x32_bf16 v[92:95], v[24:27], v[64:67], v[92:95]
    v_mfma_f32_16x16x32_bf16 v[88:91], v[24:27], v[60:63], v[88:91]
    ds_read_b64 v[24:25], v6 offset:3136
    ds_read_b64 v[26:27], v6 offset:3144
    ds_read_b128 v[76:79], v12 offset:3136
    v_mfma_f32_16x16x32_bf16 v[96:99], v[28:31], v[72:75], v[96:99]
    v_mfma_f32_16x16x32_bf16 v[92:95], v[28:31], v[60:63], v[92:95]
    v_mfma_f32_16x16x32_bf16 v[88:91], v[28:31], v[56:59], v[88:91]
    ds_read_b64 v[28:29], v6 offset:2624
    ds_read_b64 v[30:31], v6 offset:2632
    ds_read_b128 v[72:75], v12 offset:2624
    v_mfma_f32_16x16x32_bf16 v[96:99], v[32:35], v[68:71], v[96:99]
    v_mfma_f32_16x16x32_bf16 v[92:95], v[32:35], v[56:59], v[92:95]
    v_mfma_f32_16x16x32_bf16 v[88:91], v[32:35], v[52:55], v[88:91]
    ds_read_b64 v[32:33], v6 offset:2112
    ds_read_b64 v[34:35], v6 offset:2120
    ds_read_b128 v[68:71], v12 offset:2112
    v_mfma_f32_16x16x32_bf16 v[96:99], v[36:39], v[64:67], v[96:99]
    v_mfma_f32_16x16x32_bf16 v[92:95], v[36:39], v[52:55], v[92:95]
    ds_read_b64 v[36:37], v6 offset:1600
    ds_read_b64 v[38:39], v6 offset:1608
    ds_read_b128 v[64:67], v12 offset:1600
    v_mfma_f32_16x16x32_bf16 v[96:99], v[40:43], v[60:63], v[96:99]
    ds_read_b64 v[40:41], v6 offset:1088
    ds_read_b64 v[42:43], v6 offset:1096
    ds_read_b128 v[60:63], v12 offset:1088
    v_mfma_f32_16x16x32_bf16 v[96:99], v[44:47], v[56:59], v[96:99]
    ds_read_b64 v[44:45], v6 offset:576
    ds_read_b64 v[46:47], v6 offset:584
    ds_read_b128 v[56:59], v12 offset:576
    v_mfma_f32_16x16x32_bf16 v[96:99], v[48:51], v[52:55], v[96:99]
    ds_read_b64 v[48:49], v6 offset:64
    ds_read_b64 v[50:51], v6 offset:72
    ds_read_b128 v[52:55], v12 offset:64
    s_add_u32 s61, s60, 28672
    buffer_load_dwordx4 v[224:227], v3, s[8:11], s61 offen offset:0 sc1
    buffer_load_dwordx4 v[228:231], v3, s[8:11], s61 offen offset:1024 sc1
    buffer_load_dwordx4 v[232:235], v3, s[8:11], s61 offen offset:2048 sc1
    buffer_load_dwordx4 v[236:239], v3, s[8:11], s61 offen offset:3072 sc1
    s_add_u32 s61, s60, 32768
    buffer_load_dwordx4 v[240:243], v3, s[8:11], s61 offen offset:0 sc1
    s_waitcnt lgkmcnt(15)
    v_mfma_f32_16x16x32_bf16 v[96:99], v[20:23], v[80:83], v[96:99]
    s_waitcnt lgkmcnt(12)
    v_mfma_f32_16x16x32_bf16 v[92:95], v[20:23], v[68:71], v[92:95]
    s_waitcnt lgkmcnt(9)
    v_mfma_f32_16x16x32_bf16 v[88:91], v[20:23], v[64:67], v[88:91]
    s_waitcnt lgkmcnt(0)
    v_mfma_f32_16x16x32_bf16 v[84:87], v[20:23], v[52:55], v[84:87]
    ds_read_b64 v[20:21], v6 offset:3584
    ds_read_b64 v[22:23], v6 offset:3592
    ds_read_b128 v[80:83], v12 offset:3584
    v_mfma_f32_16x16x32_bf16 v[96:99], v[24:27], v[76:79], v[96:99]
    v_mfma_f32_16x16x32_bf16 v[92:95], v[24:27], v[64:67], v[92:95]
    v_mfma_f32_16x16x32_bf16 v[88:91], v[24:27], v[60:63], v[88:91]
    ds_read_b64 v[24:25], v6 offset:3072
    ds_read_b64 v[26:27], v6 offset:3080
    ds_read_b128 v[76:79], v12 offset:3072
    v_mfma_f32_16x16x32_bf16 v[96:99], v[28:31], v[72:75], v[96:99]
    v_mfma_f32_16x16x32_bf16 v[92:95], v[28:31], v[60:63], v[92:95]
    v_mfma_f32_16x16x32_bf16 v[88:91], v[28:31], v[56:59], v[88:91]
    ds_read_b64 v[28:29], v6 offset:2560
    ds_read_b64 v[30:31], v6 offset:2568
    ds_read_b128 v[72:75], v12 offset:2560
    v_mfma_f32_16x16x32_bf16 v[96:99], v[32:35], v[68:71], v[96:99]
    v_mfma_f32_16x16x32_bf16 v[92:95], v[32:35], v[56:59], v[92:95]
    v_mfma_f32_16x16x32_bf16 v[88:91], v[32:35], v[52:55], v[88:91]
    ds_read_b64 v[32:33], v6 offset:2048
    ds_read_b64 v[34:35], v6 offset:2056
    ds_read_b128 v[68:71], v12 offset:2048
    v_mfma_f32_16x16x32_bf16 v[96:99], v[36:39], v[64:67], v[96:99]
    v_mfma_f32_16x16x32_bf16 v[92:95], v[36:39], v[52:55], v[92:95]
    ds_read_b64 v[36:37], v6 offset:1536
    ds_read_b64 v[38:39], v6 offset:1544
    ds_read_b128 v[64:67], v12 offset:1536
    v_mfma_f32_16x16x32_bf16 v[96:99], v[40:43], v[60:63], v[96:99]
    ds_read_b64 v[40:41], v6 offset:1024
    ds_read_b64 v[42:43], v6 offset:1032
    ds_read_b128 v[60:63], v12 offset:1024
    v_mfma_f32_16x16x32_bf16 v[96:99], v[44:47], v[56:59], v[96:99]
    ds_read_b64 v[44:45], v6 offset:512
    ds_read_b64 v[46:47], v6 offset:520
    ds_read_b128 v[56:59], v12 offset:512
    v_mfma_f32_16x16x32_bf16 v[96:99], v[48:51], v[52:55], v[96:99]
    ds_read_b64 v[48:49], v6 offset:0
    ds_read_b64 v[50:51], v6 offset:8
    ds_read_b128 v[52:55], v12 offset:0
    buffer_load_dwordx4 v[244:247], v3, s[8:11], s61 offen offset:1024 sc1
    buffer_load_dwordx4 v[248:251], v3, s[8:11], s61 offen offset:2048 sc1
    buffer_load_dwordx4 v[252:255], v3, s[8:11], s61 offen offset:3072 sc1
    s_waitcnt lgkmcnt(15)
    v_mfma_f32_16x16x32_bf16 v[96:99], v[20:23], v[80:83], v[96:99]
    s_waitcnt lgkmcnt(12)
    v_mfma_f32_16x16x32_bf16 v[92:95], v[20:23], v[68:71], v[92:95]
    s_waitcnt lgkmcnt(9)
    v_mfma_f32_16x16x32_bf16 v[88:91], v[20:23], v[64:67], v[88:91]
    s_waitcnt lgkmcnt(0)
    v_mfma_f32_16x16x32_bf16 v[84:87], v[20:23], v[52:55], v[84:87]
    ds_read_b64 v[100:101], v10 offset:0
    v_mfma_f32_16x16x32_bf16 v[96:99], v[24:27], v[76:79], v[96:99]
    v_mfma_f32_16x16x32_bf16 v[92:95], v[24:27], v[64:67], v[92:95]
    v_mfma_f32_16x16x32_bf16 v[88:91], v[24:27], v[60:63], v[88:91]
    ds_read_b64 v[102:103], v10 offset:1536
    v_mfma_f32_16x16x32_bf16 v[96:99], v[28:31], v[72:75], v[96:99]
    v_mfma_f32_16x16x32_bf16 v[92:95], v[28:31], v[60:63], v[92:95]
    v_mfma_f32_16x16x32_bf16 v[88:91], v[28:31], v[56:59], v[88:91]
    ds_read_b64 v[104:105], v10 offset:2048
    v_mfma_f32_16x16x32_bf16 v[96:99], v[32:35], v[68:71], v[96:99]
    v_mfma_f32_16x16x32_bf16 v[92:95], v[32:35], v[56:59], v[92:95]
    v_mfma_f32_16x16x32_bf16 v[88:91], v[32:35], v[52:55], v[88:91]
    ds_read_b64 v[106:107], v10 offset:3584
    v_mfma_f32_16x16x32_bf16 v[96:99], v[36:39], v[64:67], v[96:99]
    v_mfma_f32_16x16x32_bf16 v[92:95], v[36:39], v[52:55], v[92:95]
    v_mfma_f32_16x16x32_bf16 v[96:99], v[40:43], v[60:63], v[96:99]
    v_mfma_f32_16x16x32_bf16 v[96:99], v[44:47], v[56:59], v[96:99]
    v_mfma_f32_16x16x32_bf16 v[96:99], v[48:51], v[52:55], v[96:99]
    s_mov_b32 s20, 0x00003f80
    s_mov_b32 s21, 0x3f800000
    s_waitcnt lgkmcnt(0)
    v_dot2_f32_bf16 v84, v100, s20, v84
    v_dot2_f32_bf16 v85, v100, s21, v85
    v_dot2_f32_bf16 v86, v101, s20, v86
    v_dot2_f32_bf16 v87, v101, s21, v87
    v_dot2_f32_bf16 v88, v102, s20, v88
    v_dot2_f32_bf16 v89, v102, s21, v89
    v_dot2_f32_bf16 v90, v103, s20, v90
    v_dot2_f32_bf16 v91, v103, s21, v91
    v_dot2_f32_bf16 v92, v104, s20, v92
    v_dot2_f32_bf16 v93, v104, s21, v93
    v_dot2_f32_bf16 v94, v105, s20, v94
    v_dot2_f32_bf16 v95, v105, s21, v95
    v_dot2_f32_bf16 v96, v106, s20, v96
    v_dot2_f32_bf16 v97, v106, s21, v97
    v_dot2_f32_bf16 v98, v107, s20, v98
    v_dot2_f32_bf16 v99, v107, s21, v99
    v_cvt_pk_bf16_f32 v100, v84, v85
    v_cvt_pk_bf16_f32 v101, v86, v87
    buffer_store_dwordx2 v[100:101], v8, s[8:11], s23 offen offset:0 sc1
    v_cvt_pk_bf16_f32 v102, v88, v89
    v_cvt_pk_bf16_f32 v103, v90, v91
    buffer_store_dwordx2 v[102:103], v8, s[8:11], s23 offen offset:1536 sc1
    v_cvt_pk_bf16_f32 v104, v92, v93
    v_cvt_pk_bf16_f32 v105, v94, v95
    buffer_store_dwordx2 v[104:105], v8, s[8:11], s23 offen offset:2048 sc1
    v_cvt_pk_bf16_f32 v106, v96, v97
    v_cvt_pk_bf16_f32 v107, v98, v99
    buffer_store_dwordx2 v[106:107], v8, s[8:11], s23 offen offset:3584 sc1
    s_branch Lcj_0_49
Lcb_0_48:
    ds_read_b64 v[20:21], v6 offset:4032
    ds_read_b64 v[22:23], v6 offset:4040
    ds_read_b128 v[76:79], v12 offset:3520
    ds_read_b128 v[72:75], v12 offset:3008
    ds_read_b128 v[68:71], v12 offset:2496
    ds_read_b128 v[64:67], v12 offset:1984
    ds_read_b128 v[60:63], v12 offset:1472
    ds_read_b128 v[56:59], v12 offset:960
    ds_read_b128 v[52:55], v12 offset:448
    ds_read_b64 v[24:25], v6 offset:3520
    ds_read_b64 v[26:27], v6 offset:3528
    ds_read_b64 v[28:29], v6 offset:3008
    ds_read_b64 v[30:31], v6 offset:3016
    ds_read_b64 v[32:33], v6 offset:2496
    ds_read_b64 v[34:35], v6 offset:2504
    ds_read_b64 v[36:37], v6 offset:1984
    ds_read_b64 v[38:39], v6 offset:1992
    ds_read_b64 v[40:41], v6 offset:1472
    ds_read_b64 v[42:43], v6 offset:1480
    ds_read_b64 v[44:45], v6 offset:960
    ds_read_b64 v[46:47], v6 offset:968
    s_waitcnt lgkmcnt(15)
    v_mfma_f32_16x16x32_bf16 v[96:99], v[20:23], v[76:79], 0
    v_mfma_f32_16x16x32_bf16 v[92:95], v[20:23], v[72:75], 0
    s_waitcnt lgkmcnt(14)
    v_mfma_f32_16x16x32_bf16 v[88:91], v[20:23], v[60:63], 0
    s_waitcnt lgkmcnt(13)
    v_mfma_f32_16x16x32_bf16 v[84:87], v[20:23], v[56:59], 0
    ds_read_b64 v[20:21], v6 offset:3968
    ds_read_b64 v[22:23], v6 offset:3976
    ds_read_b128 v[76:79], v12 offset:3456
    s_waitcnt lgkmcnt(13)
    v_mfma_f32_16x16x32_bf16 v[96:99], v[24:27], v[72:75], v[96:99]
    v_mfma_f32_16x16x32_bf16 v[92:95], v[24:27], v[68:71], v[92:95]
    v_mfma_f32_16x16x32_bf16 v[88:91], v[24:27], v[56:59], v[88:91]
    v_mfma_f32_16x16x32_bf16 v[84:87], v[24:27], v[52:55], v[84:87]
    ds_read_b64 v[24:25], v6 offset:3456
    ds_read_b64 v[26:27], v6 offset:3464
    ds_read_b128 v[72:75], v12 offset:2944
    s_waitcnt lgkmcnt(14)
    v_mfma_f32_16x16x32_bf16 v[96:99], v[28:31], v[68:71], v[96:99]
    v_mfma_f32_16x16x32_bf16 v[92:95], v[28:31], v[64:67], v[92:95]
    v_mfma_f32_16x16x32_bf16 v[88:91], v[28:31], v[52:55], v[88:91]
    ds_read_b64 v[28:29], v6 offset:2944
    ds_read_b64 v[30:31], v6 offset:2952
    ds_read_b128 v[68:71], v12 offset:2432
    s_waitcnt lgkmcnt(15)
    v_mfma_f32_16x16x32_bf16 v[96:99], v[32:35], v[64:67], v[96:99]
    v_mfma_f32_16x16x32_bf16 v[92:95], v[32:35], v[60:63], v[92:95]
    ds_read_b64 v[32:33], v6 offset:2432
    ds_read_b64 v[34:35], v6 offset:2440
    ds_read_b128 v[64:67], v12 offset:1920
    s_waitcnt lgkmcnt(15)
    v_mfma_f32_16x16x32_bf16 v[96:99], v[36:39], v[60:63], v[96:99]
    v_mfma_f32_16x16x32_bf16 v[92:95], v[36:39], v[56:59], v[92:95]
    ds_read_b64 v[36:37], v6 offset:1920
    ds_read_b64 v[38:39], v6 offset:1928
    ds_read_b128 v[60:63], v12 offset:1408
    s_waitcnt lgkmcnt(15)
    v_mfma_f32_16x16x32_bf16 v[96:99], v[40:43], v[56:59], v[96:99]
    v_mfma_f32_16x16x32_bf16 v[92:95], v[40:43], v[52:55], v[92:95]
    ds_read_b64 v[40:41], v6 offset:1408
    ds_read_b64 v[42:43], v6 offset:1416
    ds_read_b128 v[56:59], v12 offset:896
    v_mfma_f32_16x16x32_bf16 v[96:99], v[44:47], v[52:55], v[96:99]
    ds_read_b64 v[44:45], v6 offset:896
    ds_read_b64 v[46:47], v6 offset:904
    ds_read_b128 v[52:55], v12 offset:384
    s_bfe_u32 s27, s2, 0x20003
    s_mul_i32 s27, s27, 165888
    s_cmp_ge_u32 s24, 4
    s_cselect_b32 s28, 663552, 0
    s_cselect_b32 s29, 18432, 0
    s_add_u32 s27, s27, s28
    s_add_u32 s27, s27, 8372224
    s_and_b32 s28, s24, 3
    s_mul_i32 s28, s28, 5
    s_min_u32 s28, s28, 13
    s_lshl_b32 s28, s28, 10
    s_add_u32 s27, s27, s28
    s_add_u32 s29, s29, s28
    s_add_u32 m0, s29, 126976
    s_nop 0
    buffer_load_dwordx4 v3, s[8:11], s27 offen offset:0 sc1 lds
    buffer_load_dwordx4 v3, s[8:11], s27 offen offset:1024 sc1 lds
    s_waitcnt lgkmcnt(15)
    v_mfma_f32_16x16x32_bf16 v[96:99], v[20:23], v[76:79], v[96:99]
    v_mfma_f32_16x16x32_bf16 v[92:95], v[20:23], v[72:75], v[92:95]
    s_waitcnt lgkmcnt(6)
    v_mfma_f32_16x16x32_bf16 v[88:91], v[20:23], v[60:63], v[88:91]
    s_waitcnt lgkmcnt(3)
    v_mfma_f32_16x16x32_bf16 v[84:87], v[20:23], v[56:59], v[84:87]
    ds_read_b64 v[20:21], v6 offset:3904
    ds_read_b64 v[22:23], v6 offset:3912
    ds_read_b128 v[76:79], v12 offset:3392
    v_mfma_f32_16x16x32_bf16 v[96:99], v[24:27], v[72:75], v[96:99]
    v_mfma_f32_16x16x32_bf16 v[92:95], v[24:27], v[68:71], v[92:95]
    v_mfma_f32_16x16x32_bf16 v[88:91], v[24:27], v[56:59], v[88:91]
    s_waitcnt lgkmcnt(3)
    v_mfma_f32_16x16x32_bf16 v[84:87], v[24:27], v[52:55], v[84:87]
    ds_read_b64 v[24:25], v6 offset:3392
    ds_read_b64 v[26:27], v6 offset:3400
    ds_read_b128 v[72:75], v12 offset:2880
    v_mfma_f32_16x16x32_bf16 v[96:99], v[28:31], v[68:71], v[96:99]
    v_mfma_f32_16x16x32_bf16 v[92:95], v[28:31], v[64:67], v[92:95]
    v_mfma_f32_16x16x32_bf16 v[88:91], v[28:31], v[52:55], v[88:91]
    ds_read_b64 v[28:29], v6 offset:2880
    ds_read_b64 v[30:31], v6 offset:2888
    ds_read_b128 v[68:71], v12 offset:2368
    v_mfma_f32_16x16x32_bf16 v[96:99], v[32:35], v[64:67], v[96:99]
    v_mfma_f32_16x16x32_bf16 v[92:95], v[32:35], v[60:63], v[92:95]
    ds_read_b64 v[32:33], v6 offset:2368
    ds_read_b64 v[34:35], v6 offset:2376
    ds_read_b128 v[64:67], v12 offset:1856
    v_mfma_f32_16x16x32_bf16 v[96:99], v[36:39], v[60:63], v[96:99]
    v_mfma_f32_16x16x32_bf16 v[92:95], v[36:39], v[56:59], v[92:95]
    ds_read_b64 v[36:37], v6 offset:1856
    ds_read_b64 v[38:39], v6 offset:1864
    ds_read_b128 v[60:63], v12 offset:1344
    v_mfma_f32_16x16x32_bf16 v[96:99], v[40:43], v[56:59], v[96:99]
    v_mfma_f32_16x16x32_bf16 v[92:95], v[40:43], v[52:55], v[92:95]
    ds_read_b64 v[40:41], v6 offset:1344
    ds_read_b64 v[42:43], v6 offset:1352
    ds_read_b128 v[56:59], v12 offset:832
    v_mfma_f32_16x16x32_bf16 v[96:99], v[44:47], v[52:55], v[96:99]
    ds_read_b64 v[44:45], v6 offset:832
    ds_read_b64 v[46:47], v6 offset:840
    ds_read_b128 v[52:55], v12 offset:320
    buffer_load_dwordx4 v3, s[8:11], s27 offen offset:2048 sc1 lds
    buffer_load_dwordx4 v3, s[8:11], s27 offen offset:3072 sc1 lds
    s_waitcnt lgkmcnt(15)
    v_mfma_f32_16x16x32_bf16 v[96:99], v[20:23], v[76:79], v[96:99]
    v_mfma_f32_16x16x32_bf16 v[92:95], v[20:23], v[72:75], v[92:95]
    s_waitcnt lgkmcnt(6)
    v_mfma_f32_16x16x32_bf16 v[88:91], v[20:23], v[60:63], v[88:91]
    s_waitcnt lgkmcnt(3)
    v_mfma_f32_16x16x32_bf16 v[84:87], v[20:23], v[56:59], v[84:87]
    ds_read_b64 v[20:21], v6 offset:3840
    ds_read_b64 v[22:23], v6 offset:3848
    ds_read_b128 v[76:79], v12 offset:3328
    v_mfma_f32_16x16x32_bf16 v[96:99], v[24:27], v[72:75], v[96:99]
    v_mfma_f32_16x16x32_bf16 v[92:95], v[24:27], v[68:71], v[92:95]
    v_mfma_f32_16x16x32_bf16 v[88:91], v[24:27], v[56:59], v[88:91]
    s_waitcnt lgkmcnt(3)
    v_mfma_f32_16x16x32_bf16 v[84:87], v[24:27], v[52:55], v[84:87]
    ds_read_b64 v[24:25], v6 offset:3328
    ds_read_b64 v[26:27], v6 offset:3336
    ds_read_b128 v[72:75], v12 offset:2816
    v_mfma_f32_16x16x32_bf16 v[96:99], v[28:31], v[68:71], v[96:99]
    v_mfma_f32_16x16x32_bf16 v[92:95], v[28:31], v[64:67], v[92:95]
    v_mfma_f32_16x16x32_bf16 v[88:91], v[28:31], v[52:55], v[88:91]
    ds_read_b64 v[28:29], v6 offset:2816
    ds_read_b64 v[30:31], v6 offset:2824
    ds_read_b128 v[68:71], v12 offset:2304
    v_mfma_f32_16x16x32_bf16 v[96:99], v[32:35], v[64:67], v[96:99]
    v_mfma_f32_16x16x32_bf16 v[92:95], v[32:35], v[60:63], v[92:95]
    ds_read_b64 v[32:33], v6 offset:2304
    ds_read_b64 v[34:35], v6 offset:2312
    ds_read_b128 v[64:67], v12 offset:1792
    v_mfma_f32_16x16x32_bf16 v[96:99], v[36:39], v[60:63], v[96:99]
    v_mfma_f32_16x16x32_bf16 v[92:95], v[36:39], v[56:59], v[92:95]
    ds_read_b64 v[36:37], v6 offset:1792
    ds_read_b64 v[38:39], v6 offset:1800
    ds_read_b128 v[60:63], v12 offset:1280
    v_mfma_f32_16x16x32_bf16 v[96:99], v[40:43], v[56:59], v[96:99]
    v_mfma_f32_16x16x32_bf16 v[92:95], v[40:43], v[52:55], v[92:95]
    ds_read_b64 v[40:41], v6 offset:1280
    ds_read_b64 v[42:43], v6 offset:1288
    ds_read_b128 v[56:59], v12 offset:768
    v_mfma_f32_16x16x32_bf16 v[96:99], v[44:47], v[52:55], v[96:99]
    ds_read_b64 v[44:45], v6 offset:768
    ds_read_b64 v[46:47], v6 offset:776
    ds_read_b128 v[52:55], v12 offset:256
    s_add_u32 m0, s29, 131072
    s_add_u32 s27, s27, 4096
    buffer_load_dwordx4 v3, s[8:11], s27 offen offset:0 sc1 lds
    s_bfe_u32 s60, s2, 0x20003
    s_mul_i32 s60, s60, 165888
    s_and_b32 s61, s24, 3
    s_mul_i32 s61, s61, 36864
    s_add_u32 s60, s60, s61
    s_cmp_ge_u32 s24, 4
    s_cselect_b32 s61, 663552, 0
    s_add_u32 s60, s60, s61
    s_add_u32 s60, s60, 8224768
    s_add_u32 s61, s60, 8192
    buffer_load_dwordx4 v[144:147], v3, s[8:11], s61 offen offset:0 sc1
    s_waitcnt lgkmcnt(15)
    v_mfma_f32_16x16x32_bf16 v[96:99], v[20:23], v[76:79], v[96:99]
    v_mfma_f32_16x16x32_bf16 v[92:95], v[20:23], v[72:75], v[92:95]
    s_waitcnt lgkmcnt(6)
    v_mfma_f32_16x16x32_bf16 v[88:91], v[20:23], v[60:63], v[88:91]
    s_waitcnt lgkmcnt(3)
    v_mfma_f32_16x16x32_bf16 v[84:87], v[20:23], v[56:59], v[84:87]
    ds_read_b64 v[20:21], v6 offset:3776
    ds_read_b64 v[22:23], v6 offset:3784
    ds_read_b128 v[76:79], v12 offset:3264
    v_mfma_f32_16x16x32_bf16 v[96:99], v[24:27], v[72:75], v[96:99]
    v_mfma_f32_16x16x32_bf16 v[92:95], v[24:27], v[68:71], v[92:95]
    v_mfma_f32_16x16x32_bf16 v[88:91], v[24:27], v[56:59], v[88:91]
    s_waitcnt lgkmcnt(3)
    v_mfma_f32_16x16x32_bf16 v[84:87], v[24:27], v[52:55], v[84:87]
    ds_read_b64 v[24:25], v6 offset:3264
    ds_read_b64 v[26:27], v6 offset:3272
    ds_read_b128 v[72:75], v12 offset:2752
    v_mfma_f32_16x16x32_bf16 v[96:99], v[28:31], v[68:71], v[96:99]
    v_mfma_f32_16x16x32_bf16 v[92:95], v[28:31], v[64:67], v[92:95]
    v_mfma_f32_16x16x32_bf16 v[88:91], v[28:31], v[52:55], v[88:91]
    ds_read_b64 v[28:29], v6 offset:2752
    ds_read_b64 v[30:31], v6 offset:2760
    ds_read_b128 v[68:71], v12 offset:2240
    v_mfma_f32_16x16x32_bf16 v[96:99], v[32:35], v[64:67], v[96:99]
    v_mfma_f32_16x16x32_bf16 v[92:95], v[32:35], v[60:63], v[92:95]
    ds_read_b64 v[32:33], v6 offset:2240
    ds_read_b64 v[34:35], v6 offset:2248
    ds_read_b128 v[64:67], v12 offset:1728
    v_mfma_f32_16x16x32_bf16 v[96:99], v[36:39], v[60:63], v[96:99]
    v_mfma_f32_16x16x32_bf16 v[92:95], v[36:39], v[56:59], v[92:95]
    ds_read_b64 v[36:37], v6 offset:1728
    ds_read_b64 v[38:39], v6 offset:1736
    ds_read_b128 v[60:63], v12 offset:1216
    v_mfma_f32_16x16x32_bf16 v[96:99], v[40:43], v[56:59], v[96:99]
    v_mfma_f32_16x16x32_bf16 v[92:95], v[40:43], v[52:55], v[92:95]
    ds_read_b64 v[40:41], v6 offset:1216
    ds_read_b64 v[42:43], v6 offset:1224
    ds_read_b128 v[56:59], v12 offset:704
    v_mfma_f32_16x16x32_bf16 v[96:99], v[44:47], v[52:55], v[96:99]
    ds_read_b64 v[44:45], v6 offset:704
    ds_read_b64 v[46:47], v6 offset:712
    ds_read_b128 v[52:55], v12 offset:192
    buffer_load_dwordx4 v[148:151], v3, s[8:11], s61 offen offset:1024 sc1
    buffer_load_dwordx4 v[152:155], v3, s[8:11], s61 offen offset:2048 sc1
    s_waitcnt lgkmcnt(15)
    v_mfma_f32_16x16x32_bf16 v[96:99], v[20:23], v[76:79], v[96:99]
    v_mfma_f32_16x16x32_bf16 v[92:95], v[20:23], v[72:75], v[92:95]
    s_waitcnt lgkmcnt(6)
    v_mfma_f32_16x16x32_bf16 v[88:91], v[20:23], v[60:63], v[88:91]
    s_waitcnt lgkmcnt(3)
    v_mfma_f32_16x16x32_bf16 v[84:87], v[20:23], v[56:59], v[84:87]
    ds_read_b64 v[20:21], v6 offset:3712
    ds_read_b64 v[22:23], v6 offset:3720
    ds_read_b128 v[76:79], v12 offset:3200
    v_mfma_f32_16x16x32_bf16 v[96:99], v[24:27], v[72:75], v[96:99]
    v_mfma_f32_16x16x32_bf16 v[92:95], v[24:27], v[68:71], v[92:95]
    v_mfma_f32_16x16x32_bf16 v[88:91], v[24:27], v[56:59], v[88:91]
    s_waitcnt lgkmcnt(3)
    v_mfma_f32_16x16x32_bf16 v[84:87], v[24:27], v[52:55], v[84:87]
    ds_read_b64 v[24:25], v6 offset:3200
    ds_read_b64 v[26:27], v6 offset:3208
    ds_read_b128 v[72:75], v12 offset:2688
    v_mfma_f32_16x16x32_bf16 v[96:99], v[28:31], v[68:71], v[96:99]
    v_mfma_f32_16x16x32_bf16 v[92:95], v[28:31], v[64:67], v[92:95]
    v_mfma_f32_16x16x32_bf16 v[88:91], v[28:31], v[52:55], v[88:91]
    ds_read_b64 v[28:29], v6 offset:2688
    ds_read_b64 v[30:31], v6 offset:2696
    ds_read_b128 v[68:71], v12 offset:2176
    v_mfma_f32_16x16x32_bf16 v[96:99], v[32:35], v[64:67], v[96:99]
    v_mfma_f32_16x16x32_bf16 v[92:95], v[32:35], v[60:63], v[92:95]
    ds_read_b64 v[32:33], v6 offset:2176
    ds_read_b64 v[34:35], v6 offset:2184
    ds_read_b128 v[64:67], v12 offset:1664
    v_mfma_f32_16x16x32_bf16 v[96:99], v[36:39], v[60:63], v[96:99]
    v_mfma_f32_16x16x32_bf16 v[92:95], v[36:39], v[56:59], v[92:95]
    ds_read_b64 v[36:37], v6 offset:1664
    ds_read_b64 v[38:39], v6 offset:1672
    ds_read_b128 v[60:63], v12 offset:1152
    v_mfma_f32_16x16x32_bf16 v[96:99], v[40:43], v[56:59], v[96:99]
    v_mfma_f32_16x16x32_bf16 v[92:95], v[40:43], v[52:55], v[92:95]
    ds_read_b64 v[40:41], v6 offset:1152
    ds_read_b64 v[42:43], v6 offset:1160
    ds_read_b128 v[56:59], v12 offset:640
    v_mfma_f32_16x16x32_bf16 v[96:99], v[44:47], v[52:55], v[96:99]
    ds_read_b64 v[44:45], v6 offset:640
    ds_read_b64 v[46:47], v6 offset:648
    ds_read_b128 v[52:55], v12 offset:128
    buffer_load_dwordx4 v[156:159], v3, s[8:11], s61 offen offset:3072 sc1
    s_add_u32 s61, s60, 12288
    buffer_load_dwordx4 v[160:163], v3, s[8:11], s61 offen offset:0 sc1
    s_waitcnt lgkmcnt(15)
    v_mfma_f32_16x16x32_bf16 v[96:99], v[20:23], v[76:79], v[96:99]
    v_mfma_f32_16x16x32_bf16 v[92:95], v[20:23], v[72:75], v[92:95]
    s_waitcnt lgkmcnt(6)
    v_mfma_f32_16x16x32_bf16 v[88:91], v[20:23], v[60:63], v[88:91]
    s_waitcnt lgkmcnt(3)
    v_mfma_f32_16x16x32_bf16 v[84:87], v[20:23], v[56:59], v[84:87]
    ds_read_b64 v[20:21], v6 offset:3648
    ds_read_b64 v[22:23], v6 offset:3656
    ds_read_b128 v[76:79], v12 offset:3136
    v_mfma_f32_16x16x32_bf16 v[96:99], v[24:27], v[72:75], v[96:99]
    v_mfma_f32_16x16x32_bf16 v[92:95], v[24:27], v[68:71], v[92:95]
    v_mfma_f32_16x16x32_bf16 v[88:91], v[24:27], v[56:59], v[88:91]
    s_waitcnt lgkmcnt(3)
    v_mfma_f32_16x16x32_bf16 v[84:87], v[24:27], v[52:55], v[84:87]
    ds_read_b64 v[24:25], v6 offset:3136
    ds_read_b64 v[26:27], v6 offset:3144
    ds_read_b128 v[72:75], v12 offset:2624
    v_mfma_f32_16x16x32_bf16 v[96:99], v[28:31], v[68:71], v[96:99]
    v_mfma_f32_16x16x32_bf16 v[92:95], v[28:31], v[64:67], v[92:95]
    v_mfma_f32_16x16x32_bf16 v[88:91], v[28:31], v[52:55], v[88:91]
    ds_read_b64 v[28:29], v6 offset:2624
    ds_read_b64 v[30:31], v6 offset:2632
    ds_read_b128 v[68:71], v12 offset:2112
    v_mfma_f32_16x16x32_bf16 v[96:99], v[32:35], v[64:67], v[96:99]
    v_mfma_f32_16x16x32_bf16 v[92:95], v[32:35], v[60:63], v[92:95]
    ds_read_b64 v[32:33], v6 offset:2112
    ds_read_b64 v[34:35], v6 offset:2120
    ds_read_b128 v[64:67], v12 offset:1600
    v_mfma_f32_16x16x32_bf16 v[96:99], v[36:39], v[60:63], v[96:99]
    v_mfma_f32_16x16x32_bf16 v[92:95], v[36:39], v[56:59], v[92:95]
    ds_read_b64 v[36:37], v6 offset:1600
    ds_read_b64 v[38:39], v6 offset:1608
    ds_read_b128 v[60:63], v12 offset:1088
    v_mfma_f32_16x16x32_bf16 v[96:99], v[40:43], v[56:59], v[96:99]
    v_mfma_f32_16x16x32_bf16 v[92:95], v[40:43], v[52:55], v[92:95]
    ds_read_b64 v[40:41], v6 offset:1088
    ds_read_b64 v[42:43], v6 offset:1096
    ds_read_b128 v[56:59], v12 offset:576
    v_mfma_f32_16x16x32_bf16 v[96:99], v[44:47], v[52:55], v[96:99]
    ds_read_b64 v[44:45], v6 offset:576
    ds_read_b64 v[46:47], v6 offset:584
    ds_read_b128 v[52:55], v12 offset:64
    buffer_load_dwordx4 v[164:167], v3, s[8:11], s61 offen offset:1024 sc1
    buffer_load_dwordx4 v[168:171], v3, s[8:11], s61 offen offset:2048 sc1
    s_waitcnt lgkmcnt(15)
    v_mfma_f32_16x16x32_bf16 v[96:99], v[20:23], v[76:79], v[96:99]
    v_mfma_f32_16x16x32_bf16 v[92:95], v[20:23], v[72:75], v[92:95]
    s_waitcnt lgkmcnt(6)
    v_mfma_f32_16x16x32_bf16 v[88:91], v[20:23], v[60:63], v[88:91]
    s_waitcnt lgkmcnt(3)
    v_mfma_f32_16x16x32_bf16 v[84:87], v[20:23], v[56:59], v[84:87]
    ds_read_b64 v[20:21], v6 offset:3584
    ds_read_b64 v[22:23], v6 offset:3592
    ds_read_b128 v[76:79], v12 offset:3072
    v_mfma_f32_16x16x32_bf16 v[96:99], v[24:27], v[72:75], v[96:99]
    v_mfma_f32_16x16x32_bf16 v[92:95], v[24:27], v[68:71], v[92:95]
    v_mfma_f32_16x16x32_bf16 v[88:91], v[24:27], v[56:59], v[88:91]
    s_waitcnt lgkmcnt(3)
    v_mfma_f32_16x16x32_bf16 v[84:87], v[24:27], v[52:55], v[84:87]
    ds_read_b64 v[24:25], v6 offset:3072
    ds_read_b64 v[26:27], v6 offset:3080
    ds_read_b128 v[72:75], v12 offset:2560
    v_mfma_f32_16x16x32_bf16 v[96:99], v[28:31], v[68:71], v[96:99]
    v_mfma_f32_16x16x32_bf16 v[92:95], v[28:31], v[64:67], v[92:95]
    v_mfma_f32_16x16x32_bf16 v[88:91], v[28:31], v[52:55], v[88:91]
    ds_read_b64 v[28:29], v6 offset:2560
    ds_read_b64 v[30:31], v6 offset:2568
    ds_read_b128 v[68:71], v12 offset:2048
    v_mfma_f32_16x16x32_bf16 v[96:99], v[32:35], v[64:67], v[96:99]
    v_mfma_f32_16x16x32_bf16 v[92:95], v[32:35], v[60:63], v[92:95]
    ds_read_b64 v[32:33], v6 offset:2048
    ds_read_b64 v[34:35], v6 offset:2056
    ds_read_b128 v[64:67], v12 offset:1536
    v_mfma_f32_16x16x32_bf16 v[96:99], v[36:39], v[60:63], v[96:99]
    v_mfma_f32_16x16x32_bf16 v[92:95], v[36:39], v[56:59], v[92:95]
    ds_read_b64 v[36:37], v6 offset:1536
    ds_read_b64 v[38:39], v6 offset:1544
    ds_read_b128 v[60:63], v12 offset:1024
    v_mfma_f32_16x16x32_bf16 v[96:99], v[40:43], v[56:59], v[96:99]
    v_mfma_f32_16x16x32_bf16 v[92:95], v[40:43], v[52:55], v[92:95]
    ds_read_b64 v[40:41], v6 offset:1024
    ds_read_b64 v[42:43], v6 offset:1032
    ds_read_b128 v[56:59], v12 offset:512
    v_mfma_f32_16x16x32_bf16 v[96:99], v[44:47], v[52:55], v[96:99]
    ds_read_b64 v[44:45], v6 offset:512
    ds_read_b64 v[46:47], v6 offset:520
    ds_read_b128 v[52:55], v12 offset:0
    buffer_load_dwordx4 v[172:175], v3, s[8:11], s61 offen offset:3072 sc1
    s_waitcnt lgkmcnt(15)
    v_mfma_f32_16x16x32_bf16 v[96:99], v[20:23], v[76:79], v[96:99]
    v_mfma_f32_16x16x32_bf16 v[92:95], v[20:23], v[72:75], v[92:95]
    s_waitcnt lgkmcnt(6)
    v_mfma_f32_16x16x32_bf16 v[88:91], v[20:23], v[60:63], v[88:91]
    s_waitcnt lgkmcnt(3)
    v_mfma_f32_16x16x32_bf16 v[84:87], v[20:23], v[56:59], v[84:87]
    ds_read_b64 v[100:101], v10 offset:512
    v_mfma_f32_16x16x32_bf16 v[96:99], v[24:27], v[72:75], v[96:99]
    v_mfma_f32_16x16x32_bf16 v[92:95], v[24:27], v[68:71], v[92:95]
    v_mfma_f32_16x16x32_bf16 v[88:91], v[24:27], v[56:59], v[88:91]
    s_waitcnt lgkmcnt(1)
    v_mfma_f32_16x16x32_bf16 v[84:87], v[24:27], v[52:55], v[84:87]
    ds_read_b64 v[102:103], v10 offset:1024
    v_mfma_f32_16x16x32_bf16 v[96:99], v[28:31], v[68:71], v[96:99]
    v_mfma_f32_16x16x32_bf16 v[92:95], v[28:31], v[64:67], v[92:95]
    v_mfma_f32_16x16x32_bf16 v[88:91], v[28:31], v[52:55], v[88:91]
    ds_read_b64 v[104:105], v10 offset:2560
    v_mfma_f32_16x16x32_bf16 v[96:99], v[32:35], v[64:67], v[96:99]
    v_mfma_f32_16x16x32_bf16 v[92:95], v[32:35], v[60:63], v[92:95]
    ds_read_b64 v[106:107], v10 offset:3072
    v_mfma_f32_16x16x32_bf16 v[96:99], v[36:39], v[60:63], v[96:99]
    v_mfma_f32_16x16x32_bf16 v[92:95], v[36:39], v[56:59], v[92:95]
    v_mfma_f32_16x16x32_bf16 v[96:99], v[40:43], v[56:59], v[96:99]
    v_mfma_f32_16x16x32_bf16 v[92:95], v[40:43], v[52:55], v[92:95]
    v_mfma_f32_16x16x32_bf16 v[96:99], v[44:47], v[52:55], v[96:99]
    s_mov_b32 s20, 0x00003f80
    s_mov_b32 s21, 0x3f800000
    s_waitcnt lgkmcnt(0)
    v_dot2_f32_bf16 v84, v100, s20, v84
    v_dot2_f32_bf16 v85, v100, s21, v85
    v_dot2_f32_bf16 v86, v101, s20, v86
    v_dot2_f32_bf16 v87, v101, s21, v87
    v_dot2_f32_bf16 v88, v102, s20, v88
    v_dot2_f32_bf16 v89, v102, s21, v89
    v_dot2_f32_bf16 v90, v103, s20, v90
    v_dot2_f32_bf16 v91, v103, s21, v91
    v_dot2_f32_bf16 v92, v104, s20, v92
    v_dot2_f32_bf16 v93, v104, s21, v93
    v_dot2_f32_bf16 v94, v105, s20, v94
    v_dot2_f32_bf16 v95, v105, s21, v95
    v_dot2_f32_bf16 v96, v106, s20, v96
    v_dot2_f32_bf16 v97, v106, s21, v97
    v_dot2_f32_bf16 v98, v107, s20, v98
    v_dot2_f32_bf16 v99, v107, s21, v99
    v_cvt_pk_bf16_f32 v100, v84, v85
    v_cvt_pk_bf16_f32 v101, v86, v87
    buffer_store_dwordx2 v[100:101], v8, s[8:11], s23 offen offset:512 sc1
    v_cvt_pk_bf16_f32 v102, v88, v89
    v_cvt_pk_bf16_f32 v103, v90, v91
    buffer_store_dwordx2 v[102:103], v8, s[8:11], s23 offen offset:1024 sc1
    v_cvt_pk_bf16_f32 v104, v92, v93
    v_cvt_pk_bf16_f32 v105, v94, v95
    buffer_store_dwordx2 v[104:105], v8, s[8:11], s23 offen offset:2560 sc1
    v_cvt_pk_bf16_f32 v106, v96, v97
    v_cvt_pk_bf16_f32 v107, v98, v99
    buffer_store_dwordx2 v[106:107], v8, s[8:11], s23 offen offset:3072 sc1
Lcj_0_49:
    s_waitcnt vmcnt(0)
    s_barrier
    s_cmp_lg_u32 s24, 7
    s_cbranch_scc1 LD_0_3
    s_and_b32 s15, s2, 7
    s_add_u32 s15, s15, 40
    s_lshl_b32 s15, s15, 8
    v_mov_b32 v4, 0
    v_mov_b32 v5, 1
    s_mov_b64 exec, 1
    buffer_atomic_add v5, v4, s[8:11], s15 offen sc0 sc1
    s_mov_b64 exec, -1
    s_waitcnt vmcnt(0)
    v_readfirstlane_b32 s3, v5
    s_nop 0
    s_cmp_lg_u32 s3, 17
    s_cbranch_scc1 Lar_0_50
    v_mov_b32 v5, 1
    s_mov_b64 exec, 1
    buffer_store_dword v5, v4, s[8:11], s15 offen offset:2048 sc1
    s_mov_b64 exec, -1
Lar_0_50:
LD_0_3:
    s_and_b32 s12, s2, 7
    s_lshl_b32 s12, s12, 3
    s_lshr_b32 s13, s2, 5
    s_add_u32 s12, s12, s13
    s_bfe_u32 s13, s2, 0x20003
    s_and_b32 s15, s24, 3
    s_lshl_b32 s15, s15, 1
    s_mul_i32 s14, s13, 9
    s_add_u32 s14, s14, s15
    v_and_b32 v4, 15, v1
    v_lshrrev_b32 v5, 4, v1
    v_and_b32 v8, 3, v1
    v_lshrrev_b32 v6, 2, v1
    v_mul_u32_u24 v6, 4224, v6
    v_lshrrev_b32 v7, 5, v1
    v_lshlrev_b32 v7, 1, v7
    v_xor_b32 v7, v7, v8
    v_lshl_add_u32 v6, v7, 4, v6
    s_mul_i32 s18, s24, 67584
    s_lshl_b32 s19, s12, 6
    s_add_u32 s18, s18, s19
    s_add_u32 s18, s18, 5787776
    s_lshl_b32 s19, s24, 10
    s_add_u32 s19, s19, 73728
    v_lshrrev_b32 v9, 2, v1
    v_lshlrev_b32 v9, 6, v9
    v_lshl_add_u32 v9, v8, 3, v9
    v_add_u32 v9, 73728, v9
    v_lshrrev_b32 v7, 5, v1
    v_lshl_add_u32 v9, v7, 5, v9
    v_xor_b32 v10, 32, v9
    v_lshrrev_b32 v11, 2, v4
    v_lshl_add_u32 v11, v5, 3, v11
    v_lshlrev_b32 v11, 6, v11
    v_lshl_add_u32 v11, v8, 3, v11
    v_and_b32 v7, 1, v5
    v_lshl_add_u32 v11, v7, 5, v11
    v_add_u32 v11, 73728, v11
    v_xor_b32 v12, 32, v11
    s_lshl_b32 s21, s24, 5
    s_and_b32 s21, s21, 32
    v_xor_b32 v14, s21, v11
    v_xor_b32 v15, s21, v9
    v_lshlrev_b32 v13, 4, v4
    v_add_u32 v13, 73728, v13
    v_add_u32 v19, 126976, v3
    s_mov_b32 s20, 0x3f803f80
    v_mov_b32 v104, s20
    v_mov_b32 v105, s20
    v_mov_b32 v106, s20
    v_mov_b32 v107, s20
    v_lshrrev_b32 v7, 1, v5
    v_lshlrev_b32 v7, 9, v7
    v_and_b32 v16, 1, v5
    v_lshl_add_u32 v7, v16, 3, v7
    v_lshl_add_u32 v7, v4, 4, v7
    s_mul_i32 s25, s12, 36864
    s_lshl_b32 s36, s14, 10
    s_add_u32 s36, s36, s25
    s_mul_i32 s37, s13, 9216
    s_add_u32 s37, s37, s25
    s_lshl_b32 s21, s21, 3
    s_add_u32 s37, s37, s21
    s_add_u32 s37, s37, 8192
    s_mov_b32 s26, 0x00003f80
    s_mov_b32 s27, 0x3f800000
    s_mov_b32 s28, 0xbdd2d3e8
    v_mov_b32 v18, 0xc0135761
    s_cmp_lg_u32 s24, 6
    s_cbranch_scc1 Lx_0_52
    v_and_b32 v20, 7, v1
    v_lshlrev_b32 v20, 8, v20
    v_add_u32 v20, 12288, v20
Lpo_0_53:
    buffer_load_dword v22, v20, s[8:11], 0 offen sc1
    s_sub_u32 s38, s38, 1
    s_cmp_lt_i32 s38, 0
    s_cbranch_scc1 Lpx_0_54
    s_waitcnt vmcnt(0)
    v_cmp_eq_u32 vcc, 0, v22
    s_nop 0
    s_cbranch_vccz Lpx_0_54
    s_sleep 0
    s_branch Lpo_0_53
Lpx_0_54:
    s_waitcnt vmcnt(0)
Lx_0_52:
    s_barrier
    v_add_u32 v16, s19, v3
    s_cmp_ge_u32 s24, 4
    s_cselect_b32 s17, 0, 32768
    v_add_u32 v17, s17, v16
    s_mov_b32 s48, 0
Ld_0_63:
    s_add_u32 m0, s19, 0
    s_add_u32 s17, s18, 0
    buffer_load_dwordx4 v6, s[8:11], s17 offen sc1 lds
    s_add_u32 m0, s19, 8192
    s_add_u32 s17, s18, 540672
    buffer_load_dwordx4 v6, s[8:11], s17 offen sc1 lds
    s_add_u32 m0, s19, 16384
    s_add_u32 s17, s18, 1081344
    buffer_load_dwordx4 v6, s[8:11], s17 offen sc1 lds
    s_add_u32 m0, s19, 24576
    s_add_u32 s17, s18, 1622016
    buffer_load_dwordx4 v6, s[8:11], s17 offen sc1 lds
    s_cmp_ge_u32 s24, 4
    s_cbranch_scc1 Ld_0_55
    s_add_u32 m0, s19, 32768
    s_add_u32 s17, s18, 2162688
    buffer_load_dwordx4 v6, s[8:11], s17 offen sc1 lds
Ld_0_55:
    s_cmp_lg_u32 s48, 0
    s_cbranch_scc1 Ld_0_64
    s_mov_b32 s48, 1
    s_cmp_ge_u32 s24, 4
    s_cbranch_scc1 Ld_0_65
    ds_read_b128 v[56:59], v19 offset:0
    ds_read_b128 v[60:63], v19 offset:1024
    ds_read_b128 v[64:67], v19 offset:2048
    ds_read_b128 v[68:71], v19 offset:3072
    v_mfma_f32_16x16x32_bf16 v[92:95], v[112:115], v[104:107], 0
    v_mfma_f32_16x16x32_bf16 v[96:99], v[184:187], v[104:107], 0
    s_waitcnt lgkmcnt(3)
    v_mfma_f32_16x16x32_bf16 v[100:103], v[56:59], v[104:107], 0
    ds_read_b128 v[56:59], v19 offset:4096
    v_mfma_f32_16x16x32_bf16 v[92:95], v[116:119], v[104:107], v[92:95]
    v_mfma_f32_16x16x32_bf16 v[96:99], v[188:191], v[104:107], v[96:99]
    s_waitcnt lgkmcnt(3)
    v_mfma_f32_16x16x32_bf16 v[100:103], v[60:63], v[104:107], v[100:103]
    ds_read_b128 v[60:63], v19 offset:5120
    v_mfma_f32_16x16x32_bf16 v[92:95], v[120:123], v[104:107], v[92:95]
    v_mfma_f32_16x16x32_bf16 v[96:99], v[192:195], v[104:107], v[96:99]
    s_waitcnt lgkmcnt(3)
    v_mfma_f32_16x16x32_bf16 v[100:103], v[64:67], v[104:107], v[100:103]
    ds_read_b128 v[64:67], v19 offset:6144
    v_mfma_f32_16x16x32_bf16 v[92:95], v[124:127], v[104:107], v[92:95]
    v_mfma_f32_16x16x32_bf16 v[96:99], v[196:199], v[104:107], v[96:99]
    s_waitcnt lgkmcnt(3)
    v_mfma_f32_16x16x32_bf16 v[100:103], v[68:71], v[104:107], v[100:103]
    ds_read_b128 v[68:71], v19 offset:7168
    v_mfma_f32_16x16x32_bf16 v[92:95], v[128:131], v[104:107], v[92:95]
    v_mfma_f32_16x16x32_bf16 v[96:99], v[200:203], v[104:107], v[96:99]
    s_waitcnt lgkmcnt(3)
    v_mfma_f32_16x16x32_bf16 v[100:103], v[56:59], v[104:107], v[100:103]
    ds_read_b128 v[56:59], v19 offset:8192
    v_mfma_f32_16x16x32_bf16 v[92:95], v[132:135], v[104:107], v[92:95]
    v_mfma_f32_16x16x32_bf16 v[96:99], v[204:207], v[104:107], v[96:99]
    s_waitcnt lgkmcnt(3)
    v_mfma_f32_16x16x32_bf16 v[100:103], v[60:63], v[104:107], v[100:103]
    ds_read_b128 v[60:63], v19 offset:9216
    v_mfma_f32_16x16x32_bf16 v[92:95], v[136:139], v[104:107], v[92:95]
    v_mfma_f32_16x16x32_bf16 v[96:99], v[208:211], v[104:107], v[96:99]
    s_waitcnt lgkmcnt(3)
    v_mfma_f32_16x16x32_bf16 v[100:103], v[64:67], v[104:107], v[100:103]
    ds_read_b128 v[64:67], v19 offset:10240
    v_mfma_f32_16x16x32_bf16 v[92:95], v[140:143], v[104:107], v[92:95]
    v_mfma_f32_16x16x32_bf16 v[96:99], v[212:215], v[104:107], v[96:99]
    s_waitcnt lgkmcnt(3)
    v_mfma_f32_16x16x32_bf16 v[100:103], v[68:71], v[104:107], v[100:103]
    ds_read_b128 v[68:71], v19 offset:11264
    v_mfma_f32_16x16x32_bf16 v[92:95], v[144:147], v[104:107], v[92:95]
    v_mfma_f32_16x16x32_bf16 v[96:99], v[216:219], v[104:107], v[96:99]
    s_waitcnt lgkmcnt(3)
    v_mfma_f32_16x16x32_bf16 v[100:103], v[56:59], v[104:107], v[100:103]
    ds_read_b128 v[56:59], v19 offset:12288
    v_mfma_f32_16x16x32_bf16 v[92:95], v[148:151], v[104:107], v[92:95]
    v_mfma_f32_16x16x32_bf16 v[96:99], v[220:223], v[104:107], v[96:99]
    s_waitcnt lgkmcnt(3)
    v_mfma_f32_16x16x32_bf16 v[100:103], v[60:63], v[104:107], v[100:103]
    ds_read_b128 v[60:63], v19 offset:13312
    v_mfma_f32_16x16x32_bf16 v[92:95], v[152:155], v[104:107], v[92:95]
    v_mfma_f32_16x16x32_bf16 v[96:99], v[224:227], v[104:107], v[96:99]
    s_waitcnt lgkmcnt(3)
    v_mfma_f32_16x16x32_bf16 v[100:103], v[64:67], v[104:107], v[100:103]
    ds_read_b128 v[64:67], v19 offset:14336
    v_mfma_f32_16x16x32_bf16 v[92:95], v[156:159], v[104:107], v[92:95]
    v_mfma_f32_16x16x32_bf16 v[96:99], v[228:231], v[104:107], v[96:99]
    s_waitcnt lgkmcnt(3)
    v_mfma_f32_16x16x32_bf16 v[100:103], v[68:71], v[104:107], v[100:103]
    ds_read_b128 v[68:71], v19 offset:15360
    v_mfma_f32_16x16x32_bf16 v[92:95], v[160:163], v[104:107], v[92:95]
    v_mfma_f32_16x16x32_bf16 v[96:99], v[232:235], v[104:107], v[96:99]
    s_waitcnt lgkmcnt(3)
    v_mfma_f32_16x16x32_bf16 v[100:103], v[56:59], v[104:107], v[100:103]
    ds_read_b128 v[56:59], v19 offset:16384
    v_mfma_f32_16x16x32_bf16 v[92:95], v[164:167], v[104:107], v[92:95]
    v_mfma_f32_16x16x32_bf16 v[96:99], v[236:239], v[104:107], v[96:99]
    s_waitcnt lgkmcnt(3)
    v_mfma_f32_16x16x32_bf16 v[100:103], v[60:63], v[104:107], v[100:103]
    ds_read_b128 v[60:63], v19 offset:17408
    v_mfma_f32_16x16x32_bf16 v[92:95], v[168:171], v[104:107], v[92:95]
    v_mfma_f32_16x16x32_bf16 v[96:99], v[240:243], v[104:107], v[96:99]
    s_waitcnt lgkmcnt(3)
    v_mfma_f32_16x16x32_bf16 v[100:103], v[64:67], v[104:107], v[100:103]
    v_mfma_f32_16x16x32_bf16 v[92:95], v[172:175], v[104:107], v[92:95]
    v_mfma_f32_16x16x32_bf16 v[96:99], v[244:247], v[104:107], v[96:99]
    s_waitcnt lgkmcnt(2)
    v_mfma_f32_16x16x32_bf16 v[100:103], v[68:71], v[104:107], v[100:103]
    v_mfma_f32_16x16x32_bf16 v[92:95], v[176:179], v[104:107], v[92:95]
    v_mfma_f32_16x16x32_bf16 v[96:99], v[248:251], v[104:107], v[96:99]
    s_waitcnt lgkmcnt(1)
    v_mfma_f32_16x16x32_bf16 v[100:103], v[56:59], v[104:107], v[100:103]
    v_mfma_f32_16x16x32_bf16 v[92:95], v[180:183], v[104:107], v[92:95]
    v_mfma_f32_16x16x32_bf16 v[96:99], v[252:255], v[104:107], v[96:99]
    s_waitcnt lgkmcnt(0)
    v_mfma_f32_16x16x32_bf16 v[100:103], v[60:63], v[104:107], v[100:103]
Ld_0_65:
Ld_0_64:
    s_waitcnt vmcnt(0)
    s_barrier
    s_cmp_ge_u32 s24, 4
    s_cbranch_scc1 Ld_0_56
    s_cmp_eq_u32 s24, 0
    s_cbranch_scc1 Ld_0_66
    s_cmp_eq_u32 s24, 1
    s_cbranch_scc1 Ld_0_67
    ds_read_b64_tr_b16 v[36:37], v11 offset:0
    ds_read_b64_tr_b16 v[38:39], v11 offset:256
    ds_read_b64_tr_b16 v[40:41], v12 offset:0
    ds_read_b64_tr_b16 v[42:43], v12 offset:256
    ds_read_b64_tr_b16 v[44:45], v11 offset:2048
    ds_read_b64_tr_b16 v[46:47], v11 offset:2304
    ds_read_b64_tr_b16 v[48:49], v12 offset:2048
    ds_read_b64_tr_b16 v[50:51], v12 offset:2304
    s_waitcnt lgkmcnt(4)
    v_mfma_f32_16x16x32_bf16 v[72:75], v[112:115], v[36:39], 0
    ds_read_b64_tr_b16 v[52:53], v11 offset:4096
    v_mfma_f32_16x16x32_bf16 v[76:79], v[112:115], v[40:43], 0
    ds_read_b64_tr_b16 v[54:55], v11 offset:4352
    v_mfma_f32_16x16x32_bf16 v[80:83], v[184:187], v[36:39], 0
    ds_read_b64_tr_b16 v[56:57], v12 offset:4096
    v_mfma_f32_16x16x32_bf16 v[84:87], v[184:187], v[40:43], 0
    ds_read_b64_tr_b16 v[58:59], v12 offset:4352
    s_waitcnt lgkmcnt(4)
    v_mfma_f32_16x16x32_bf16 v[72:75], v[116:119], v[44:47], v[72:75]
    ds_read_b64_tr_b16 v[36:37], v11 offset:6144
    v_mfma_f32_16x16x32_bf16 v[76:79], v[116:119], v[48:51], v[76:79]
    ds_read_b64_tr_b16 v[38:39], v11 offset:6400
    v_mfma_f32_16x16x32_bf16 v[80:83], v[188:191], v[44:47], v[80:83]
    ds_read_b64_tr_b16 v[40:41], v12 offset:6144
    v_mfma_f32_16x16x32_bf16 v[84:87], v[188:191], v[48:51], v[84:87]
    ds_read_b64_tr_b16 v[42:43], v12 offset:6400
    s_waitcnt lgkmcnt(4)
    v_mfma_f32_16x16x32_bf16 v[72:75], v[120:123], v[52:55], v[72:75]
    ds_read_b64_tr_b16 v[44:45], v11 offset:8192
    v_mfma_f32_16x16x32_bf16 v[76:79], v[120:123], v[56:59], v[76:79]
    ds_read_b64_tr_b16 v[46:47], v11 offset:8448
    v_mfma_f32_16x16x32_bf16 v[80:83], v[192:195], v[52:55], v[80:83]
    ds_read_b64_tr_b16 v[48:49], v12 offset:8192
    v_mfma_f32_16x16x32_bf16 v[84:87], v[192:195], v[56:59], v[84:87]
    ds_read_b64_tr_b16 v[50:51], v12 offset:8448
    s_waitcnt lgkmcnt(4)
    v_mfma_f32_16x16x32_bf16 v[72:75], v[124:127], v[36:39], v[72:75]
    ds_read_b64_tr_b16 v[52:53], v11 offset:10240
    v_mfma_f32_16x16x32_bf16 v[76:79], v[124:127], v[40:43], v[76:79]
    ds_read_b64_tr_b16 v[54:55], v11 offset:10496
    v_mfma_f32_16x16x32_bf16 v[80:83], v[196:199], v[36:39], v[80:83]
    ds_read_b64_tr_b16 v[56:57], v12 offset:10240
    v_mfma_f32_16x16x32_bf16 v[84:87], v[196:199], v[40:43], v[84:87]
    ds_read_b64_tr_b16 v[58:59], v12 offset:10496
    s_waitcnt lgkmcnt(4)
    v_mfma_f32_16x16x32_bf16 v[72:75], v[128:131], v[44:47], v[72:75]
    ds_read_b64_tr_b16 v[36:37], v11 offset:12288
    v_mfma_f32_16x16x32_bf16 v[76:79], v[128:131], v[48:51], v[76:79]
    ds_read_b64_tr_b16 v[38:39], v11 offset:12544
    v_mfma_f32_16x16x32_bf16 v[80:83], v[200:203], v[44:47], v[80:83]
    ds_read_b64_tr_b16 v[40:41], v12 offset:12288
    v_mfma_f32_16x16x32_bf16 v[84:87], v[200:203], v[48:51], v[84:87]
    ds_read_b64_tr_b16 v[42:43], v12 offset:12544
    s_waitcnt lgkmcnt(4)
    v_mfma_f32_16x16x32_bf16 v[72:75], v[132:135], v[52:55], v[72:75]
    ds_read_b64_tr_b16 v[44:45], v11 offset:14336
    v_mfma_f32_16x16x32_bf16 v[76:79], v[132:135], v[56:59], v[76:79]
    ds_read_b64_tr_b16 v[46:47], v11 offset:14592
    v_mfma_f32_16x16x32_bf16 v[80:83], v[204:207], v[52:55], v[80:83]
    ds_read_b64_tr_b16 v[48:49], v12 offset:14336
    v_mfma_f32_16x16x32_bf16 v[84:87], v[204:207], v[56:59], v[84:87]
    ds_read_b64_tr_b16 v[50:51], v12 offset:14592
    s_waitcnt lgkmcnt(4)
    v_mfma_f32_16x16x32_bf16 v[72:75], v[136:139], v[36:39], v[72:75]
    ds_read_b64_tr_b16 v[52:53], v11 offset:16384
    v_mfma_f32_16x16x32_bf16 v[76:79], v[136:139], v[40:43], v[76:79]
    ds_read_b64_tr_b16 v[54:55], v11 offset:16640
    v_mfma_f32_16x16x32_bf16 v[80:83], v[208:211], v[36:39], v[80:83]
    ds_read_b64_tr_b16 v[56:57], v12 offset:16384
    v_mfma_f32_16x16x32_bf16 v[84:87], v[208:211], v[40:43], v[84:87]
    ds_read_b64_tr_b16 v[58:59], v12 offset:16640
    s_waitcnt lgkmcnt(4)
    v_mfma_f32_16x16x32_bf16 v[72:75], v[140:143], v[44:47], v[72:75]
    ds_read_b64_tr_b16 v[36:37], v11 offset:18432
    v_mfma_f32_16x16x32_bf16 v[76:79], v[140:143], v[48:51], v[76:79]
    ds_read_b64_tr_b16 v[38:39], v11 offset:18688
    v_mfma_f32_16x16x32_bf16 v[80:83], v[212:215], v[44:47], v[80:83]
    ds_read_b64_tr_b16 v[40:41], v12 offset:18432
    v_mfma_f32_16x16x32_bf16 v[84:87], v[212:215], v[48:51], v[84:87]
    ds_read_b64_tr_b16 v[42:43], v12 offset:18688
    s_waitcnt lgkmcnt(4)
    v_mfma_f32_16x16x32_bf16 v[72:75], v[144:147], v[52:55], v[72:75]
    ds_read_b64_tr_b16 v[44:45], v11 offset:20480
    v_mfma_f32_16x16x32_bf16 v[76:79], v[144:147], v[56:59], v[76:79]
    ds_read_b64_tr_b16 v[46:47], v11 offset:20736
    v_mfma_f32_16x16x32_bf16 v[80:83], v[216:219], v[52:55], v[80:83]
    ds_read_b64_tr_b16 v[48:49], v12 offset:20480
    v_mfma_f32_16x16x32_bf16 v[84:87], v[216:219], v[56:59], v[84:87]
    ds_read_b64_tr_b16 v[50:51], v12 offset:20736
    s_waitcnt lgkmcnt(4)
    v_mfma_f32_16x16x32_bf16 v[72:75], v[148:151], v[36:39], v[72:75]
    ds_read_b64_tr_b16 v[52:53], v11 offset:22528
    v_mfma_f32_16x16x32_bf16 v[76:79], v[148:151], v[40:43], v[76:79]
    ds_read_b64_tr_b16 v[54:55], v11 offset:22784
    v_mfma_f32_16x16x32_bf16 v[80:83], v[220:223], v[36:39], v[80:83]
    ds_read_b64_tr_b16 v[56:57], v12 offset:22528
    v_mfma_f32_16x16x32_bf16 v[84:87], v[220:223], v[40:43], v[84:87]
    ds_read_b64_tr_b16 v[58:59], v12 offset:22784
    s_waitcnt lgkmcnt(4)
    v_mfma_f32_16x16x32_bf16 v[72:75], v[152:155], v[44:47], v[72:75]
    ds_read_b64_tr_b16 v[36:37], v11 offset:24576
    v_mfma_f32_16x16x32_bf16 v[76:79], v[152:155], v[48:51], v[76:79]
    ds_read_b64_tr_b16 v[38:39], v11 offset:24832
    v_mfma_f32_16x16x32_bf16 v[80:83], v[224:227], v[44:47], v[80:83]
    ds_read_b64_tr_b16 v[40:41], v12 offset:24576
    v_mfma_f32_16x16x32_bf16 v[84:87], v[224:227], v[48:51], v[84:87]
    ds_read_b64_tr_b16 v[42:43], v12 offset:24832
    s_waitcnt lgkmcnt(4)
    v_mfma_f32_16x16x32_bf16 v[72:75], v[156:159], v[52:55], v[72:75]
    ds_read_b64_tr_b16 v[44:45], v11 offset:26624
    v_mfma_f32_16x16x32_bf16 v[76:79], v[156:159], v[56:59], v[76:79]
    ds_read_b64_tr_b16 v[46:47], v11 offset:26880
    v_mfma_f32_16x16x32_bf16 v[80:83], v[228:231], v[52:55], v[80:83]
    ds_read_b64_tr_b16 v[48:49], v12 offset:26624
    v_mfma_f32_16x16x32_bf16 v[84:87], v[228:231], v[56:59], v[84:87]
    ds_read_b64_tr_b16 v[50:51], v12 offset:26880
    s_waitcnt lgkmcnt(4)
    v_mfma_f32_16x16x32_bf16 v[72:75], v[160:163], v[36:39], v[72:75]
    ds_read_b64_tr_b16 v[52:53], v11 offset:28672
    v_mfma_f32_16x16x32_bf16 v[76:79], v[160:163], v[40:43], v[76:79]
    ds_read_b64_tr_b16 v[54:55], v11 offset:28928
    v_mfma_f32_16x16x32_bf16 v[80:83], v[232:235], v[36:39], v[80:83]
    ds_read_b64_tr_b16 v[56:57], v12 offset:28672
    v_mfma_f32_16x16x32_bf16 v[84:87], v[232:235], v[40:43], v[84:87]
    ds_read_b64_tr_b16 v[58:59], v12 offset:28928
    s_waitcnt lgkmcnt(4)
    v_mfma_f32_16x16x32_bf16 v[72:75], v[164:167], v[44:47], v[72:75]
    ds_read_b64_tr_b16 v[36:37], v11 offset:30720
    v_mfma_f32_16x16x32_bf16 v[76:79], v[164:167], v[48:51], v[76:79]
    ds_read_b64_tr_b16 v[38:39], v11 offset:30976
    v_mfma_f32_16x16x32_bf16 v[80:83], v[236:239], v[44:47], v[80:83]
    ds_read_b64_tr_b16 v[40:41], v12 offset:30720
    v_mfma_f32_16x16x32_bf16 v[84:87], v[236:239], v[48:51], v[84:87]
    ds_read_b64_tr_b16 v[42:43], v12 offset:30976
    s_waitcnt lgkmcnt(4)
    v_mfma_f32_16x16x32_bf16 v[72:75], v[168:171], v[52:55], v[72:75]
    ds_read_b64_tr_b16 v[44:45], v11 offset:32768
    v_mfma_f32_16x16x32_bf16 v[76:79], v[168:171], v[56:59], v[76:79]
    ds_read_b64_tr_b16 v[46:47], v11 offset:33024
    v_mfma_f32_16x16x32_bf16 v[80:83], v[240:243], v[52:55], v[80:83]
    ds_read_b64_tr_b16 v[48:49], v12 offset:32768
    v_mfma_f32_16x16x32_bf16 v[84:87], v[240:243], v[56:59], v[84:87]
    ds_read_b64_tr_b16 v[50:51], v12 offset:33024
    s_waitcnt lgkmcnt(4)
    v_mfma_f32_16x16x32_bf16 v[72:75], v[172:175], v[36:39], v[72:75]
    ds_read_b64_tr_b16 v[52:53], v11 offset:34816
    v_mfma_f32_16x16x32_bf16 v[76:79], v[172:175], v[40:43], v[76:79]
    ds_read_b64_tr_b16 v[54:55], v11 offset:35072
    v_mfma_f32_16x16x32_bf16 v[80:83], v[244:247], v[36:39], v[80:83]
    ds_read_b64_tr_b16 v[56:57], v12 offset:34816
    v_mfma_f32_16x16x32_bf16 v[84:87], v[244:247], v[40:43], v[84:87]
    ds_read_b64_tr_b16 v[58:59], v12 offset:35072
    s_waitcnt lgkmcnt(4)
    v_mfma_f32_16x16x32_bf16 v[72:75], v[176:179], v[44:47], v[72:75]
    v_mfma_f32_16x16x32_bf16 v[76:79], v[176:179], v[48:51], v[76:79]
    v_mfma_f32_16x16x32_bf16 v[80:83], v[248:251], v[44:47], v[80:83]
    v_mfma_f32_16x16x32_bf16 v[84:87], v[248:251], v[48:51], v[84:87]
    s_waitcnt lgkmcnt(0)
    v_mfma_f32_16x16x32_bf16 v[72:75], v[180:183], v[52:55], v[72:75]
    v_mfma_f32_16x16x32_bf16 v[76:79], v[180:183], v[56:59], v[76:79]
    v_mfma_f32_16x16x32_bf16 v[80:83], v[252:255], v[52:55], v[80:83]
    v_mfma_f32_16x16x32_bf16 v[84:87], v[252:255], v[56:59], v[84:87]
    s_branch Ld_0_58
Ld_0_66:
    ds_read_b64_tr_b16 v[36:37], v11 offset:0
    ds_read_b64_tr_b16 v[38:39], v11 offset:256
    ds_read_b64_tr_b16 v[40:41], v12 offset:0
    ds_read_b64_tr_b16 v[42:43], v12 offset:256
    ds_read_b128 v[60:63], v19 offset:0
    ds_read_b64_tr_b16 v[44:45], v11 offset:2048
    ds_read_b64_tr_b16 v[46:47], v11 offset:2304
    ds_read_b64_tr_b16 v[48:49], v12 offset:2048
    ds_read_b64_tr_b16 v[50:51], v12 offset:2304
    ds_read_b128 v[64:67], v19 offset:1024
    s_waitcnt lgkmcnt(5)
    v_mfma_f32_16x16x32_bf16 v[72:75], v[112:115], v[36:39], 0
    ds_read_b64_tr_b16 v[52:53], v11 offset:4096
    v_mfma_f32_16x16x32_bf16 v[76:79], v[112:115], v[40:43], 0
    ds_read_b64_tr_b16 v[54:55], v11 offset:4352
    v_mfma_f32_16x16x32_bf16 v[80:83], v[184:187], v[36:39], 0
    ds_read_b64_tr_b16 v[56:57], v12 offset:4096
    v_mfma_f32_16x16x32_bf16 v[84:87], v[184:187], v[40:43], 0
    ds_read_b64_tr_b16 v[58:59], v12 offset:4352
    v_mfma_f32_16x16x32_bf16 v[88:91], v[60:63], v[36:39], 0
    ds_read_b128 v[68:71], v19 offset:2048
    s_waitcnt lgkmcnt(5)
    v_mfma_f32_16x16x32_bf16 v[72:75], v[116:119], v[44:47], v[72:75]
    ds_read_b64_tr_b16 v[36:37], v11 offset:6144
    v_mfma_f32_16x16x32_bf16 v[76:79], v[116:119], v[48:51], v[76:79]
    ds_read_b64_tr_b16 v[38:39], v11 offset:6400
    v_mfma_f32_16x16x32_bf16 v[80:83], v[188:191], v[44:47], v[80:83]
    ds_read_b64_tr_b16 v[40:41], v12 offset:6144
    v_mfma_f32_16x16x32_bf16 v[84:87], v[188:191], v[48:51], v[84:87]
    ds_read_b64_tr_b16 v[42:43], v12 offset:6400
    v_mfma_f32_16x16x32_bf16 v[88:91], v[64:67], v[44:47], v[88:91]
    ds_read_b128 v[60:63], v19 offset:3072
    s_waitcnt lgkmcnt(5)
    v_mfma_f32_16x16x32_bf16 v[72:75], v[120:123], v[52:55], v[72:75]
    ds_read_b64_tr_b16 v[44:45], v11 offset:8192
    v_mfma_f32_16x16x32_bf16 v[76:79], v[120:123], v[56:59], v[76:79]
    ds_read_b64_tr_b16 v[46:47], v11 offset:8448
    v_mfma_f32_16x16x32_bf16 v[80:83], v[192:195], v[52:55], v[80:83]
    ds_read_b64_tr_b16 v[48:49], v12 offset:8192
    v_mfma_f32_16x16x32_bf16 v[84:87], v[192:195], v[56:59], v[84:87]
    ds_read_b64_tr_b16 v[50:51], v12 offset:8448
    v_mfma_f32_16x16x32_bf16 v[88:91], v[68:71], v[52:55], v[88:91]
    ds_read_b128 v[64:67], v19 offset:4096
    s_waitcnt lgkmcnt(5)
    v_mfma_f32_16x16x32_bf16 v[72:75], v[124:127], v[36:39], v[72:75]
    ds_read_b64_tr_b16 v[52:53], v11 offset:10240
    v_mfma_f32_16x16x32_bf16 v[76:79], v[124:127], v[40:43], v[76:79]
    ds_read_b64_tr_b16 v[54:55], v11 offset:10496
    v_mfma_f32_16x16x32_bf16 v[80:83], v[196:199], v[36:39], v[80:83]
    ds_read_b64_tr_b16 v[56:57], v12 offset:10240
    v_mfma_f32_16x16x32_bf16 v[84:87], v[196:199], v[40:43], v[84:87]
    ds_read_b64_tr_b16 v[58:59], v12 offset:10496
    v_mfma_f32_16x16x32_bf16 v[88:91], v[60:63], v[36:39], v[88:91]
    ds_read_b128 v[68:71], v19 offset:5120
    s_waitcnt lgkmcnt(5)
    v_mfma_f32_16x16x32_bf16 v[72:75], v[128:131], v[44:47], v[72:75]
    ds_read_b64_tr_b16 v[36:37], v11 offset:12288
    v_mfma_f32_16x16x32_bf16 v[76:79], v[128:131], v[48:51], v[76:79]
    ds_read_b64_tr_b16 v[38:39], v11 offset:12544
    v_mfma_f32_16x16x32_bf16 v[80:83], v[200:203], v[44:47], v[80:83]
    ds_read_b64_tr_b16 v[40:41], v12 offset:12288
    v_mfma_f32_16x16x32_bf16 v[84:87], v[200:203], v[48:51], v[84:87]
    ds_read_b64_tr_b16 v[42:43], v12 offset:12544
    v_mfma_f32_16x16x32_bf16 v[88:91], v[64:67], v[44:47], v[88:91]
    ds_read_b128 v[60:63], v19 offset:6144
    s_waitcnt lgkmcnt(5)
    v_mfma_f32_16x16x32_bf16 v[72:75], v[132:135], v[52:55], v[72:75]
    ds_read_b64_tr_b16 v[44:45], v11 offset:14336
    v_mfma_f32_16x16x32_bf16 v[76:79], v[132:135], v[56:59], v[76:79]
    ds_read_b64_tr_b16 v[46:47], v11 offset:14592
    v_mfma_f32_16x16x32_bf16 v[80:83], v[204:207], v[52:55], v[80:83]
    ds_read_b64_tr_b16 v[48:49], v12 offset:14336
    v_mfma_f32_16x16x32_bf16 v[84:87], v[204:207], v[56:59], v[84:87]
    ds_read_b64_tr_b16 v[50:51], v12 offset:14592
    v_mfma_f32_16x16x32_bf16 v[88:91], v[68:71], v[52:55], v[88:91]
    ds_read_b128 v[64:67], v19 offset:7168
    s_waitcnt lgkmcnt(5)
    v_mfma_f32_16x16x32_bf16 v[72:75], v[136:139], v[36:39], v[72:75]
    ds_read_b64_tr_b16 v[52:53], v11 offset:16384
    v_mfma_f32_16x16x32_bf16 v[76:79], v[136:139], v[40:43], v[76:79]
    ds_read_b64_tr_b16 v[54:55], v11 offset:16640
    v_mfma_f32_16x16x32_bf16 v[80:83], v[208:211], v[36:39], v[80:83]
    ds_read_b64_tr_b16 v[56:57], v12 offset:16384
    v_mfma_f32_16x16x32_bf16 v[84:87], v[208:211], v[40:43], v[84:87]
    ds_read_b64_tr_b16 v[58:59], v12 offset:16640
    v_mfma_f32_16x16x32_bf16 v[88:91], v[60:63], v[36:39], v[88:91]
    ds_read_b128 v[68:71], v19 offset:8192
    s_waitcnt lgkmcnt(5)
    v_mfma_f32_16x16x32_bf16 v[72:75], v[140:143], v[44:47], v[72:75]
    ds_read_b64_tr_b16 v[36:37], v11 offset:18432
    v_mfma_f32_16x16x32_bf16 v[76:79], v[140:143], v[48:51], v[76:79]
    ds_read_b64_tr_b16 v[38:39], v11 offset:18688
    v_mfma_f32_16x16x32_bf16 v[80:83], v[212:215], v[44:47], v[80:83]
    ds_read_b64_tr_b16 v[40:41], v12 offset:18432
    v_mfma_f32_16x16x32_bf16 v[84:87], v[212:215], v[48:51], v[84:87]
    ds_read_b64_tr_b16 v[42:43], v12 offset:18688
    v_mfma_f32_16x16x32_bf16 v[88:91], v[64:67], v[44:47], v[88:91]
    ds_read_b128 v[60:63], v19 offset:9216
    s_waitcnt lgkmcnt(5)
    v_mfma_f32_16x16x32_bf16 v[72:75], v[144:147], v[52:55], v[72:75]
    ds_read_b64_tr_b16 v[44:45], v11 offset:20480
    v_mfma_f32_16x16x32_bf16 v[76:79], v[144:147], v[56:59], v[76:79]
    ds_read_b64_tr_b16 v[46:47], v11 offset:20736
    v_mfma_f32_16x16x32_bf16 v[80:83], v[216:219], v[52:55], v[80:83]
    ds_read_b64_tr_b16 v[48:49], v12 offset:20480
    v_mfma_f32_16x16x32_bf16 v[84:87], v[216:219], v[56:59], v[84:87]
    ds_read_b64_tr_b16 v[50:51], v12 offset:20736
    v_mfma_f32_16x16x32_bf16 v[88:91], v[68:71], v[52:55], v[88:91]
    ds_read_b128 v[64:67], v19 offset:10240
    s_waitcnt lgkmcnt(5)
    v_mfma_f32_16x16x32_bf16 v[72:75], v[148:151], v[36:39], v[72:75]
    ds_read_b64_tr_b16 v[52:53], v11 offset:22528
    v_mfma_f32_16x16x32_bf16 v[76:79], v[148:151], v[40:43], v[76:79]
    ds_read_b64_tr_b16 v[54:55], v11 offset:22784
    v_mfma_f32_16x16x32_bf16 v[80:83], v[220:223], v[36:39], v[80:83]
    ds_read_b64_tr_b16 v[56:57], v12 offset:22528
    v_mfma_f32_16x16x32_bf16 v[84:87], v[220:223], v[40:43], v[84:87]
    ds_read_b64_tr_b16 v[58:59], v12 offset:22784
    v_mfma_f32_16x16x32_bf16 v[88:91], v[60:63], v[36:39], v[88:91]
    ds_read_b128 v[68:71], v19 offset:11264
    s_waitcnt lgkmcnt(5)
    v_mfma_f32_16x16x32_bf16 v[72:75], v[152:155], v[44:47], v[72:75]
    ds_read_b64_tr_b16 v[36:37], v11 offset:24576
    v_mfma_f32_16x16x32_bf16 v[76:79], v[152:155], v[48:51], v[76:79]
    ds_read_b64_tr_b16 v[38:39], v11 offset:24832
    v_mfma_f32_16x16x32_bf16 v[80:83], v[224:227], v[44:47], v[80:83]
    ds_read_b64_tr_b16 v[40:41], v12 offset:24576
    v_mfma_f32_16x16x32_bf16 v[84:87], v[224:227], v[48:51], v[84:87]
    ds_read_b64_tr_b16 v[42:43], v12 offset:24832
    v_mfma_f32_16x16x32_bf16 v[88:91], v[64:67], v[44:47], v[88:91]
    ds_read_b128 v[60:63], v19 offset:12288
    s_waitcnt lgkmcnt(5)
    v_mfma_f32_16x16x32_bf16 v[72:75], v[156:159], v[52:55], v[72:75]
    ds_read_b64_tr_b16 v[44:45], v11 offset:26624
    v_mfma_f32_16x16x32_bf16 v[76:79], v[156:159], v[56:59], v[76:79]
    ds_read_b64_tr_b16 v[46:47], v11 offset:26880
    v_mfma_f32_16x16x32_bf16 v[80:83], v[228:231], v[52:55], v[80:83]
    ds_read_b64_tr_b16 v[48:49], v12 offset:26624
    v_mfma_f32_16x16x32_bf16 v[84:87], v[228:231], v[56:59], v[84:87]
    ds_read_b64_tr_b16 v[50:51], v12 offset:26880
    v_mfma_f32_16x16x32_bf16 v[88:91], v[68:71], v[52:55], v[88:91]
    ds_read_b128 v[64:67], v19 offset:13312
    s_waitcnt lgkmcnt(5)
    v_mfma_f32_16x16x32_bf16 v[72:75], v[160:163], v[36:39], v[72:75]
    ds_read_b64_tr_b16 v[52:53], v11 offset:28672
    v_mfma_f32_16x16x32_bf16 v[76:79], v[160:163], v[40:43], v[76:79]
    ds_read_b64_tr_b16 v[54:55], v11 offset:28928
    v_mfma_f32_16x16x32_bf16 v[80:83], v[232:235], v[36:39], v[80:83]
    ds_read_b64_tr_b16 v[56:57], v12 offset:28672
    v_mfma_f32_16x16x32_bf16 v[84:87], v[232:235], v[40:43], v[84:87]
    ds_read_b64_tr_b16 v[58:59], v12 offset:28928
    v_mfma_f32_16x16x32_bf16 v[88:91], v[60:63], v[36:39], v[88:91]
    ds_read_b128 v[68:71], v19 offset:14336
    s_waitcnt lgkmcnt(5)
    v_mfma_f32_16x16x32_bf16 v[72:75], v[164:167], v[44:47], v[72:75]
    ds_read_b64_tr_b16 v[36:37], v11 offset:30720
    v_mfma_f32_16x16x32_bf16 v[76:79], v[164:167], v[48:51], v[76:79]
    ds_read_b64_tr_b16 v[38:39], v11 offset:30976
    v_mfma_f32_16x16x32_bf16 v[80:83], v[236:239], v[44:47], v[80:83]
    ds_read_b64_tr_b16 v[40:41], v12 offset:30720
    v_mfma_f32_16x16x32_bf16 v[84:87], v[236:239], v[48:51], v[84:87]
    ds_read_b64_tr_b16 v[42:43], v12 offset:30976
    v_mfma_f32_16x16x32_bf16 v[88:91], v[64:67], v[44:47], v[88:91]
    ds_read_b128 v[60:63], v19 offset:15360
    s_waitcnt lgkmcnt(5)
    v_mfma_f32_16x16x32_bf16 v[72:75], v[168:171], v[52:55], v[72:75]
    ds_read_b64_tr_b16 v[44:45], v11 offset:32768
    v_mfma_f32_16x16x32_bf16 v[76:79], v[168:171], v[56:59], v[76:79]
    ds_read_b64_tr_b16 v[46:47], v11 offset:33024
    v_mfma_f32_16x16x32_bf16 v[80:83], v[240:243], v[52:55], v[80:83]
    ds_read_b64_tr_b16 v[48:49], v12 offset:32768
    v_mfma_f32_16x16x32_bf16 v[84:87], v[240:243], v[56:59], v[84:87]
    ds_read_b64_tr_b16 v[50:51], v12 offset:33024
    v_mfma_f32_16x16x32_bf16 v[88:91], v[68:71], v[52:55], v[88:91]
    ds_read_b128 v[64:67], v19 offset:16384
    s_waitcnt lgkmcnt(5)
    v_mfma_f32_16x16x32_bf16 v[72:75], v[172:175], v[36:39], v[72:75]
    ds_read_b64_tr_b16 v[52:53], v11 offset:34816
    v_mfma_f32_16x16x32_bf16 v[76:79], v[172:175], v[40:43], v[76:79]
    ds_read_b64_tr_b16 v[54:55], v11 offset:35072
    v_mfma_f32_16x16x32_bf16 v[80:83], v[244:247], v[36:39], v[80:83]
    ds_read_b64_tr_b16 v[56:57], v12 offset:34816
    v_mfma_f32_16x16x32_bf16 v[84:87], v[244:247], v[40:43], v[84:87]
    ds_read_b64_tr_b16 v[58:59], v12 offset:35072
    v_mfma_f32_16x16x32_bf16 v[88:91], v[60:63], v[36:39], v[88:91]
    ds_read_b128 v[68:71], v19 offset:17408
    s_waitcnt lgkmcnt(5)
    v_mfma_f32_16x16x32_bf16 v[72:75], v[176:179], v[44:47], v[72:75]
    v_mfma_f32_16x16x32_bf16 v[76:79], v[176:179], v[48:51], v[76:79]
    v_mfma_f32_16x16x32_bf16 v[80:83], v[248:251], v[44:47], v[80:83]
    v_mfma_f32_16x16x32_bf16 v[84:87], v[248:251], v[48:51], v[84:87]
    v_mfma_f32_16x16x32_bf16 v[88:91], v[64:67], v[44:47], v[88:91]
    s_waitcnt lgkmcnt(0)
    v_mfma_f32_16x16x32_bf16 v[72:75], v[180:183], v[52:55], v[72:75]
    v_mfma_f32_16x16x32_bf16 v[76:79], v[180:183], v[56:59], v[76:79]
    v_mfma_f32_16x16x32_bf16 v[80:83], v[252:255], v[52:55], v[80:83]
    v_mfma_f32_16x16x32_bf16 v[84:87], v[252:255], v[56:59], v[84:87]
    v_mfma_f32_16x16x32_bf16 v[88:91], v[68:71], v[52:55], v[88:91]
    s_branch Ld_0_58
Ld_0_67:
    ds_read_b64_tr_b16 v[36:37], v11 offset:0
    ds_read_b64_tr_b16 v[38:39], v11 offset:256
    ds_read_b64_tr_b16 v[40:41], v12 offset:0
    ds_read_b64_tr_b16 v[42:43], v12 offset:256
    ds_read_b128 v[60:63], v19 offset:0
    ds_read_b64_tr_b16 v[44:45], v11 offset:2048
    ds_read_b64_tr_b16 v[46:47], v11 offset:2304
    ds_read_b64_tr_b16 v[48:49], v12 offset:2048
    ds_read_b64_tr_b16 v[50:51], v12 offset:2304
    ds_read_b128 v[64:67], v19 offset:1024
    s_waitcnt lgkmcnt(5)
    v_mfma_f32_16x16x32_bf16 v[72:75], v[112:115], v[36:39], 0
    ds_read_b64_tr_b16 v[52:53], v11 offset:4096
    v_mfma_f32_16x16x32_bf16 v[76:79], v[112:115], v[40:43], 0
    ds_read_b64_tr_b16 v[54:55], v11 offset:4352
    v_mfma_f32_16x16x32_bf16 v[80:83], v[184:187], v[36:39], 0
    ds_read_b64_tr_b16 v[56:57], v12 offset:4096
    v_mfma_f32_16x16x32_bf16 v[84:87], v[184:187], v[40:43], 0
    ds_read_b64_tr_b16 v[58:59], v12 offset:4352
    v_mfma_f32_16x16x32_bf16 v[88:91], v[60:63], v[40:43], 0
    ds_read_b128 v[68:71], v19 offset:2048
    s_waitcnt lgkmcnt(5)
    v_mfma_f32_16x16x32_bf16 v[72:75], v[116:119], v[44:47], v[72:75]
    ds_read_b64_tr_b16 v[36:37], v11 offset:6144
    v_mfma_f32_16x16x32_bf16 v[76:79], v[116:119], v[48:51], v[76:79]
    ds_read_b64_tr_b16 v[38:39], v11 offset:6400
    v_mfma_f32_16x16x32_bf16 v[80:83], v[188:191], v[44:47], v[80:83]
    ds_read_b64_tr_b16 v[40:41], v12 offset:6144
    v_mfma_f32_16x16x32_bf16 v[84:87], v[188:191], v[48:51], v[84:87]
    ds_read_b64_tr_b16 v[42:43], v12 offset:6400
    v_mfma_f32_16x16x32_bf16 v[88:91], v[64:67], v[48:51], v[88:91]
    ds_read_b128 v[60:63], v19 offset:3072
    s_waitcnt lgkmcnt(5)
    v_mfma_f32_16x16x32_bf16 v[72:75], v[120:123], v[52:55], v[72:75]
    ds_read_b64_tr_b16 v[44:45], v11 offset:8192
    v_mfma_f32_16x16x32_bf16 v[76:79], v[120:123], v[56:59], v[76:79]
    ds_read_b64_tr_b16 v[46:47], v11 offset:8448
    v_mfma_f32_16x16x32_bf16 v[80:83], v[192:195], v[52:55], v[80:83]
    ds_read_b64_tr_b16 v[48:49], v12 offset:8192
    v_mfma_f32_16x16x32_bf16 v[84:87], v[192:195], v[56:59], v[84:87]
    ds_read_b64_tr_b16 v[50:51], v12 offset:8448
    v_mfma_f32_16x16x32_bf16 v[88:91], v[68:71], v[56:59], v[88:91]
    ds_read_b128 v[64:67], v19 offset:4096
    s_waitcnt lgkmcnt(5)
    v_mfma_f32_16x16x32_bf16 v[72:75], v[124:127], v[36:39], v[72:75]
    ds_read_b64_tr_b16 v[52:53], v11 offset:10240
    v_mfma_f32_16x16x32_bf16 v[76:79], v[124:127], v[40:43], v[76:79]
    ds_read_b64_tr_b16 v[54:55], v11 offset:10496
    v_mfma_f32_16x16x32_bf16 v[80:83], v[196:199], v[36:39], v[80:83]
    ds_read_b64_tr_b16 v[56:57], v12 offset:10240
    v_mfma_f32_16x16x32_bf16 v[84:87], v[196:199], v[40:43], v[84:87]
    ds_read_b64_tr_b16 v[58:59], v12 offset:10496
    v_mfma_f32_16x16x32_bf16 v[88:91], v[60:63], v[40:43], v[88:91]
    ds_read_b128 v[68:71], v19 offset:5120
    s_waitcnt lgkmcnt(5)
    v_mfma_f32_16x16x32_bf16 v[72:75], v[128:131], v[44:47], v[72:75]
    ds_read_b64_tr_b16 v[36:37], v11 offset:12288
    v_mfma_f32_16x16x32_bf16 v[76:79], v[128:131], v[48:51], v[76:79]
    ds_read_b64_tr_b16 v[38:39], v11 offset:12544
    v_mfma_f32_16x16x32_bf16 v[80:83], v[200:203], v[44:47], v[80:83]
    ds_read_b64_tr_b16 v[40:41], v12 offset:12288
    v_mfma_f32_16x16x32_bf16 v[84:87], v[200:203], v[48:51], v[84:87]
    ds_read_b64_tr_b16 v[42:43], v12 offset:12544
    v_mfma_f32_16x16x32_bf16 v[88:91], v[64:67], v[48:51], v[88:91]
    ds_read_b128 v[60:63], v19 offset:6144
    s_waitcnt lgkmcnt(5)
    v_mfma_f32_16x16x32_bf16 v[72:75], v[132:135], v[52:55], v[72:75]
    ds_read_b64_tr_b16 v[44:45], v11 offset:14336
    v_mfma_f32_16x16x32_bf16 v[76:79], v[132:135], v[56:59], v[76:79]
    ds_read_b64_tr_b16 v[46:47], v11 offset:14592
    v_mfma_f32_16x16x32_bf16 v[80:83], v[204:207], v[52:55], v[80:83]
    ds_read_b64_tr_b16 v[48:49], v12 offset:14336
    v_mfma_f32_16x16x32_bf16 v[84:87], v[204:207], v[56:59], v[84:87]
    ds_read_b64_tr_b16 v[50:51], v12 offset:14592
    v_mfma_f32_16x16x32_bf16 v[88:91], v[68:71], v[56:59], v[88:91]
    ds_read_b128 v[64:67], v19 offset:7168
    s_waitcnt lgkmcnt(5)
    v_mfma_f32_16x16x32_bf16 v[72:75], v[136:139], v[36:39], v[72:75]
    ds_read_b64_tr_b16 v[52:53], v11 offset:16384
    v_mfma_f32_16x16x32_bf16 v[76:79], v[136:139], v[40:43], v[76:79]
    ds_read_b64_tr_b16 v[54:55], v11 offset:16640
    v_mfma_f32_16x16x32_bf16 v[80:83], v[208:211], v[36:39], v[80:83]
    ds_read_b64_tr_b16 v[56:57], v12 offset:16384
    v_mfma_f32_16x16x32_bf16 v[84:87], v[208:211], v[40:43], v[84:87]
    ds_read_b64_tr_b16 v[58:59], v12 offset:16640
    v_mfma_f32_16x16x32_bf16 v[88:91], v[60:63], v[40:43], v[88:91]
    ds_read_b128 v[68:71], v19 offset:8192
    s_waitcnt lgkmcnt(5)
    v_mfma_f32_16x16x32_bf16 v[72:75], v[140:143], v[44:47], v[72:75]
    ds_read_b64_tr_b16 v[36:37], v11 offset:18432
    v_mfma_f32_16x16x32_bf16 v[76:79], v[140:143], v[48:51], v[76:79]
    ds_read_b64_tr_b16 v[38:39], v11 offset:18688
    v_mfma_f32_16x16x32_bf16 v[80:83], v[212:215], v[44:47], v[80:83]
    ds_read_b64_tr_b16 v[40:41], v12 offset:18432
    v_mfma_f32_16x16x32_bf16 v[84:87], v[212:215], v[48:51], v[84:87]
    ds_read_b64_tr_b16 v[42:43], v12 offset:18688
    v_mfma_f32_16x16x32_bf16 v[88:91], v[64:67], v[48:51], v[88:91]
    ds_read_b128 v[60:63], v19 offset:9216
    s_waitcnt lgkmcnt(5)
    v_mfma_f32_16x16x32_bf16 v[72:75], v[144:147], v[52:55], v[72:75]
    ds_read_b64_tr_b16 v[44:45], v11 offset:20480
    v_mfma_f32_16x16x32_bf16 v[76:79], v[144:147], v[56:59], v[76:79]
    ds_read_b64_tr_b16 v[46:47], v11 offset:20736
    v_mfma_f32_16x16x32_bf16 v[80:83], v[216:219], v[52:55], v[80:83]
    ds_read_b64_tr_b16 v[48:49], v12 offset:20480
    v_mfma_f32_16x16x32_bf16 v[84:87], v[216:219], v[56:59], v[84:87]
    ds_read_b64_tr_b16 v[50:51], v12 offset:20736
    v_mfma_f32_16x16x32_bf16 v[88:91], v[68:71], v[56:59], v[88:91]
    ds_read_b128 v[64:67], v19 offset:10240
    s_waitcnt lgkmcnt(5)
    v_mfma_f32_16x16x32_bf16 v[72:75], v[148:151], v[36:39], v[72:75]
    ds_read_b64_tr_b16 v[52:53], v11 offset:22528
    v_mfma_f32_16x16x32_bf16 v[76:79], v[148:151], v[40:43], v[76:79]
    ds_read_b64_tr_b16 v[54:55], v11 offset:22784
    v_mfma_f32_16x16x32_bf16 v[80:83], v[220:223], v[36:39], v[80:83]
    ds_read_b64_tr_b16 v[56:57], v12 offset:22528
    v_mfma_f32_16x16x32_bf16 v[84:87], v[220:223], v[40:43], v[84:87]
    ds_read_b64_tr_b16 v[58:59], v12 offset:22784
    v_mfma_f32_16x16x32_bf16 v[88:91], v[60:63], v[40:43], v[88:91]
    ds_read_b128 v[68:71], v19 offset:11264
    s_waitcnt lgkmcnt(5)
    v_mfma_f32_16x16x32_bf16 v[72:75], v[152:155], v[44:47], v[72:75]
    ds_read_b64_tr_b16 v[36:37], v11 offset:24576
    v_mfma_f32_16x16x32_bf16 v[76:79], v[152:155], v[48:51], v[76:79]
    ds_read_b64_tr_b16 v[38:39], v11 offset:24832
    v_mfma_f32_16x16x32_bf16 v[80:83], v[224:227], v[44:47], v[80:83]
    ds_read_b64_tr_b16 v[40:41], v12 offset:24576
    v_mfma_f32_16x16x32_bf16 v[84:87], v[224:227], v[48:51], v[84:87]
    ds_read_b64_tr_b16 v[42:43], v12 offset:24832
    v_mfma_f32_16x16x32_bf16 v[88:91], v[64:67], v[48:51], v[88:91]
    ds_read_b128 v[60:63], v19 offset:12288
    s_waitcnt lgkmcnt(5)
    v_mfma_f32_16x16x32_bf16 v[72:75], v[156:159], v[52:55], v[72:75]
    ds_read_b64_tr_b16 v[44:45], v11 offset:26624
    v_mfma_f32_16x16x32_bf16 v[76:79], v[156:159], v[56:59], v[76:79]
    ds_read_b64_tr_b16 v[46:47], v11 offset:26880
    v_mfma_f32_16x16x32_bf16 v[80:83], v[228:231], v[52:55], v[80:83]
    ds_read_b64_tr_b16 v[48:49], v12 offset:26624
    v_mfma_f32_16x16x32_bf16 v[84:87], v[228:231], v[56:59], v[84:87]
    ds_read_b64_tr_b16 v[50:51], v12 offset:26880
    v_mfma_f32_16x16x32_bf16 v[88:91], v[68:71], v[56:59], v[88:91]
    ds_read_b128 v[64:67], v19 offset:13312
    s_waitcnt lgkmcnt(5)
    v_mfma_f32_16x16x32_bf16 v[72:75], v[160:163], v[36:39], v[72:75]
    ds_read_b64_tr_b16 v[52:53], v11 offset:28672
    v_mfma_f32_16x16x32_bf16 v[76:79], v[160:163], v[40:43], v[76:79]
    ds_read_b64_tr_b16 v[54:55], v11 offset:28928
    v_mfma_f32_16x16x32_bf16 v[80:83], v[232:235], v[36:39], v[80:83]
    ds_read_b64_tr_b16 v[56:57], v12 offset:28672
    v_mfma_f32_16x16x32_bf16 v[84:87], v[232:235], v[40:43], v[84:87]
    ds_read_b64_tr_b16 v[58:59], v12 offset:28928
    v_mfma_f32_16x16x32_bf16 v[88:91], v[60:63], v[40:43], v[88:91]
    ds_read_b128 v[68:71], v19 offset:14336
    s_waitcnt lgkmcnt(5)
    v_mfma_f32_16x16x32_bf16 v[72:75], v[164:167], v[44:47], v[72:75]
    ds_read_b64_tr_b16 v[36:37], v11 offset:30720
    v_mfma_f32_16x16x32_bf16 v[76:79], v[164:167], v[48:51], v[76:79]
    ds_read_b64_tr_b16 v[38:39], v11 offset:30976
    v_mfma_f32_16x16x32_bf16 v[80:83], v[236:239], v[44:47], v[80:83]
    ds_read_b64_tr_b16 v[40:41], v12 offset:30720
    v_mfma_f32_16x16x32_bf16 v[84:87], v[236:239], v[48:51], v[84:87]
    ds_read_b64_tr_b16 v[42:43], v12 offset:30976
    v_mfma_f32_16x16x32_bf16 v[88:91], v[64:67], v[48:51], v[88:91]
    ds_read_b128 v[60:63], v19 offset:15360
    s_waitcnt lgkmcnt(5)
    v_mfma_f32_16x16x32_bf16 v[72:75], v[168:171], v[52:55], v[72:75]
    ds_read_b64_tr_b16 v[44:45], v11 offset:32768
    v_mfma_f32_16x16x32_bf16 v[76:79], v[168:171], v[56:59], v[76:79]
    ds_read_b64_tr_b16 v[46:47], v11 offset:33024
    v_mfma_f32_16x16x32_bf16 v[80:83], v[240:243], v[52:55], v[80:83]
    ds_read_b64_tr_b16 v[48:49], v12 offset:32768
    v_mfma_f32_16x16x32_bf16 v[84:87], v[240:243], v[56:59], v[84:87]
    ds_read_b64_tr_b16 v[50:51], v12 offset:33024
    v_mfma_f32_16x16x32_bf16 v[88:91], v[68:71], v[56:59], v[88:91]
    ds_read_b128 v[64:67], v19 offset:16384
    s_waitcnt lgkmcnt(5)
    v_mfma_f32_16x16x32_bf16 v[72:75], v[172:175], v[36:39], v[72:75]
    ds_read_b64_tr_b16 v[52:53], v11 offset:34816
    v_mfma_f32_16x16x32_bf16 v[76:79], v[172:175], v[40:43], v[76:79]
    ds_read_b64_tr_b16 v[54:55], v11 offset:35072
    v_mfma_f32_16x16x32_bf16 v[80:83], v[244:247], v[36:39], v[80:83]
    ds_read_b64_tr_b16 v[56:57], v12 offset:34816
    v_mfma_f32_16x16x32_bf16 v[84:87], v[244:247], v[40:43], v[84:87]
    ds_read_b64_tr_b16 v[58:59], v12 offset:35072
    v_mfma_f32_16x16x32_bf16 v[88:91], v[60:63], v[40:43], v[88:91]
    ds_read_b128 v[68:71], v19 offset:17408
    s_waitcnt lgkmcnt(5)
    v_mfma_f32_16x16x32_bf16 v[72:75], v[176:179], v[44:47], v[72:75]
    v_mfma_f32_16x16x32_bf16 v[76:79], v[176:179], v[48:51], v[76:79]
    v_mfma_f32_16x16x32_bf16 v[80:83], v[248:251], v[44:47], v[80:83]
    v_mfma_f32_16x16x32_bf16 v[84:87], v[248:251], v[48:51], v[84:87]
    v_mfma_f32_16x16x32_bf16 v[88:91], v[64:67], v[48:51], v[88:91]
    s_waitcnt lgkmcnt(0)
    v_mfma_f32_16x16x32_bf16 v[72:75], v[180:183], v[52:55], v[72:75]
    v_mfma_f32_16x16x32_bf16 v[76:79], v[180:183], v[56:59], v[76:79]
    v_mfma_f32_16x16x32_bf16 v[80:83], v[252:255], v[52:55], v[80:83]
    v_mfma_f32_16x16x32_bf16 v[84:87], v[252:255], v[56:59], v[84:87]
    v_mfma_f32_16x16x32_bf16 v[88:91], v[68:71], v[56:59], v[88:91]
    s_branch Ld_0_58
Ld_0_56:
    s_cmp_lt_u32 s24, 6
    s_cbranch_scc1 Ld_0_68
    s_setprio 1
    ds_read_b64_tr_b16 v[36:37], v14 offset:0
    ds_read_b64_tr_b16 v[38:39], v14 offset:256
    ds_read_b64_tr_b16 v[40:41], v14 offset:2048
    ds_read_b64_tr_b16 v[42:43], v14 offset:2304
    ds_read_b64_tr_b16 v[44:45], v14 offset:4096
    ds_read_b64_tr_b16 v[46:47], v14 offset:4352
    ds_read_b64_tr_b16 v[48:49], v14 offset:6144
    ds_read_b64_tr_b16 v[50:51], v14 offset:6400
    ds_read_b64_tr_b16 v[52:53], v14 offset:8192
    ds_read_b64_tr_b16 v[54:55], v14 offset:8448
    s_waitcnt lgkmcnt(8)
    v_mfma_f32_16x16x32_bf16 v[20:23], v[104:107], v[36:39], 0
    v_mfma_f32_16x16x32_bf16 v[24:27], v[36:39], v[36:39], 0
    ds_read_b64_tr_b16 v[56:57], v14 offset:10240
    ds_read_b64_tr_b16 v[58:59], v14 offset:10496
    s_waitcnt lgkmcnt(8)
    v_mfma_f32_16x16x32_bf16 v[20:23], v[104:107], v[40:43], v[20:23]
    v_mfma_f32_16x16x32_bf16 v[24:27], v[40:43], v[40:43], v[24:27]
    ds_read_b64_tr_b16 v[36:37], v14 offset:12288
    ds_read_b64_tr_b16 v[38:39], v14 offset:12544
    s_waitcnt lgkmcnt(8)
    v_mfma_f32_16x16x32_bf16 v[20:23], v[104:107], v[44:47], v[20:23]
    v_mfma_f32_16x16x32_bf16 v[24:27], v[44:47], v[44:47], v[24:27]
    ds_read_b64_tr_b16 v[40:41], v14 offset:14336
    ds_read_b64_tr_b16 v[42:43], v14 offset:14592
    s_waitcnt lgkmcnt(8)
    v_mfma_f32_16x16x32_bf16 v[20:23], v[104:107], v[48:51], v[20:23]
    v_mfma_f32_16x16x32_bf16 v[24:27], v[48:51], v[48:51], v[24:27]
    ds_read_b64_tr_b16 v[44:45], v14 offset:16384
    ds_read_b64_tr_b16 v[46:47], v14 offset:16640
    s_waitcnt lgkmcnt(8)
    v_mfma_f32_16x16x32_bf16 v[20:23], v[104:107], v[52:55], v[20:23]
    v_mfma_f32_16x16x32_bf16 v[24:27], v[52:55], v[52:55], v[24:27]
    ds_read_b64_tr_b16 v[48:49], v14 offset:18432
    ds_read_b64_tr_b16 v[50:51], v14 offset:18688
    s_waitcnt lgkmcnt(8)
    v_mfma_f32_16x16x32_bf16 v[20:23], v[104:107], v[56:59], v[20:23]
    v_mfma_f32_16x16x32_bf16 v[24:27], v[56:59], v[56:59], v[24:27]
    ds_read_b64_tr_b16 v[52:53], v14 offset:20480
    ds_read_b64_tr_b16 v[54:55], v14 offset:20736
    s_waitcnt lgkmcnt(8)
    v_mfma_f32_16x16x32_bf16 v[20:23], v[104:107], v[36:39], v[20:23]
    v_mfma_f32_16x16x32_bf16 v[24:27], v[36:39], v[36:39], v[24:27]
    ds_read_b64_tr_b16 v[56:57], v14 offset:22528
    ds_read_b64_tr_b16 v[58:59], v14 offset:22784
    s_waitcnt lgkmcnt(8)
    v_mfma_f32_16x16x32_bf16 v[20:23], v[104:107], v[40:43], v[20:23]
    v_mfma_f32_16x16x32_bf16 v[24:27], v[40:43], v[40:43], v[24:27]
    ds_read_b64_tr_b16 v[36:37], v14 offset:24576
    ds_read_b64_tr_b16 v[38:39], v14 offset:24832
    s_waitcnt lgkmcnt(8)
    v_mfma_f32_16x16x32_bf16 v[20:23], v[104:107], v[44:47], v[20:23]
    v_mfma_f32_16x16x32_bf16 v[24:27], v[44:47], v[44:47], v[24:27]
    ds_read_b64_tr_b16 v[40:41], v14 offset:26624
    ds_read_b64_tr_b16 v[42:43], v14 offset:26880
    s_waitcnt lgkmcnt(8)
    v_mfma_f32_16x16x32_bf16 v[20:23], v[104:107], v[48:51], v[20:23]
    v_mfma_f32_16x16x32_bf16 v[24:27], v[48:51], v[48:51], v[24:27]
    ds_read_b64_tr_b16 v[44:45], v14 offset:28672
    ds_read_b64_tr_b16 v[46:47], v14 offset:28928
    s_waitcnt lgkmcnt(8)
    v_mfma_f32_16x16x32_bf16 v[20:23], v[104:107], v[52:55], v[20:23]
    v_mfma_f32_16x16x32_bf16 v[24:27], v[52:55], v[52:55], v[24:27]
    ds_read_b64_tr_b16 v[48:49], v14 offset:30720
    ds_read_b64_tr_b16 v[50:51], v14 offset:30976
    s_waitcnt lgkmcnt(8)
    v_mfma_f32_16x16x32_bf16 v[20:23], v[104:107], v[56:59], v[20:23]
    v_mfma_f32_16x16x32_bf16 v[24:27], v[56:59], v[56:59], v[24:27]
    ds_read_b64_tr_b16 v[52:53], v14 offset:32768
    ds_read_b64_tr_b16 v[54:55], v14 offset:33024
    s_waitcnt lgkmcnt(8)
    v_mfma_f32_16x16x32_bf16 v[20:23], v[104:107], v[36:39], v[20:23]
    v_mfma_f32_16x16x32_bf16 v[24:27], v[36:39], v[36:39], v[24:27]
    ds_read_b64_tr_b16 v[56:57], v14 offset:34816
    ds_read_b64_tr_b16 v[58:59], v14 offset:35072
    s_waitcnt lgkmcnt(8)
    v_mfma_f32_16x16x32_bf16 v[20:23], v[104:107], v[40:43], v[20:23]
    v_mfma_f32_16x16x32_bf16 v[24:27], v[40:43], v[40:43], v[24:27]
    s_waitcnt lgkmcnt(6)
    v_mfma_f32_16x16x32_bf16 v[20:23], v[104:107], v[44:47], v[20:23]
    v_mfma_f32_16x16x32_bf16 v[24:27], v[44:47], v[44:47], v[24:27]
    s_waitcnt lgkmcnt(4)
    v_mfma_f32_16x16x32_bf16 v[20:23], v[104:107], v[48:51], v[20:23]
    v_mfma_f32_16x16x32_bf16 v[24:27], v[48:51], v[48:51], v[24:27]
    s_waitcnt lgkmcnt(2)
    v_mfma_f32_16x16x32_bf16 v[20:23], v[104:107], v[52:55], v[20:23]
    v_mfma_f32_16x16x32_bf16 v[24:27], v[52:55], v[52:55], v[24:27]
    s_waitcnt lgkmcnt(0)
    v_mfma_f32_16x16x32_bf16 v[20:23], v[104:107], v[56:59], v[20:23]
    v_mfma_f32_16x16x32_bf16 v[24:27], v[56:59], v[56:59], v[24:27]
    v_cmp_eq_u32 s[40:41], 1, v8
    v_cmp_eq_u32 s[42:43], 2, v8
    v_cmp_eq_u32 s[44:45], 3, v8
    v_lshrrev_b32 v16, 2, v4
    v_cmp_eq_u32 s[46:47], v16, v5
    s_nop 2
    v_cndmask_b32 v21, v24, v25, s[40:41]
    v_cndmask_b32 v21, v21, v26, s[42:43]
    v_cndmask_b32 v21, v21, v27, s[44:45]
    v_mul_f32 v20, 0x3ae38e39, v20
    v_mul_f32 v21, 0x3ae38e39, v21
    v_fma_f32 v21, -v20, v20, v21
    v_max_f32 v21, 0, v21
    v_cvt_pk_bf16_f32 v22, v20, v20
    v_and_b32 v22, 0xffff0000, v22
    v_cvt_pk_bf16_f32 v27, v21, v21
    v_and_b32 v27, 0xffff0000, v27
    v_add_f32 v27, 0x3727c5ac, v27
    v_cvt_pk_bf16_f32 v27, v27, v27
    v_and_b32 v27, 0xffff0000, v27
    v_sqrt_f32 v27, v27
    s_nop 0
    v_cvt_pk_bf16_f32 v27, v27, v27
    v_and_b32 v27, 0xffff0000, v27
    v_rcp_f32 v27, v27
    v_sub_f32 v28, v20, v22
    v_mul_f32 v28, v28, v27
    v_mul_f32 v29, v21, v27
    v_mul_f32 v29, v29, v27
    v_cvt_pk_bf16_f32 v28, v28, v28
    v_and_b32 v28, 0xffff0000, v28
    v_cvt_pk_bf16_f32 v29, v29, v29
    v_and_b32 v29, 0xffff0000, v29
    v_add_f32 v29, 0x3727c5ac, v29
    v_cvt_pk_bf16_f32 v29, v29, v29
    v_and_b32 v29, 0xffff0000, v29
    v_sqrt_f32 v29, v29
    s_nop 0
    v_cvt_pk_bf16_f32 v29, v29, v29
    v_and_b32 v29, 0xffff0000, v29
    v_rcp_f32 v29, v29
    v_fma_f32 v28, v22, v27, v28
    v_sub_f32 v26, 0, v22
    v_mul_f32 v24, v27, v29
    v_mul_f32 v25, v28, v29
    v_add_u32 v16, s21, v13
    s_mov_b64 exec, s[46:47]
    ds_write_b128 v16, v[24:27] offset:36864
    s_mov_b64 exec, -1
    s_setprio 0
    s_waitcnt lgkmcnt(0)
Ld_0_68:
    s_bfe_u32 s60, s2, 0x20003
    s_mul_i32 s60, s60, 165888
    s_and_b32 s61, s24, 3
    s_mul_i32 s61, s61, 36864
    s_add_u32 s60, s60, s61
    s_cmp_ge_u32 s24, 4
    s_cselect_b32 s61, 663552, 0
    s_add_u32 s60, s60, s61
    s_add_u32 s60, s60, 8224768
    s_add_u32 s61, s60, 16384
    buffer_load_dwordx4 v[176:179], v3, s[8:11], s61 offen offset:0 sc1
    buffer_load_dwordx4 v[180:183], v3, s[8:11], s61 offen offset:1024 sc1
    buffer_load_dwordx4 v[184:187], v3, s[8:11], s61 offen offset:2048 sc1
    buffer_load_dwordx4 v[188:191], v3, s[8:11], s61 offen offset:3072 sc1
    s_add_u32 s61, s60, 20480
    buffer_load_dwordx4 v[192:195], v3, s[8:11], s61 offen offset:0 sc1
    buffer_load_dwordx4 v[196:199], v3, s[8:11], s61 offen offset:1024 sc1
    buffer_load_dwordx4 v[200:203], v3, s[8:11], s61 offen offset:2048 sc1
    buffer_load_dwordx4 v[204:207], v3, s[8:11], s61 offen offset:3072 sc1
    s_add_u32 s61, s60, 24576
    buffer_load_dwordx4 v[208:211], v3, s[8:11], s61 offen offset:0 sc1
    buffer_load_dwordx4 v[212:215], v3, s[8:11], s61 offen offset:1024 sc1
    buffer_load_dwordx4 v[216:219], v3, s[8:11], s61 offen offset:2048 sc1
    buffer_load_dwordx4 v[220:223], v3, s[8:11], s61 offen offset:3072 sc1
    s_add_u32 s61, s60, 28672
    buffer_load_dwordx4 v[224:227], v3, s[8:11], s61 offen offset:0 sc1
    buffer_load_dwordx4 v[228:231], v3, s[8:11], s61 offen offset:1024 sc1
    buffer_load_dwordx4 v[232:235], v3, s[8:11], s61 offen offset:2048 sc1
    buffer_load_dwordx4 v[236:239], v3, s[8:11], s61 offen offset:3072 sc1
    s_add_u32 s61, s60, 32768
    buffer_load_dwordx4 v[240:243], v3, s[8:11], s61 offen offset:0 sc1
    buffer_load_dwordx4 v[244:247], v3, s[8:11], s61 offen offset:1024 sc1
    buffer_load_dwordx4 v[248:251], v3, s[8:11], s61 offen offset:2048 sc1
    buffer_load_dwordx4 v[252:255], v3, s[8:11], s61 offen offset:3072 sc1
Ld_0_58:
    s_barrier
    ds_read_b128 v[20:23], v13 offset:36864
    ds_read_b128 v[24:27], v13 offset:37120
    s_cmp_ge_u32 s24, 4
    s_cbranch_scc1 Ld_0_59
    s_add_u32 s22, s36, 25055232
    s_waitcnt lgkmcnt(0)
    v_mul_f32 v72, v72, v20
    v_mul_f32 v73, v73, v20
    v_mul_f32 v74, v74, v20
    v_mul_f32 v75, v75, v20
    v_fma_f32 v72, -v21, v92, v72
    v_fma_f32 v73, -v21, v93, v73
    v_fma_f32 v74, -v21, v94, v74
    v_fma_f32 v75, -v21, v95, v75
    v_mul_f32 v76, v76, v24
    v_mul_f32 v77, v77, v24
    v_mul_f32 v78, v78, v24
    v_mul_f32 v79, v79, v24
    v_fma_f32 v76, -v25, v92, v76
    v_fma_f32 v77, -v25, v93, v77
    v_fma_f32 v78, -v25, v94, v78
    v_fma_f32 v79, -v25, v95, v79
    v_mul_f32 v36, v72, v72
    v_mul_f32 v37, v73, v73
    v_mul_f32 v38, v74, v74
    v_mul_f32 v39, v75, v75
    v_mul_f32 v40, v76, v76
    v_mul_f32 v41, v77, v77
    v_mul_f32 v42, v78, v78
    v_mul_f32 v43, v79, v79
    v_fma_f32 v36, v36, s28, v18
    v_fma_f32 v37, v37, s28, v18
    v_fma_f32 v38, v38, s28, v18
    v_fma_f32 v39, v39, s28, v18
    v_fma_f32 v40, v40, s28, v18
    v_fma_f32 v41, v41, s28, v18
    v_fma_f32 v42, v42, s28, v18
    v_fma_f32 v43, v43, s28, v18
    v_mul_f32 v36, v36, v72
    v_mul_f32 v37, v37, v73
    v_mul_f32 v38, v38, v74
    v_mul_f32 v39, v39, v75
    v_mul_f32 v40, v40, v76
    v_mul_f32 v41, v41, v77
    v_mul_f32 v42, v42, v78
    v_mul_f32 v43, v43, v79
    v_exp_f32 v36, v36
    v_exp_f32 v37, v37
    v_exp_f32 v38, v38
    v_exp_f32 v39, v39
    v_exp_f32 v40, v40
    v_exp_f32 v41, v41
    v_exp_f32 v42, v42
    v_exp_f32 v43, v43
    v_add_f32 v36, 1.0, v36
    v_add_f32 v37, 1.0, v37
    v_add_f32 v38, 1.0, v38
    v_add_f32 v39, 1.0, v39
    v_add_f32 v40, 1.0, v40
    v_add_f32 v41, 1.0, v41
    v_add_f32 v42, 1.0, v42
    v_add_f32 v43, 1.0, v43
    v_rcp_f32 v36, v36
    v_rcp_f32 v37, v37
    v_rcp_f32 v38, v38
    v_rcp_f32 v39, v39
    v_rcp_f32 v40, v40
    v_rcp_f32 v41, v41
    v_rcp_f32 v42, v42
    v_rcp_f32 v43, v43
    v_mul_f32 v72, v72, v36
    v_mul_f32 v73, v73, v37
    v_mul_f32 v74, v74, v38
    v_mul_f32 v75, v75, v39
    v_mul_f32 v76, v76, v40
    v_mul_f32 v77, v77, v41
    v_mul_f32 v78, v78, v42
    v_mul_f32 v79, v79, v43
    v_cvt_pk_bf16_f32 v72, v72, v73
    v_cvt_pk_bf16_f32 v73, v74, v75
    v_cvt_pk_bf16_f32 v74, v76, v77
    v_cvt_pk_bf16_f32 v75, v78, v79
    s_nop 0
    v_permlane16_swap_b32 v72, v74
    v_permlane16_swap_b32 v73, v75
    buffer_store_dwordx4 v[72:75], v3, s[8:11], s22 offen offset:0 sc1
    v_mul_f32 v80, v80, v20
    v_mul_f32 v81, v81, v20
    v_mul_f32 v82, v82, v20
    v_mul_f32 v83, v83, v20
    v_fma_f32 v80, -v21, v96, v80
    v_fma_f32 v81, -v21, v97, v81
    v_fma_f32 v82, -v21, v98, v82
    v_fma_f32 v83, -v21, v99, v83
    v_mul_f32 v84, v84, v24
    v_mul_f32 v85, v85, v24
    v_mul_f32 v86, v86, v24
    v_mul_f32 v87, v87, v24
    v_fma_f32 v84, -v25, v96, v84
    v_fma_f32 v85, -v25, v97, v85
    v_fma_f32 v86, -v25, v98, v86
    v_fma_f32 v87, -v25, v99, v87
    v_mul_f32 v36, v80, v80
    v_mul_f32 v37, v81, v81
    v_mul_f32 v38, v82, v82
    v_mul_f32 v39, v83, v83
    v_mul_f32 v40, v84, v84
    v_mul_f32 v41, v85, v85
    v_mul_f32 v42, v86, v86
    v_mul_f32 v43, v87, v87
    v_fma_f32 v36, v36, s28, v18
    v_fma_f32 v37, v37, s28, v18
    v_fma_f32 v38, v38, s28, v18
    v_fma_f32 v39, v39, s28, v18
    v_fma_f32 v40, v40, s28, v18
    v_fma_f32 v41, v41, s28, v18
    v_fma_f32 v42, v42, s28, v18
    v_fma_f32 v43, v43, s28, v18
    v_mul_f32 v36, v36, v80
    v_mul_f32 v37, v37, v81
    v_mul_f32 v38, v38, v82
    v_mul_f32 v39, v39, v83
    v_mul_f32 v40, v40, v84
    v_mul_f32 v41, v41, v85
    v_mul_f32 v42, v42, v86
    v_mul_f32 v43, v43, v87
    v_exp_f32 v36, v36
    v_exp_f32 v37, v37
    v_exp_f32 v38, v38
    v_exp_f32 v39, v39
    v_exp_f32 v40, v40
    v_exp_f32 v41, v41
    v_exp_f32 v42, v42
    v_exp_f32 v43, v43
    v_add_f32 v36, 1.0, v36
    v_add_f32 v37, 1.0, v37
    v_add_f32 v38, 1.0, v38
    v_add_f32 v39, 1.0, v39
    v_add_f32 v40, 1.0, v40
    v_add_f32 v41, 1.0, v41
    v_add_f32 v42, 1.0, v42
    v_add_f32 v43, 1.0, v43
    v_rcp_f32 v36, v36
    v_rcp_f32 v37, v37
    v_rcp_f32 v38, v38
    v_rcp_f32 v39, v39
    v_rcp_f32 v40, v40
    v_rcp_f32 v41, v41
    v_rcp_f32 v42, v42
    v_rcp_f32 v43, v43
    v_mul_f32 v80, v80, v36
    v_mul_f32 v81, v81, v37
    v_mul_f32 v82, v82, v38
    v_mul_f32 v83, v83, v39
    v_mul_f32 v84, v84, v40
    v_mul_f32 v85, v85, v41
    v_mul_f32 v86, v86, v42
    v_mul_f32 v87, v87, v43
    v_cvt_pk_bf16_f32 v80, v80, v81
    v_cvt_pk_bf16_f32 v81, v82, v83
    v_cvt_pk_bf16_f32 v82, v84, v85
    v_cvt_pk_bf16_f32 v83, v86, v87
    s_nop 0
    v_permlane16_swap_b32 v80, v82
    v_permlane16_swap_b32 v81, v83
    buffer_store_dwordx4 v[80:83], v3, s[8:11], s22 offen offset:1024 sc1
    s_cmp_ge_u32 s24, 2
    s_cbranch_scc1 Ld_0_62
    s_bitcmp1_b32 s24, 0
    s_cselect_b64 vcc, -1, 0
    v_cndmask_b32 v28, v20, v24, vcc
    v_cndmask_b32 v29, v21, v25, vcc
    s_add_u32 s22, s37, 25055232
    v_mul_f32 v88, v88, v28
    v_mul_f32 v89, v89, v28
    v_mul_f32 v90, v90, v28
    v_mul_f32 v91, v91, v28
    v_fma_f32 v88, -v29, v100, v88
    v_fma_f32 v89, -v29, v101, v89
    v_fma_f32 v90, -v29, v102, v90
    v_fma_f32 v91, -v29, v103, v91
    v_mul_f32 v36, v88, v88
    v_mul_f32 v37, v89, v89
    v_mul_f32 v38, v90, v90
    v_mul_f32 v39, v91, v91
    v_fma_f32 v36, v36, s28, v18
    v_fma_f32 v37, v37, s28, v18
    v_fma_f32 v38, v38, s28, v18
    v_fma_f32 v39, v39, s28, v18
    v_mul_f32 v36, v36, v88
    v_mul_f32 v37, v37, v89
    v_mul_f32 v38, v38, v90
    v_mul_f32 v39, v39, v91
    v_exp_f32 v36, v36
    v_exp_f32 v37, v37
    v_exp_f32 v38, v38
    v_exp_f32 v39, v39
    v_add_f32 v36, 1.0, v36
    v_add_f32 v37, 1.0, v37
    v_add_f32 v38, 1.0, v38
    v_add_f32 v39, 1.0, v39
    v_rcp_f32 v36, v36
    v_rcp_f32 v37, v37
    v_rcp_f32 v38, v38
    v_rcp_f32 v39, v39
    v_mul_f32 v88, v88, v36
    v_mul_f32 v89, v89, v37
    v_mul_f32 v90, v90, v38
    v_mul_f32 v91, v91, v39
    v_cvt_pk_bf16_f32 v88, v88, v89
    v_cvt_pk_bf16_f32 v89, v90, v91
    buffer_store_dwordx2 v[88:89], v7, s[8:11], s22 offen sc1
Ld_0_62:
    s_lshr_b32 s16, s24, 1
    s_lshr_b32 s23, s16, 1
    s_add_u32 s23, s23, 1
    s_sub_u32 s17, 0, s23
    s_bitcmp1_b32 s16, 0
    s_cselect_b32 s23, s23, s17
    s_lshl_b32 s17, s12, 5
    s_add_u32 s23, s23, s17
    v_and_b32 v6, 31, v1
    v_add_u32 v6, s23, v6
    s_movk_i32 s17, 0x800
    v_cmp_gt_u32 vcc, s17, v6
    v_lshrrev_b32 v16, 5, v6
    s_mov_b32 s17, 36864
    v_mul_lo_u32 v16, v16, s17
    v_and_b32 v6, 31, v6
    v_lshl_add_u32 v6, v6, 4, v16
    v_and_b32 v16, 32, v1
    v_lshl_add_u32 v6, v16, 4, v6
    v_mov_b32 v16, 0x40000000
    v_cndmask_b32 v6, v16, v6, vcc
    s_mul_i32 s18, s16, 9
    s_and_b32 s17, s24, 1
    s_mul_i32 s17, s17, 5
    s_add_u32 s18, s18, s17
    s_lshl_b32 s18, s18, 10
    s_add_u32 s19, s18, 110592
    s_add_u32 s18, s18, 25055232
    v_lshlrev_b32 v11, 9, v5
    v_lshl_add_u32 v11, v4, 4, v11
    v_add_u32 v11, 110592, v11
    v_and_b32 v12, 31, v1
    v_lshlrev_b32 v12, 3, v12
    s_lshl_b32 s29, s12, 12
    s_lshl_b32 s17, s13, 10
    s_add_u32 s29, s29, s17
    s_lshl_b32 s17, s15, 7
    s_add_u32 s29, s29, s17
    s_add_u32 s29, s29, 29773824
    s_branch Ld_0_61
Ld_0_59:
    s_lshl_b32 s22, s14, 10
    v_add_u32 v16, s22, v9
    v_add_u32 v17, s22, v10
    ds_read_b64_tr_b16 v[44:45], v16
    ds_read_b64_tr_b16 v[46:47], v17
    ds_read_b64_tr_b16 v[48:49], v16 offset:1024
    ds_read_b64_tr_b16 v[50:51], v17 offset:1024
    s_mul_i32 s23, s13, 9216
    v_add_u32 v16, s23, v15
    ds_read_b64_tr_b16 v[52:53], v16 offset:8192
    v_lshrrev_b32 v32, 5, v1
    v_lshrrev_b32 v33, 2, v4
    v_lshl_add_u32 v33, v32, 3, v33
    v_lshlrev_b32 v33, 6, v33
    v_lshl_add_u32 v33, v8, 3, v33
    v_and_b32 v34, 1, v5
    v_xor_b32 v34, v34, v32
    v_lshl_add_u32 v33, v34, 5, v33
    s_add_u32 s22, s22, 73728
    v_add_u32 v33, s22, v33
    ds_read_b64_tr_b16 v[56:57], v33
    ds_read_b64_tr_b16 v[58:59], v33 offset:256
    ds_read_b64_tr_b16 v[60:61], v33 offset:1024
    ds_read_b64_tr_b16 v[62:63], v33 offset:1280
    ds_read_b64_tr_b16 v[64:65], v33 offset:2048
    ds_read_b64_tr_b16 v[66:67], v33 offset:2304
    s_bitcmp1_b32 s24, 0
    s_cselect_b64 vcc, -1, 0
    s_waitcnt lgkmcnt(11)
    v_cndmask_b32 v28, v20, v24, vcc
    v_cndmask_b32 v29, v21, v25, vcc
    v_cndmask_b32 v30, v22, v26, vcc
    v_cndmask_b32 v31, v23, v27, vcc
    s_waitcnt lgkmcnt(6)
    v_dot2_f32_bf16 v72, v44, s26, v22
    v_dot2_f32_bf16 v73, v44, s27, v22
    v_dot2_f32_bf16 v74, v45, s26, v22
    v_dot2_f32_bf16 v75, v45, s27, v22
    v_dot2_f32_bf16 v76, v46, s26, v26
    v_dot2_f32_bf16 v77, v46, s27, v26
    v_dot2_f32_bf16 v78, v47, s26, v26
    v_dot2_f32_bf16 v79, v47, s27, v26
    v_dot2_f32_bf16 v80, v48, s26, v22
    v_dot2_f32_bf16 v81, v48, s27, v22
    v_dot2_f32_bf16 v82, v49, s26, v22
    v_dot2_f32_bf16 v83, v49, s27, v22
    v_dot2_f32_bf16 v84, v50, s26, v26
    v_dot2_f32_bf16 v85, v50, s27, v26
    v_dot2_f32_bf16 v86, v51, s26, v26
    v_dot2_f32_bf16 v87, v51, s27, v26
    v_dot2_f32_bf16 v88, v52, s26, v30
    v_dot2_f32_bf16 v89, v52, s27, v30
    v_dot2_f32_bf16 v90, v53, s26, v30
    v_dot2_f32_bf16 v91, v53, s27, v30
    v_cvt_pk_bf16_f32 v44, v72, v73
    v_cvt_pk_bf16_f32 v45, v74, v75
    v_cvt_pk_bf16_f32 v46, v76, v77
    v_cvt_pk_bf16_f32 v47, v78, v79
    v_cvt_pk_bf16_f32 v48, v80, v81
    v_cvt_pk_bf16_f32 v49, v82, v83
    v_cvt_pk_bf16_f32 v50, v84, v85
    v_cvt_pk_bf16_f32 v51, v86, v87
    v_cvt_pk_bf16_f32 v52, v88, v89
    v_cvt_pk_bf16_f32 v53, v90, v91
    v_lshlrev_b32 v72, 16, v44
    v_and_b32 v73, 0xffff0000, v44
    v_lshlrev_b32 v74, 16, v45
    v_and_b32 v75, 0xffff0000, v45
    v_mul_f32 v72, v72, v23
    v_mul_f32 v73, v73, v23
    v_mul_f32 v74, v74, v23
    v_mul_f32 v75, v75, v23
    v_cvt_pk_bf16_f32 v44, v72, v73
    v_cvt_pk_bf16_f32 v45, v74, v75
    v_lshlrev_b32 v76, 16, v46
    v_and_b32 v77, 0xffff0000, v46
    v_lshlrev_b32 v78, 16, v47
    v_and_b32 v79, 0xffff0000, v47
    v_mul_f32 v76, v76, v27
    v_mul_f32 v77, v77, v27
    v_mul_f32 v78, v78, v27
    v_mul_f32 v79, v79, v27
    v_cvt_pk_bf16_f32 v46, v76, v77
    v_cvt_pk_bf16_f32 v47, v78, v79
    v_lshlrev_b32 v80, 16, v48
    v_and_b32 v81, 0xffff0000, v48
    v_lshlrev_b32 v82, 16, v49
    v_and_b32 v83, 0xffff0000, v49
    v_mul_f32 v80, v80, v23
    v_mul_f32 v81, v81, v23
    v_mul_f32 v82, v82, v23
    v_mul_f32 v83, v83, v23
    v_cvt_pk_bf16_f32 v48, v80, v81
    v_cvt_pk_bf16_f32 v49, v82, v83
    v_lshlrev_b32 v84, 16, v50
    v_and_b32 v85, 0xffff0000, v50
    v_lshlrev_b32 v86, 16, v51
    v_and_b32 v87, 0xffff0000, v51
    v_mul_f32 v84, v84, v27
    v_mul_f32 v85, v85, v27
    v_mul_f32 v86, v86, v27
    v_mul_f32 v87, v87, v27
    v_cvt_pk_bf16_f32 v50, v84, v85
    v_cvt_pk_bf16_f32 v51, v86, v87
    v_lshlrev_b32 v88, 16, v52
    v_and_b32 v89, 0xffff0000, v52
    v_lshlrev_b32 v90, 16, v53
    v_and_b32 v91, 0xffff0000, v53
    v_mul_f32 v88, v88, v31
    v_mul_f32 v89, v89, v31
    v_mul_f32 v90, v90, v31
    v_mul_f32 v91, v91, v31
    v_cvt_pk_bf16_f32 v52, v88, v89
    v_cvt_pk_bf16_f32 v53, v90, v91
    v_lshlrev_b32 v72, 16, v44
    v_and_b32 v73, 0xffff0000, v44
    v_lshlrev_b32 v74, 16, v45
    v_and_b32 v75, 0xffff0000, v45
    v_lshlrev_b32 v76, 16, v46
    v_and_b32 v77, 0xffff0000, v46
    v_lshlrev_b32 v78, 16, v47
    v_and_b32 v79, 0xffff0000, v47
    v_lshlrev_b32 v80, 16, v48
    v_and_b32 v81, 0xffff0000, v48
    v_lshlrev_b32 v82, 16, v49
    v_and_b32 v83, 0xffff0000, v49
    v_lshlrev_b32 v84, 16, v50
    v_and_b32 v85, 0xffff0000, v50
    v_lshlrev_b32 v86, 16, v51
    v_and_b32 v87, 0xffff0000, v51
    v_lshlrev_b32 v88, 16, v52
    v_and_b32 v89, 0xffff0000, v52
    v_lshlrev_b32 v90, 16, v53
    v_and_b32 v91, 0xffff0000, v53
    s_waitcnt lgkmcnt(0)
    s_add_u32 s22, s36, 20336640
    buffer_store_dwordx4 v[56:59], v3, s[8:11], s22 offen sc1
    buffer_store_dwordx4 v[60:63], v3, s[8:11], s22 offen offset:1024 sc1
    s_cmp_lg_u32 s24, 7
    s_cbranch_scc1 Le_0_69
    buffer_store_dwordx4 v[64:67], v3, s[8:11], s22 offen offset:2048 sc1
Le_0_69:
    ds_read_b128 v[60:63], v19 offset:18432
    ds_read_b128 v[64:67], v19 offset:19456
    s_cmp_lt_u32 s2, 144
    s_cbranch_scc1 Ld_0_70
    s_bfe_u32 s60, s2, 0x20003
    s_mul_i32 s60, s60, 165888
    s_and_b32 s61, s24, 3
    s_mul_i32 s61, s61, 36864
    s_add_u32 s60, s60, s61
    s_cmp_ge_u32 s24, 4
    s_cselect_b32 s61, 663552, 0
    s_add_u32 s60, s60, s61
    s_add_u32 s60, s60, 8224768
    s_add_u32 s61, s60, 0
    buffer_load_dwordx4 v[112:115], v3, s[8:11], s61 offen offset:0 sc1
    buffer_load_dwordx4 v[116:119], v3, s[8:11], s61 offen offset:1024 sc1
    buffer_load_dwordx4 v[120:123], v3, s[8:11], s61 offen offset:2048 sc1
    buffer_load_dwordx4 v[124:127], v3, s[8:11], s61 offen offset:3072 sc1
    s_add_u32 s61, s60, 4096
    buffer_load_dwordx4 v[128:131], v3, s[8:11], s61 offen offset:0 sc1
    buffer_load_dwordx4 v[132:135], v3, s[8:11], s61 offen offset:1024 sc1
    buffer_load_dwordx4 v[136:139], v3, s[8:11], s61 offen offset:2048 sc1
    buffer_load_dwordx4 v[140:143], v3, s[8:11], s61 offen offset:3072 sc1
    s_add_u32 s61, s60, 8192
    buffer_load_dwordx4 v[144:147], v3, s[8:11], s61 offen offset:0 sc1
    buffer_load_dwordx4 v[148:151], v3, s[8:11], s61 offen offset:1024 sc1
    buffer_load_dwordx4 v[152:155], v3, s[8:11], s61 offen offset:2048 sc1
    buffer_load_dwordx4 v[156:159], v3, s[8:11], s61 offen offset:3072 sc1
    s_add_u32 s61, s60, 12288
    buffer_load_dwordx4 v[160:163], v3, s[8:11], s61 offen offset:0 sc1
    buffer_load_dwordx4 v[164:167], v3, s[8:11], s61 offen offset:1024 sc1
    buffer_load_dwordx4 v[168:171], v3, s[8:11], s61 offen offset:2048 sc1
    buffer_load_dwordx4 v[172:175], v3, s[8:11], s61 offen offset:3072 sc1
Ld_0_70:
    s_lshr_b32 s16, s24, 1
    s_lshr_b32 s23, s16, 1
    s_add_u32 s23, s23, 1
    s_sub_u32 s17, 0, s23
    s_bitcmp1_b32 s16, 0
    s_cselect_b32 s23, s23, s17
    s_lshl_b32 s17, s12, 5
    s_add_u32 s23, s23, s17
    v_and_b32 v6, 31, v1
    v_add_u32 v6, s23, v6
    s_movk_i32 s17, 0x800
    v_cmp_gt_u32 vcc, s17, v6
    v_lshrrev_b32 v16, 5, v6
    s_mov_b32 s17, 36864
    v_mul_lo_u32 v16, v16, s17
    v_and_b32 v6, 31, v6
    v_lshl_add_u32 v6, v6, 4, v16
    v_and_b32 v16, 32, v1
    v_lshl_add_u32 v6, v16, 4, v6
    v_mov_b32 v16, 0x40000000
    v_cndmask_b32 v6, v16, v6, vcc
    s_mul_i32 s18, s16, 9
    s_and_b32 s17, s24, 1
    s_mul_i32 s17, s17, 5
    s_add_u32 s18, s18, s17
    s_lshl_b32 s18, s18, 10
    s_add_u32 s19, s18, 110592
    s_add_u32 s18, s18, 25055232
    v_lshlrev_b32 v11, 9, v5
    v_lshl_add_u32 v11, v4, 4, v11
    v_add_u32 v11, 110592, v11
    v_and_b32 v12, 31, v1
    v_lshlrev_b32 v12, 3, v12
    s_lshl_b32 s29, s12, 12
    s_lshl_b32 s17, s13, 10
    s_add_u32 s29, s29, s17
    s_lshl_b32 s17, s15, 7
    s_add_u32 s29, s29, s17
    s_add_u32 s29, s29, 29773824
    s_waitcnt lgkmcnt(0)
Ld_0_61:
    s_barrier
    v_add_u32 v16, s19, v3
    s_and_b32 s17, s24, 1
    s_lshl_b32 s17, s17, 10
    s_sub_u32 s17, 4096, s17
    s_add_u32 s16, s18, s17
    v_add_u32 v17, s17, v16
Le_0_79:
    s_mov_b32 m0, s19
    s_nop 0
    buffer_load_dwordx4 v6, s[8:11], s18 offen offset:0 sc1 lds
    buffer_load_dwordx4 v6, s[8:11], s18 offen offset:1024 sc1 lds
    buffer_load_dwordx4 v6, s[8:11], s18 offen offset:2048 sc1 lds
    buffer_load_dwordx4 v6, s[8:11], s18 offen offset:3072 sc1 lds
    s_bitcmp1_b32 s24, 0
    s_cbranch_scc1 Le_0_71
    s_add_u32 m0, s19, 4096
    s_nop 0
    buffer_load_dwordx4 v6, s[8:11], s16 offen sc1 lds
Le_0_71:
    s_sub_u32 s38, s38, 1
    s_waitcnt vmcnt(0)
    ds_read_b128 v[36:39], v16 offset:0
    ds_read_b128 v[40:43], v16 offset:1024
    ds_read_b128 v[44:47], v16 offset:2048
    ds_read_b128 v[48:51], v16 offset:3072
    ds_read_b128 v[52:55], v17
    s_waitcnt lgkmcnt(4)
    v_max3_u32 v24, v36, v37, v38
    v_max_u32 v25, v39, v39
    s_waitcnt lgkmcnt(3)
    v_max3_u32 v24, v40, v41, v24
    v_max3_u32 v25, v42, v43, v25
    s_waitcnt lgkmcnt(2)
    v_max3_u32 v24, v44, v45, v24
    v_max3_u32 v25, v46, v47, v25
    s_waitcnt lgkmcnt(1)
    v_max3_u32 v24, v48, v49, v24
    v_max3_u32 v25, v50, v51, v25
    s_waitcnt lgkmcnt(0)
    v_max3_u32 v24, v52, v53, v24
    v_max3_u32 v25, v54, v55, v25
    v_max_u32 v24, v24, v25
    v_cmp_eq_u32 vcc, -1, v24
    s_nop 0
    s_cbranch_vccz Le_0_80
    s_cmp_lt_i32 s38, 0
    s_cbranch_scc0 Le_0_79
Le_0_80:
    v_mov_b32 v20, 0
    v_mov_b32 v21, 0
    v_mov_b32 v22, 0
    v_mov_b32 v23, 0
    s_add_u32 s22, s36, 27414528
    s_add_u32 s23, s37, 27414528
    s_waitcnt vmcnt(0)
    s_barrier
    s_cmp_ge_u32 s24, 4
    s_cbranch_scc1 Le_0_72
    v_and_b32 v20, 0, v1
    v_lshlrev_b32 v20, 8, v20
    v_add_u32 v20, 4352, v20
Lpo_0_81:
    buffer_load_dword v22, v20, s[8:11], 0 offen sc1
    s_sub_u32 s38, s38, 1
    s_cmp_lt_i32 s38, 0
    s_cbranch_scc1 Lpx_0_82
    s_waitcnt vmcnt(0)
    v_cmp_eq_u32 vcc, 0, v22
    s_nop 0
    s_cbranch_vccz Lpx_0_82
    s_sleep 2
    s_branch Lpo_0_81
Lpx_0_82:
    s_waitcnt vmcnt(0)
    s_and_b32 s60, s2, 3
    s_lshl_b32 s60, s60, 2
    s_bfe_u32 s61, s2, 0x20005
    s_add_u32 s60, s60, s61
    s_mul_i32 s60, s60, 331776
    s_mul_i32 s62, s24, 9216
    s_add_u32 s60, s60, s62
    s_add_u32 s60, s60, 9551872
    s_sub_u32 s61, s24, s61
    s_and_b32 s61, s61, 3
    s_mul_i32 s61, s61, 9216
    s_add_u32 m0, s61, 0
    s_add_u32 s62, s60, 0
    buffer_load_dwordx4 v3, s[8:11], s62 offen offset:0 sc1 lds
    buffer_load_dwordx4 v3, s[8:11], s62 offen offset:1024 sc1 lds
    buffer_load_dwordx4 v3, s[8:11], s62 offen offset:2048 sc1 lds
    buffer_load_dwordx4 v3, s[8:11], s62 offen offset:3072 sc1 lds
    s_add_u32 m0, s61, 4096
    s_add_u32 s62, s60, 4096
    buffer_load_dwordx4 v3, s[8:11], s62 offen offset:0 sc1 lds
    buffer_load_dwordx4 v3, s[8:11], s62 offen offset:1024 sc1 lds
    buffer_load_dwordx4 v3, s[8:11], s62 offen offset:2048 sc1 lds
    buffer_load_dwordx4 v3, s[8:11], s62 offen offset:3072 sc1 lds
    s_add_u32 m0, s61, 8192
    s_add_u32 s62, s60, 8192
    buffer_load_dwordx4 v3, s[8:11], s62 offen offset:0 sc1 lds
    s_add_u32 m0, s61, 36864
    s_add_u32 s62, s60, 36864
    buffer_load_dwordx4 v3, s[8:11], s62 offen offset:0 sc1 lds
    buffer_load_dwordx4 v3, s[8:11], s62 offen offset:1024 sc1 lds
    buffer_load_dwordx4 v3, s[8:11], s62 offen offset:2048 sc1 lds
    buffer_load_dwordx4 v3, s[8:11], s62 offen offset:3072 sc1 lds
    s_add_u32 m0, s61, 40960
    s_add_u32 s62, s60, 40960
    buffer_load_dwordx4 v3, s[8:11], s62 offen offset:0 sc1 lds
    buffer_load_dwordx4 v3, s[8:11], s62 offen offset:1024 sc1 lds
    buffer_load_dwordx4 v3, s[8:11], s62 offen offset:2048 sc1 lds
    buffer_load_dwordx4 v3, s[8:11], s62 offen offset:3072 sc1 lds
    s_add_u32 m0, s61, 45056
    s_add_u32 s62, s60, 45056
    buffer_load_dwordx4 v3, s[8:11], s62 offen offset:0 sc1 lds
    s_add_u32 m0, s61, 73728
    s_add_u32 s62, s60, 73728
    buffer_load_dwordx4 v3, s[8:11], s62 offen offset:0 sc1 lds
    buffer_load_dwordx4 v3, s[8:11], s62 offen offset:1024 sc1 lds
    buffer_load_dwordx4 v3, s[8:11], s62 offen offset:2048 sc1 lds
    buffer_load_dwordx4 v3, s[8:11], s62 offen offset:3072 sc1 lds
    s_add_u32 m0, s61, 77824
    s_add_u32 s62, s60, 77824
    buffer_load_dwordx4 v3, s[8:11], s62 offen offset:0 sc1 lds
    buffer_load_dwordx4 v3, s[8:11], s62 offen offset:1024 sc1 lds
    buffer_load_dwordx4 v3, s[8:11], s62 offen offset:2048 sc1 lds
    buffer_load_dwordx4 v3, s[8:11], s62 offen offset:3072 sc1 lds
    s_add_u32 m0, s61, 81920
    s_add_u32 s62, s60, 81920
    buffer_load_dwordx4 v3, s[8:11], s62 offen offset:0 sc1 lds
    s_waitcnt vmcnt(9)
    s_branch Le_0_78
Le_0_72:
    s_cmp_eq_u32 s24, 4
    s_cbranch_scc1 Le_0_73
    s_cmp_eq_u32 s24, 5
    s_cbranch_scc1 Le_0_74
    ds_read_b128 v[36:39], v11 offset:0
    ds_read_b128 v[40:43], v11 offset:256
    ds_read_b128 v[44:47], v11 offset:2048
    ds_read_b128 v[48:51], v11 offset:2304
    s_waitcnt lgkmcnt(2)
    v_mfma_f32_16x16x32_bf16 v[72:75], v[112:115], v[36:39], v[72:75]
    ds_read_b128 v[52:55], v11 offset:4096
    v_mfma_f32_16x16x32_bf16 v[76:79], v[112:115], v[40:43], v[76:79]
    ds_read_b128 v[56:59], v11 offset:4352
    v_mfma_f32_16x16x32_bf16 v[80:83], v[184:187], v[36:39], v[80:83]
    v_mfma_f32_16x16x32_bf16 v[84:87], v[184:187], v[40:43], v[84:87]
    s_waitcnt lgkmcnt(2)
    v_mfma_f32_16x16x32_bf16 v[72:75], v[116:119], v[44:47], v[72:75]
    ds_read_b128 v[36:39], v11 offset:6144
    v_mfma_f32_16x16x32_bf16 v[76:79], v[116:119], v[48:51], v[76:79]
    ds_read_b128 v[40:43], v11 offset:6400
    v_mfma_f32_16x16x32_bf16 v[80:83], v[188:191], v[44:47], v[80:83]
    v_mfma_f32_16x16x32_bf16 v[84:87], v[188:191], v[48:51], v[84:87]
    s_waitcnt lgkmcnt(2)
    v_mfma_f32_16x16x32_bf16 v[72:75], v[120:123], v[52:55], v[72:75]
    ds_read_b128 v[44:47], v11 offset:8192
    v_mfma_f32_16x16x32_bf16 v[76:79], v[120:123], v[56:59], v[76:79]
    ds_read_b128 v[48:51], v11 offset:8448
    v_mfma_f32_16x16x32_bf16 v[80:83], v[192:195], v[52:55], v[80:83]
    v_mfma_f32_16x16x32_bf16 v[84:87], v[192:195], v[56:59], v[84:87]
    s_waitcnt lgkmcnt(2)
    v_mfma_f32_16x16x32_bf16 v[72:75], v[124:127], v[36:39], v[72:75]
    ds_read_b128 v[52:55], v11 offset:10240
    v_mfma_f32_16x16x32_bf16 v[76:79], v[124:127], v[40:43], v[76:79]
    ds_read_b128 v[56:59], v11 offset:10496
    v_mfma_f32_16x16x32_bf16 v[80:83], v[196:199], v[36:39], v[80:83]
    v_mfma_f32_16x16x32_bf16 v[84:87], v[196:199], v[40:43], v[84:87]
    s_waitcnt lgkmcnt(2)
    v_mfma_f32_16x16x32_bf16 v[72:75], v[128:131], v[44:47], v[72:75]
    ds_read_b128 v[36:39], v11 offset:12288
    v_mfma_f32_16x16x32_bf16 v[76:79], v[128:131], v[48:51], v[76:79]
    ds_read_b128 v[40:43], v11 offset:12544
    v_mfma_f32_16x16x32_bf16 v[80:83], v[200:203], v[44:47], v[80:83]
    v_mfma_f32_16x16x32_bf16 v[84:87], v[200:203], v[48:51], v[84:87]
    s_waitcnt lgkmcnt(2)
    v_mfma_f32_16x16x32_bf16 v[72:75], v[132:135], v[52:55], v[72:75]
    ds_read_b128 v[44:47], v11 offset:14336
    v_mfma_f32_16x16x32_bf16 v[76:79], v[132:135], v[56:59], v[76:79]
    ds_read_b128 v[48:51], v11 offset:14592
    v_mfma_f32_16x16x32_bf16 v[80:83], v[204:207], v[52:55], v[80:83]
    v_mfma_f32_16x16x32_bf16 v[84:87], v[204:207], v[56:59], v[84:87]
    s_waitcnt lgkmcnt(2)
    v_mfma_f32_16x16x32_bf16 v[72:75], v[136:139], v[36:39], v[72:75]
    ds_read_b128 v[52:55], v11 offset:16384
    v_mfma_f32_16x16x32_bf16 v[76:79], v[136:139], v[40:43], v[76:79]
    ds_read_b128 v[56:59], v11 offset:16640
    v_mfma_f32_16x16x32_bf16 v[80:83], v[208:211], v[36:39], v[80:83]
    v_mfma_f32_16x16x32_bf16 v[84:87], v[208:211], v[40:43], v[84:87]
    s_waitcnt lgkmcnt(2)
    v_mfma_f32_16x16x32_bf16 v[72:75], v[140:143], v[44:47], v[72:75]
    ds_read_b128 v[36:39], v11 offset:18432
    v_mfma_f32_16x16x32_bf16 v[76:79], v[140:143], v[48:51], v[76:79]
    ds_read_b128 v[40:43], v11 offset:18688
    v_mfma_f32_16x16x32_bf16 v[80:83], v[212:215], v[44:47], v[80:83]
    v_mfma_f32_16x16x32_bf16 v[84:87], v[212:215], v[48:51], v[84:87]
    s_waitcnt lgkmcnt(2)
    v_mfma_f32_16x16x32_bf16 v[72:75], v[144:147], v[52:55], v[72:75]
    ds_read_b128 v[44:47], v11 offset:20480
    v_mfma_f32_16x16x32_bf16 v[76:79], v[144:147], v[56:59], v[76:79]
    ds_read_b128 v[48:51], v11 offset:20736
    v_mfma_f32_16x16x32_bf16 v[80:83], v[216:219], v[52:55], v[80:83]
    v_mfma_f32_16x16x32_bf16 v[84:87], v[216:219], v[56:59], v[84:87]
    s_waitcnt lgkmcnt(2)
    v_mfma_f32_16x16x32_bf16 v[72:75], v[148:151], v[36:39], v[72:75]
    ds_read_b128 v[52:55], v11 offset:22528
    v_mfma_f32_16x16x32_bf16 v[76:79], v[148:151], v[40:43], v[76:79]
    ds_read_b128 v[56:59], v11 offset:22784
    v_mfma_f32_16x16x32_bf16 v[80:83], v[220:223], v[36:39], v[80:83]
    v_mfma_f32_16x16x32_bf16 v[84:87], v[220:223], v[40:43], v[84:87]
    s_waitcnt lgkmcnt(2)
    v_mfma_f32_16x16x32_bf16 v[72:75], v[152:155], v[44:47], v[72:75]
    ds_read_b128 v[36:39], v11 offset:24576
    v_mfma_f32_16x16x32_bf16 v[76:79], v[152:155], v[48:51], v[76:79]
    ds_read_b128 v[40:43], v11 offset:24832
    v_mfma_f32_16x16x32_bf16 v[80:83], v[224:227], v[44:47], v[80:83]
    v_mfma_f32_16x16x32_bf16 v[84:87], v[224:227], v[48:51], v[84:87]
    s_waitcnt lgkmcnt(2)
    v_mfma_f32_16x16x32_bf16 v[72:75], v[156:159], v[52:55], v[72:75]
    ds_read_b128 v[44:47], v11 offset:26624
    v_mfma_f32_16x16x32_bf16 v[76:79], v[156:159], v[56:59], v[76:79]
    ds_read_b128 v[48:51], v11 offset:26880
    v_mfma_f32_16x16x32_bf16 v[80:83], v[228:231], v[52:55], v[80:83]
    v_mfma_f32_16x16x32_bf16 v[84:87], v[228:231], v[56:59], v[84:87]
    s_waitcnt lgkmcnt(2)
    v_mfma_f32_16x16x32_bf16 v[72:75], v[160:163], v[36:39], v[72:75]
    ds_read_b128 v[52:55], v11 offset:28672
    v_mfma_f32_16x16x32_bf16 v[76:79], v[160:163], v[40:43], v[76:79]
    ds_read_b128 v[56:59], v11 offset:28928
    v_mfma_f32_16x16x32_bf16 v[80:83], v[232:235], v[36:39], v[80:83]
    v_mfma_f32_16x16x32_bf16 v[84:87], v[232:235], v[40:43], v[84:87]
    s_waitcnt lgkmcnt(2)
    v_mfma_f32_16x16x32_bf16 v[72:75], v[164:167], v[44:47], v[72:75]
    ds_read_b128 v[36:39], v11 offset:30720
    v_mfma_f32_16x16x32_bf16 v[76:79], v[164:167], v[48:51], v[76:79]
    ds_read_b128 v[40:43], v11 offset:30976
    v_mfma_f32_16x16x32_bf16 v[80:83], v[236:239], v[44:47], v[80:83]
    v_mfma_f32_16x16x32_bf16 v[84:87], v[236:239], v[48:51], v[84:87]
    s_waitcnt lgkmcnt(2)
    v_mfma_f32_16x16x32_bf16 v[72:75], v[168:171], v[52:55], v[72:75]
    ds_read_b128 v[44:47], v11 offset:32768
    v_mfma_f32_16x16x32_bf16 v[76:79], v[168:171], v[56:59], v[76:79]
    ds_read_b128 v[48:51], v11 offset:33024
    v_mfma_f32_16x16x32_bf16 v[80:83], v[240:243], v[52:55], v[80:83]
    v_mfma_f32_16x16x32_bf16 v[84:87], v[240:243], v[56:59], v[84:87]
    s_waitcnt lgkmcnt(2)
    v_mfma_f32_16x16x32_bf16 v[72:75], v[172:175], v[36:39], v[72:75]
    ds_read_b128 v[52:55], v11 offset:34816
    v_mfma_f32_16x16x32_bf16 v[76:79], v[172:175], v[40:43], v[76:79]
    ds_read_b128 v[56:59], v11 offset:35072
    v_mfma_f32_16x16x32_bf16 v[80:83], v[244:247], v[36:39], v[80:83]
    v_mfma_f32_16x16x32_bf16 v[84:87], v[244:247], v[40:43], v[84:87]
    s_waitcnt lgkmcnt(2)
    v_mfma_f32_16x16x32_bf16 v[72:75], v[176:179], v[44:47], v[72:75]
    v_mfma_f32_16x16x32_bf16 v[76:79], v[176:179], v[48:51], v[76:79]
    v_mfma_f32_16x16x32_bf16 v[80:83], v[248:251], v[44:47], v[80:83]
    v_mfma_f32_16x16x32_bf16 v[84:87], v[248:251], v[48:51], v[84:87]
    s_waitcnt lgkmcnt(0)
    v_mfma_f32_16x16x32_bf16 v[72:75], v[180:183], v[52:55], v[72:75]
    v_mfma_f32_16x16x32_bf16 v[76:79], v[180:183], v[56:59], v[76:79]
    v_mfma_f32_16x16x32_bf16 v[80:83], v[252:255], v[52:55], v[80:83]
    v_mfma_f32_16x16x32_bf16 v[84:87], v[252:255], v[56:59], v[84:87]
    s_branch Le_0_75
Le_0_73:
    ds_read_b128 v[36:39], v11 offset:0
    ds_read_b128 v[40:43], v11 offset:256
    ds_read_b128 v[44:47], v11 offset:2048
    ds_read_b128 v[48:51], v11 offset:2304
    s_waitcnt lgkmcnt(2)
    v_mfma_f32_16x16x32_bf16 v[72:75], v[112:115], v[36:39], v[72:75]
    ds_read_b128 v[52:55], v11 offset:4096
    v_mfma_f32_16x16x32_bf16 v[76:79], v[112:115], v[40:43], v[76:79]
    ds_read_b128 v[56:59], v11 offset:4352
    v_mfma_f32_16x16x32_bf16 v[80:83], v[184:187], v[36:39], v[80:83]
    ds_read_b128 v[68:71], v19 offset:20480
    v_mfma_f32_16x16x32_bf16 v[84:87], v[184:187], v[40:43], v[84:87]
    v_mfma_f32_16x16x32_bf16 v[88:91], v[60:63], v[36:39], v[88:91]
    s_waitcnt lgkmcnt(3)
    v_mfma_f32_16x16x32_bf16 v[72:75], v[116:119], v[44:47], v[72:75]
    ds_read_b128 v[36:39], v11 offset:6144
    v_mfma_f32_16x16x32_bf16 v[76:79], v[116:119], v[48:51], v[76:79]
    ds_read_b128 v[40:43], v11 offset:6400
    v_mfma_f32_16x16x32_bf16 v[80:83], v[188:191], v[44:47], v[80:83]
    ds_read_b128 v[60:63], v19 offset:21504
    v_mfma_f32_16x16x32_bf16 v[84:87], v[188:191], v[48:51], v[84:87]
    v_mfma_f32_16x16x32_bf16 v[88:91], v[64:67], v[44:47], v[88:91]
    s_waitcnt lgkmcnt(3)
    v_mfma_f32_16x16x32_bf16 v[72:75], v[120:123], v[52:55], v[72:75]
    ds_read_b128 v[44:47], v11 offset:8192
    v_mfma_f32_16x16x32_bf16 v[76:79], v[120:123], v[56:59], v[76:79]
    ds_read_b128 v[48:51], v11 offset:8448
    v_mfma_f32_16x16x32_bf16 v[80:83], v[192:195], v[52:55], v[80:83]
    ds_read_b128 v[64:67], v19 offset:22528
    v_mfma_f32_16x16x32_bf16 v[84:87], v[192:195], v[56:59], v[84:87]
    v_mfma_f32_16x16x32_bf16 v[88:91], v[68:71], v[52:55], v[88:91]
    s_waitcnt lgkmcnt(3)
    v_mfma_f32_16x16x32_bf16 v[72:75], v[124:127], v[36:39], v[72:75]
    ds_read_b128 v[52:55], v11 offset:10240
    v_mfma_f32_16x16x32_bf16 v[76:79], v[124:127], v[40:43], v[76:79]
    ds_read_b128 v[56:59], v11 offset:10496
    v_mfma_f32_16x16x32_bf16 v[80:83], v[196:199], v[36:39], v[80:83]
    ds_read_b128 v[68:71], v19 offset:23552
    v_mfma_f32_16x16x32_bf16 v[84:87], v[196:199], v[40:43], v[84:87]
    v_mfma_f32_16x16x32_bf16 v[88:91], v[60:63], v[36:39], v[88:91]
    s_waitcnt lgkmcnt(3)
    v_mfma_f32_16x16x32_bf16 v[72:75], v[128:131], v[44:47], v[72:75]
    ds_read_b128 v[36:39], v11 offset:12288
    v_mfma_f32_16x16x32_bf16 v[76:79], v[128:131], v[48:51], v[76:79]
    ds_read_b128 v[40:43], v11 offset:12544
    v_mfma_f32_16x16x32_bf16 v[80:83], v[200:203], v[44:47], v[80:83]
    ds_read_b128 v[60:63], v19 offset:24576
    v_mfma_f32_16x16x32_bf16 v[84:87], v[200:203], v[48:51], v[84:87]
    v_mfma_f32_16x16x32_bf16 v[88:91], v[64:67], v[44:47], v[88:91]
    s_waitcnt lgkmcnt(3)
    v_mfma_f32_16x16x32_bf16 v[72:75], v[132:135], v[52:55], v[72:75]
    ds_read_b128 v[44:47], v11 offset:14336
    v_mfma_f32_16x16x32_bf16 v[76:79], v[132:135], v[56:59], v[76:79]
    ds_read_b128 v[48:51], v11 offset:14592
    v_mfma_f32_16x16x32_bf16 v[80:83], v[204:207], v[52:55], v[80:83]
    ds_read_b128 v[64:67], v19 offset:25600
    v_mfma_f32_16x16x32_bf16 v[84:87], v[204:207], v[56:59], v[84:87]
    v_mfma_f32_16x16x32_bf16 v[88:91], v[68:71], v[52:55], v[88:91]
    s_waitcnt lgkmcnt(3)
    v_mfma_f32_16x16x32_bf16 v[72:75], v[136:139], v[36:39], v[72:75]
    ds_read_b128 v[52:55], v11 offset:16384
    v_mfma_f32_16x16x32_bf16 v[76:79], v[136:139], v[40:43], v[76:79]
    ds_read_b128 v[56:59], v11 offset:16640
    v_mfma_f32_16x16x32_bf16 v[80:83], v[208:211], v[36:39], v[80:83]
    ds_read_b128 v[68:71], v19 offset:26624
    v_mfma_f32_16x16x32_bf16 v[84:87], v[208:211], v[40:43], v[84:87]
    v_mfma_f32_16x16x32_bf16 v[88:91], v[60:63], v[36:39], v[88:91]
    s_waitcnt lgkmcnt(3)
    v_mfma_f32_16x16x32_bf16 v[72:75], v[140:143], v[44:47], v[72:75]
    ds_read_b128 v[36:39], v11 offset:18432
    v_mfma_f32_16x16x32_bf16 v[76:79], v[140:143], v[48:51], v[76:79]
    ds_read_b128 v[40:43], v11 offset:18688
    v_mfma_f32_16x16x32_bf16 v[80:83], v[212:215], v[44:47], v[80:83]
    ds_read_b128 v[60:63], v19 offset:27648
    v_mfma_f32_16x16x32_bf16 v[84:87], v[212:215], v[48:51], v[84:87]
    v_mfma_f32_16x16x32_bf16 v[88:91], v[64:67], v[44:47], v[88:91]
    s_waitcnt lgkmcnt(3)
    v_mfma_f32_16x16x32_bf16 v[72:75], v[144:147], v[52:55], v[72:75]
    ds_read_b128 v[44:47], v11 offset:20480
    v_mfma_f32_16x16x32_bf16 v[76:79], v[144:147], v[56:59], v[76:79]
    ds_read_b128 v[48:51], v11 offset:20736
    v_mfma_f32_16x16x32_bf16 v[80:83], v[216:219], v[52:55], v[80:83]
    ds_read_b128 v[64:67], v19 offset:28672
    v_mfma_f32_16x16x32_bf16 v[84:87], v[216:219], v[56:59], v[84:87]
    v_mfma_f32_16x16x32_bf16 v[88:91], v[68:71], v[52:55], v[88:91]
    s_waitcnt lgkmcnt(3)
    v_mfma_f32_16x16x32_bf16 v[72:75], v[148:151], v[36:39], v[72:75]
    ds_read_b128 v[52:55], v11 offset:22528
    v_mfma_f32_16x16x32_bf16 v[76:79], v[148:151], v[40:43], v[76:79]
    ds_read_b128 v[56:59], v11 offset:22784
    v_mfma_f32_16x16x32_bf16 v[80:83], v[220:223], v[36:39], v[80:83]
    ds_read_b128 v[68:71], v19 offset:29696
    v_mfma_f32_16x16x32_bf16 v[84:87], v[220:223], v[40:43], v[84:87]
    v_mfma_f32_16x16x32_bf16 v[88:91], v[60:63], v[36:39], v[88:91]
    s_waitcnt lgkmcnt(3)
    v_mfma_f32_16x16x32_bf16 v[72:75], v[152:155], v[44:47], v[72:75]
    ds_read_b128 v[36:39], v11 offset:24576
    v_mfma_f32_16x16x32_bf16 v[76:79], v[152:155], v[48:51], v[76:79]
    ds_read_b128 v[40:43], v11 offset:24832
    v_mfma_f32_16x16x32_bf16 v[80:83], v[224:227], v[44:47], v[80:83]
    ds_read_b128 v[60:63], v19 offset:30720
    v_mfma_f32_16x16x32_bf16 v[84:87], v[224:227], v[48:51], v[84:87]
    v_mfma_f32_16x16x32_bf16 v[88:91], v[64:67], v[44:47], v[88:91]
    s_waitcnt lgkmcnt(3)
    v_mfma_f32_16x16x32_bf16 v[72:75], v[156:159], v[52:55], v[72:75]
    ds_read_b128 v[44:47], v11 offset:26624
    v_mfma_f32_16x16x32_bf16 v[76:79], v[156:159], v[56:59], v[76:79]
    ds_read_b128 v[48:51], v11 offset:26880
    v_mfma_f32_16x16x32_bf16 v[80:83], v[228:231], v[52:55], v[80:83]
    ds_read_b128 v[64:67], v19 offset:31744
    v_mfma_f32_16x16x32_bf16 v[84:87], v[228:231], v[56:59], v[84:87]
    v_mfma_f32_16x16x32_bf16 v[88:91], v[68:71], v[52:55], v[88:91]
    s_waitcnt lgkmcnt(3)
    v_mfma_f32_16x16x32_bf16 v[72:75], v[160:163], v[36:39], v[72:75]
    ds_read_b128 v[52:55], v11 offset:28672
    v_mfma_f32_16x16x32_bf16 v[76:79], v[160:163], v[40:43], v[76:79]
    ds_read_b128 v[56:59], v11 offset:28928
    v_mfma_f32_16x16x32_bf16 v[80:83], v[232:235], v[36:39], v[80:83]
    ds_read_b128 v[68:71], v19 offset:32768
    v_mfma_f32_16x16x32_bf16 v[84:87], v[232:235], v[40:43], v[84:87]
    v_mfma_f32_16x16x32_bf16 v[88:91], v[60:63], v[36:39], v[88:91]
    s_waitcnt lgkmcnt(3)
    v_mfma_f32_16x16x32_bf16 v[72:75], v[164:167], v[44:47], v[72:75]
    ds_read_b128 v[36:39], v11 offset:30720
    v_mfma_f32_16x16x32_bf16 v[76:79], v[164:167], v[48:51], v[76:79]
    ds_read_b128 v[40:43], v11 offset:30976
    v_mfma_f32_16x16x32_bf16 v[80:83], v[236:239], v[44:47], v[80:83]
    ds_read_b128 v[60:63], v19 offset:33792
    v_mfma_f32_16x16x32_bf16 v[84:87], v[236:239], v[48:51], v[84:87]
    v_mfma_f32_16x16x32_bf16 v[88:91], v[64:67], v[44:47], v[88:91]
    s_waitcnt lgkmcnt(3)
    v_mfma_f32_16x16x32_bf16 v[72:75], v[168:171], v[52:55], v[72:75]
    ds_read_b128 v[44:47], v11 offset:32768
    v_mfma_f32_16x16x32_bf16 v[76:79], v[168:171], v[56:59], v[76:79]
    ds_read_b128 v[48:51], v11 offset:33024
    v_mfma_f32_16x16x32_bf16 v[80:83], v[240:243], v[52:55], v[80:83]
    ds_read_b128 v[64:67], v19 offset:34816
    v_mfma_f32_16x16x32_bf16 v[84:87], v[240:243], v[56:59], v[84:87]
    v_mfma_f32_16x16x32_bf16 v[88:91], v[68:71], v[52:55], v[88:91]
    s_waitcnt lgkmcnt(3)
    v_mfma_f32_16x16x32_bf16 v[72:75], v[172:175], v[36:39], v[72:75]
    ds_read_b128 v[52:55], v11 offset:34816
    v_mfma_f32_16x16x32_bf16 v[76:79], v[172:175], v[40:43], v[76:79]
    ds_read_b128 v[56:59], v11 offset:35072
    v_mfma_f32_16x16x32_bf16 v[80:83], v[244:247], v[36:39], v[80:83]
    ds_read_b128 v[68:71], v19 offset:35840
    v_mfma_f32_16x16x32_bf16 v[84:87], v[244:247], v[40:43], v[84:87]
    v_mfma_f32_16x16x32_bf16 v[88:91], v[60:63], v[36:39], v[88:91]
    s_waitcnt lgkmcnt(3)
    v_mfma_f32_16x16x32_bf16 v[72:75], v[176:179], v[44:47], v[72:75]
    v_mfma_f32_16x16x32_bf16 v[76:79], v[176:179], v[48:51], v[76:79]
    v_mfma_f32_16x16x32_bf16 v[80:83], v[248:251], v[44:47], v[80:83]
    v_mfma_f32_16x16x32_bf16 v[84:87], v[248:251], v[48:51], v[84:87]
    v_mfma_f32_16x16x32_bf16 v[88:91], v[64:67], v[44:47], v[88:91]
    s_waitcnt lgkmcnt(0)
    v_mfma_f32_16x16x32_bf16 v[72:75], v[180:183], v[52:55], v[72:75]
    v_mfma_f32_16x16x32_bf16 v[76:79], v[180:183], v[56:59], v[76:79]
    v_mfma_f32_16x16x32_bf16 v[80:83], v[252:255], v[52:55], v[80:83]
    v_mfma_f32_16x16x32_bf16 v[84:87], v[252:255], v[56:59], v[84:87]
    v_mfma_f32_16x16x32_bf16 v[88:91], v[68:71], v[52:55], v[88:91]
    s_branch Le_0_75
Le_0_74:
    ds_read_b128 v[36:39], v11 offset:0
    ds_read_b128 v[40:43], v11 offset:256
    ds_read_b128 v[44:47], v11 offset:2048
    ds_read_b128 v[48:51], v11 offset:2304
    s_waitcnt lgkmcnt(2)
    v_mfma_f32_16x16x32_bf16 v[72:75], v[112:115], v[36:39], v[72:75]
    ds_read_b128 v[52:55], v11 offset:4096
    v_mfma_f32_16x16x32_bf16 v[76:79], v[112:115], v[40:43], v[76:79]
    ds_read_b128 v[56:59], v11 offset:4352
    v_mfma_f32_16x16x32_bf16 v[80:83], v[184:187], v[36:39], v[80:83]
    ds_read_b128 v[68:71], v19 offset:20480
    v_mfma_f32_16x16x32_bf16 v[84:87], v[184:187], v[40:43], v[84:87]
    v_mfma_f32_16x16x32_bf16 v[88:91], v[60:63], v[40:43], v[88:91]
    s_waitcnt lgkmcnt(3)
    v_mfma_f32_16x16x32_bf16 v[72:75], v[116:119], v[44:47], v[72:75]
    ds_read_b128 v[36:39], v11 offset:6144
    v_mfma_f32_16x16x32_bf16 v[76:79], v[116:119], v[48:51], v[76:79]
    ds_read_b128 v[40:43], v11 offset:6400
    v_mfma_f32_16x16x32_bf16 v[80:83], v[188:191], v[44:47], v[80:83]
    ds_read_b128 v[60:63], v19 offset:21504
    v_mfma_f32_16x16x32_bf16 v[84:87], v[188:191], v[48:51], v[84:87]
    v_mfma_f32_16x16x32_bf16 v[88:91], v[64:67], v[48:51], v[88:91]
    s_waitcnt lgkmcnt(3)
    v_mfma_f32_16x16x32_bf16 v[72:75], v[120:123], v[52:55], v[72:75]
    ds_read_b128 v[44:47], v11 offset:8192
    v_mfma_f32_16x16x32_bf16 v[76:79], v[120:123], v[56:59], v[76:79]
    ds_read_b128 v[48:51], v11 offset:8448
    v_mfma_f32_16x16x32_bf16 v[80:83], v[192:195], v[52:55], v[80:83]
    ds_read_b128 v[64:67], v19 offset:22528
    v_mfma_f32_16x16x32_bf16 v[84:87], v[192:195], v[56:59], v[84:87]
    v_mfma_f32_16x16x32_bf16 v[88:91], v[68:71], v[56:59], v[88:91]
    s_waitcnt lgkmcnt(3)
    v_mfma_f32_16x16x32_bf16 v[72:75], v[124:127], v[36:39], v[72:75]
    ds_read_b128 v[52:55], v11 offset:10240
    v_mfma_f32_16x16x32_bf16 v[76:79], v[124:127], v[40:43], v[76:79]
    ds_read_b128 v[56:59], v11 offset:10496
    v_mfma_f32_16x16x32_bf16 v[80:83], v[196:199], v[36:39], v[80:83]
    ds_read_b128 v[68:71], v19 offset:23552
    v_mfma_f32_16x16x32_bf16 v[84:87], v[196:199], v[40:43], v[84:87]
    v_mfma_f32_16x16x32_bf16 v[88:91], v[60:63], v[40:43], v[88:91]
    s_waitcnt lgkmcnt(3)
    v_mfma_f32_16x16x32_bf16 v[72:75], v[128:131], v[44:47], v[72:75]
    ds_read_b128 v[36:39], v11 offset:12288
    v_mfma_f32_16x16x32_bf16 v[76:79], v[128:131], v[48:51], v[76:79]
    ds_read_b128 v[40:43], v11 offset:12544
    v_mfma_f32_16x16x32_bf16 v[80:83], v[200:203], v[44:47], v[80:83]
    ds_read_b128 v[60:63], v19 offset:24576
    v_mfma_f32_16x16x32_bf16 v[84:87], v[200:203], v[48:51], v[84:87]
    v_mfma_f32_16x16x32_bf16 v[88:91], v[64:67], v[48:51], v[88:91]
    s_waitcnt lgkmcnt(3)
    v_mfma_f32_16x16x32_bf16 v[72:75], v[132:135], v[52:55], v[72:75]
    ds_read_b128 v[44:47], v11 offset:14336
    v_mfma_f32_16x16x32_bf16 v[76:79], v[132:135], v[56:59], v[76:79]
    ds_read_b128 v[48:51], v11 offset:14592
    v_mfma_f32_16x16x32_bf16 v[80:83], v[204:207], v[52:55], v[80:83]
    ds_read_b128 v[64:67], v19 offset:25600
    v_mfma_f32_16x16x32_bf16 v[84:87], v[204:207], v[56:59], v[84:87]
    v_mfma_f32_16x16x32_bf16 v[88:91], v[68:71], v[56:59], v[88:91]
    s_waitcnt lgkmcnt(3)
    v_mfma_f32_16x16x32_bf16 v[72:75], v[136:139], v[36:39], v[72:75]
    ds_read_b128 v[52:55], v11 offset:16384
    v_mfma_f32_16x16x32_bf16 v[76:79], v[136:139], v[40:43], v[76:79]
    ds_read_b128 v[56:59], v11 offset:16640
    v_mfma_f32_16x16x32_bf16 v[80:83], v[208:211], v[36:39], v[80:83]
    ds_read_b128 v[68:71], v19 offset:26624
    v_mfma_f32_16x16x32_bf16 v[84:87], v[208:211], v[40:43], v[84:87]
    v_mfma_f32_16x16x32_bf16 v[88:91], v[60:63], v[40:43], v[88:91]
    s_waitcnt lgkmcnt(3)
    v_mfma_f32_16x16x32_bf16 v[72:75], v[140:143], v[44:47], v[72:75]
    ds_read_b128 v[36:39], v11 offset:18432
    v_mfma_f32_16x16x32_bf16 v[76:79], v[140:143], v[48:51], v[76:79]
    ds_read_b128 v[40:43], v11 offset:18688
    v_mfma_f32_16x16x32_bf16 v[80:83], v[212:215], v[44:47], v[80:83]
    ds_read_b128 v[60:63], v19 offset:27648
    v_mfma_f32_16x16x32_bf16 v[84:87], v[212:215], v[48:51], v[84:87]
    v_mfma_f32_16x16x32_bf16 v[88:91], v[64:67], v[48:51], v[88:91]
    s_waitcnt lgkmcnt(3)
    v_mfma_f32_16x16x32_bf16 v[72:75], v[144:147], v[52:55], v[72:75]
    ds_read_b128 v[44:47], v11 offset:20480
    v_mfma_f32_16x16x32_bf16 v[76:79], v[144:147], v[56:59], v[76:79]
    ds_read_b128 v[48:51], v11 offset:20736
    v_mfma_f32_16x16x32_bf16 v[80:83], v[216:219], v[52:55], v[80:83]
    ds_read_b128 v[64:67], v19 offset:28672
    v_mfma_f32_16x16x32_bf16 v[84:87], v[216:219], v[56:59], v[84:87]
    v_mfma_f32_16x16x32_bf16 v[88:91], v[68:71], v[56:59], v[88:91]
    s_waitcnt lgkmcnt(3)
    v_mfma_f32_16x16x32_bf16 v[72:75], v[148:151], v[36:39], v[72:75]
    ds_read_b128 v[52:55], v11 offset:22528
    v_mfma_f32_16x16x32_bf16 v[76:79], v[148:151], v[40:43], v[76:79]
    ds_read_b128 v[56:59], v11 offset:22784
    v_mfma_f32_16x16x32_bf16 v[80:83], v[220:223], v[36:39], v[80:83]
    ds_read_b128 v[68:71], v19 offset:29696
    v_mfma_f32_16x16x32_bf16 v[84:87], v[220:223], v[40:43], v[84:87]
    v_mfma_f32_16x16x32_bf16 v[88:91], v[60:63], v[40:43], v[88:91]
    s_waitcnt lgkmcnt(3)
    v_mfma_f32_16x16x32_bf16 v[72:75], v[152:155], v[44:47], v[72:75]
    ds_read_b128 v[36:39], v11 offset:24576
    v_mfma_f32_16x16x32_bf16 v[76:79], v[152:155], v[48:51], v[76:79]
    ds_read_b128 v[40:43], v11 offset:24832
    v_mfma_f32_16x16x32_bf16 v[80:83], v[224:227], v[44:47], v[80:83]
    ds_read_b128 v[60:63], v19 offset:30720
    v_mfma_f32_16x16x32_bf16 v[84:87], v[224:227], v[48:51], v[84:87]
    v_mfma_f32_16x16x32_bf16 v[88:91], v[64:67], v[48:51], v[88:91]
    s_waitcnt lgkmcnt(3)
    v_mfma_f32_16x16x32_bf16 v[72:75], v[156:159], v[52:55], v[72:75]
    ds_read_b128 v[44:47], v11 offset:26624
    v_mfma_f32_16x16x32_bf16 v[76:79], v[156:159], v[56:59], v[76:79]
    ds_read_b128 v[48:51], v11 offset:26880
    v_mfma_f32_16x16x32_bf16 v[80:83], v[228:231], v[52:55], v[80:83]
    ds_read_b128 v[64:67], v19 offset:31744
    v_mfma_f32_16x16x32_bf16 v[84:87], v[228:231], v[56:59], v[84:87]
    v_mfma_f32_16x16x32_bf16 v[88:91], v[68:71], v[56:59], v[88:91]
    s_waitcnt lgkmcnt(3)
    v_mfma_f32_16x16x32_bf16 v[72:75], v[160:163], v[36:39], v[72:75]
    ds_read_b128 v[52:55], v11 offset:28672
    v_mfma_f32_16x16x32_bf16 v[76:79], v[160:163], v[40:43], v[76:79]
    ds_read_b128 v[56:59], v11 offset:28928
    v_mfma_f32_16x16x32_bf16 v[80:83], v[232:235], v[36:39], v[80:83]
    ds_read_b128 v[68:71], v19 offset:32768
    v_mfma_f32_16x16x32_bf16 v[84:87], v[232:235], v[40:43], v[84:87]
    v_mfma_f32_16x16x32_bf16 v[88:91], v[60:63], v[40:43], v[88:91]
    s_waitcnt lgkmcnt(3)
    v_mfma_f32_16x16x32_bf16 v[72:75], v[164:167], v[44:47], v[72:75]
    ds_read_b128 v[36:39], v11 offset:30720
    v_mfma_f32_16x16x32_bf16 v[76:79], v[164:167], v[48:51], v[76:79]
    ds_read_b128 v[40:43], v11 offset:30976
    v_mfma_f32_16x16x32_bf16 v[80:83], v[236:239], v[44:47], v[80:83]
    ds_read_b128 v[60:63], v19 offset:33792
    v_mfma_f32_16x16x32_bf16 v[84:87], v[236:239], v[48:51], v[84:87]
    v_mfma_f32_16x16x32_bf16 v[88:91], v[64:67], v[48:51], v[88:91]
    s_waitcnt lgkmcnt(3)
    v_mfma_f32_16x16x32_bf16 v[72:75], v[168:171], v[52:55], v[72:75]
    ds_read_b128 v[44:47], v11 offset:32768
    v_mfma_f32_16x16x32_bf16 v[76:79], v[168:171], v[56:59], v[76:79]
    ds_read_b128 v[48:51], v11 offset:33024
    v_mfma_f32_16x16x32_bf16 v[80:83], v[240:243], v[52:55], v[80:83]
    ds_read_b128 v[64:67], v19 offset:34816
    v_mfma_f32_16x16x32_bf16 v[84:87], v[240:243], v[56:59], v[84:87]
    v_mfma_f32_16x16x32_bf16 v[88:91], v[68:71], v[56:59], v[88:91]
    s_waitcnt lgkmcnt(3)
    v_mfma_f32_16x16x32_bf16 v[72:75], v[172:175], v[36:39], v[72:75]
    ds_read_b128 v[52:55], v11 offset:34816
    v_mfma_f32_16x16x32_bf16 v[76:79], v[172:175], v[40:43], v[76:79]
    ds_read_b128 v[56:59], v11 offset:35072
    v_mfma_f32_16x16x32_bf16 v[80:83], v[244:247], v[36:39], v[80:83]
    ds_read_b128 v[68:71], v19 offset:35840
    v_mfma_f32_16x16x32_bf16 v[84:87], v[244:247], v[40:43], v[84:87]
    v_mfma_f32_16x16x32_bf16 v[88:91], v[60:63], v[40:43], v[88:91]
    s_waitcnt lgkmcnt(3)
    v_mfma_f32_16x16x32_bf16 v[72:75], v[176:179], v[44:47], v[72:75]
    v_mfma_f32_16x16x32_bf16 v[76:79], v[176:179], v[48:51], v[76:79]
    v_mfma_f32_16x16x32_bf16 v[80:83], v[248:251], v[44:47], v[80:83]
    v_mfma_f32_16x16x32_bf16 v[84:87], v[248:251], v[48:51], v[84:87]
    v_mfma_f32_16x16x32_bf16 v[88:91], v[64:67], v[48:51], v[88:91]
    s_waitcnt lgkmcnt(0)
    v_mfma_f32_16x16x32_bf16 v[72:75], v[180:183], v[52:55], v[72:75]
    v_mfma_f32_16x16x32_bf16 v[76:79], v[180:183], v[56:59], v[76:79]
    v_mfma_f32_16x16x32_bf16 v[80:83], v[252:255], v[52:55], v[80:83]
    v_mfma_f32_16x16x32_bf16 v[84:87], v[252:255], v[56:59], v[84:87]
    v_mfma_f32_16x16x32_bf16 v[88:91], v[68:71], v[56:59], v[88:91]
Le_0_75:
    s_nop 3
    v_cvt_pk_bf16_f32 v72, v72, v73
    v_cvt_pk_bf16_f32 v73, v74, v75
    v_cvt_pk_bf16_f32 v74, v76, v77
    v_cvt_pk_bf16_f32 v75, v78, v79
    s_nop 0
    v_permlane16_swap_b32 v72, v74
    v_permlane16_swap_b32 v73, v75
    buffer_store_dwordx4 v[72:75], v3, s[8:11], s22 offen offset:0 sc1
    v_cvt_pk_bf16_f32 v80, v80, v81
    v_cvt_pk_bf16_f32 v81, v82, v83
    v_cvt_pk_bf16_f32 v82, v84, v85
    v_cvt_pk_bf16_f32 v83, v86, v87
    s_nop 0
    v_permlane16_swap_b32 v80, v82
    v_permlane16_swap_b32 v81, v83
    buffer_store_dwordx4 v[80:83], v3, s[8:11], s22 offen offset:1024 sc1
    v_mov_b32 v24, 0
    v_mov_b32 v25, 0
    v_dot2_f32_bf16 v24, v72, s20, v24
    v_dot2_f32_bf16 v25, v72, v72, v25
    v_dot2_f32_bf16 v24, v73, s20, v24
    v_dot2_f32_bf16 v25, v73, v73, v25
    v_dot2_f32_bf16 v24, v74, s20, v24
    v_dot2_f32_bf16 v25, v74, v74, v25
    v_dot2_f32_bf16 v24, v75, s20, v24
    v_dot2_f32_bf16 v25, v75, v75, v25
    v_dot2_f32_bf16 v24, v80, s20, v24
    v_dot2_f32_bf16 v25, v80, v80, v25
    v_dot2_f32_bf16 v24, v81, s20, v24
    v_dot2_f32_bf16 v25, v81, v81, v25
    v_dot2_f32_bf16 v24, v82, s20, v24
    v_dot2_f32_bf16 v25, v82, v82, v25
    v_dot2_f32_bf16 v24, v83, s20, v24
    v_dot2_f32_bf16 v25, v83, v83, v25
    s_cmp_ge_u32 s24, 6
    s_cbranch_scc1 Le_0_76
    s_cmp_eq_u32 s24, 5
    s_cbranch_scc1 Le_0_77
    v_cvt_pk_bf16_f32 v88, v88, v89
    v_cvt_pk_bf16_f32 v89, v90, v91
    buffer_store_dwordx2 v[88:89], v7, s[8:11], s23 offen offset:0 sc1
    v_dot2_f32_bf16 v20, v88, s20, v20
    v_dot2_f32_bf16 v21, v88, v88, v21
    v_dot2_f32_bf16 v20, v89, s20, v20
    v_dot2_f32_bf16 v21, v89, v89, v21
    s_branch Le_0_76
Le_0_77:
    v_cvt_pk_bf16_f32 v88, v88, v89
    v_cvt_pk_bf16_f32 v89, v90, v91
    buffer_store_dwordx2 v[88:89], v7, s[8:11], s23 offen offset:0 sc1
    v_dot2_f32_bf16 v22, v88, s20, v22
    v_dot2_f32_bf16 v23, v88, v88, v23
    v_dot2_f32_bf16 v22, v89, s20, v22
    v_dot2_f32_bf16 v23, v89, v89, v23
Le_0_76:
    s_nop 1
    v_permlane16_swap_b32 v20, v22
    v_permlane16_swap_b32 v21, v23
    v_add_f32 v20, v20, v22
    v_add_f32 v21, v21, v23
    v_add_f32 v20, v20, v24
    v_add_f32 v21, v21, v25
    v_mov_b32 v22, v20
    v_mov_b32 v23, v21
    s_nop 0
    v_permlane32_swap_b32 v20, v22
    v_permlane32_swap_b32 v21, v23
    v_add_f32 v20, v20, v22
    v_add_f32 v21, v21, v23
    buffer_store_dwordx2 v[20:21], v12, s[8:11], s29 offen sc1
    s_waitcnt vmcnt(0)
Le_0_78:
    s_barrier
    s_cmp_lg_u32 s24, 6
    s_cbranch_scc1 Lx_0_83
    s_lshl_b32 s3, s2, 3
    s_add_u32 s3, s3, 1
    s_lshl_b32 s3, s3, 8
    v_mov_b32 v20, 32768
    v_mov_b32 v21, 1
    s_mov_b64 exec, 1
    buffer_store_dword v21, v20, s[8:11], s3 offen offset:0 sc1
    s_mov_b64 exec, -1
Lx_0_83:
    s_bfe_u32 s12, s2, 0x10002
    s_lshl_b32 s12, s12, 3
    s_bfe_u32 s14, s2, 0x20003
    s_lshl_b32 s14, s14, 1
    s_lshr_b32 s13, s2, 7
    s_add_u32 s14, s14, s13
    s_add_u32 s12, s12, s14
    s_and_b32 s26, s2, 3
    s_bfe_u32 s27, s2, 0x20005
    s_lshl_b32 s13, s26, 2
    s_add_u32 s13, s13, s27
    s_cmp_ge_u32 s24, 4
    s_cbranch_scc1 LLd_0_4
    s_and_b32 s25, s24, 3
    s_lshl_b32 s16, s12, 2
    s_add_u32 s16, s16, s25
    v_and_b32 v4, 31, v1
    v_lshrrev_b32 v5, 5, v1
    v_lshrrev_b32 v7, 4, v4
    v_lshlrev_b32 v7, 10, v7
    v_lshl_add_u32 v7, v5, 8, v7
    v_and_b32 v8, 15, v1
    v_lshl_add_u32 v7, v8, 4, v7
    s_mul_i32 s21, s12, 1179648
    s_mul_i32 s22, s13, 73728
    s_add_u32 s21, s21, s22
    s_lshl_b32 s22, s25, 11
    s_add_u32 s21, s21, s22
    s_add_u32 s21, s21, 30101504
    v_lshlrev_b32 v9, 4, v5
    v_add_u32 v9, 147456, v9
    s_add_u32 s22, s22, 148736
    v_add_u32 v10, s22, v3
    s_mul_i32 s15, s16, 36864
    s_add_u32 s15, s15, 27414528
    v_add_u32 v18, 0x10000, v3
    v_add_u32 v19, 0x20000, v3
    s_and_b32 s22, s16, 7
    s_lshl_b32 s22, s22, 5
    s_lshr_b32 s23, s16, 3
    s_add_u32 s22, s22, s23
    s_lshl_b32 s22, s22, 11
    s_add_u32 s22, s22, 33024
    v_and_b32 v20, 3, v1
    v_lshl_add_u32 v20, v20, 14, s22
Lpo_0_84:
    buffer_load_dword v22, v20, s[8:11], 0 offen sc1
    s_sub_u32 s38, s38, 1
    s_cmp_lt_i32 s38, 0
    s_cbranch_scc1 Lpx_0_85
    s_waitcnt vmcnt(0)
    v_cmp_eq_u32 vcc, 0, v22
    s_nop 0
    s_cbranch_vccz Lpx_0_85
    s_sleep 0
    s_branch Lpo_0_84
Lpx_0_85:
    s_waitcnt vmcnt(0)
    s_add_u32 s17, s27, 0
    s_and_b32 s17, s17, 3
    s_mul_i32 s17, s17, 9216
    s_add_u32 s17, s17, s15
    buffer_load_dwordx4 v[112:115], v3, s[8:11], s17 offen offset:0 sc1
    buffer_load_dwordx4 v[116:119], v3, s[8:11], s17 offen offset:1024 sc1
    buffer_load_dwordx4 v[120:123], v3, s[8:11], s17 offen offset:2048 sc1
    buffer_load_dwordx4 v[124:127], v3, s[8:11], s17 offen offset:3072 sc1
    s_add_u32 s17, s17, 4096
    buffer_load_dwordx4 v[128:131], v3, s[8:11], s17 offen offset:0 sc1
    buffer_load_dwordx4 v[132:135], v3, s[8:11], s17 offen offset:1024 sc1
    buffer_load_dwordx4 v[136:139], v3, s[8:11], s17 offen offset:2048 sc1
    buffer_load_dwordx4 v[140:143], v3, s[8:11], s17 offen offset:3072 sc1
    s_add_u32 s17, s17, 4096
    buffer_load_dwordx4 v[144:147], v3, s[8:11], s17 offen offset:0 sc1
    s_add_u32 s17, s27, 1
    s_and_b32 s17, s17, 3
    s_mul_i32 s17, s17, 9216
    s_add_u32 s17, s17, s15
    buffer_load_dwordx4 v[148:151], v3, s[8:11], s17 offen offset:0 sc1
    ds_read_b128 v[20:23], v3 offset:0
    ds_read_b128 v[24:27], v3 offset:36864
    ds_read_b128 v[28:31], v3 offset:1024
    ds_read_b128 v[32:35], v3 offset:37888
    ds_read_b128 v[36:39], v3 offset:2048
    ds_read_b128 v[40:43], v3 offset:38912
    ds_read_b128 v[44:47], v3 offset:3072
    ds_read_b128 v[48:51], v3 offset:39936
    s_waitcnt vmcnt(9) lgkmcnt(6)
    v_mfma_f32_32x32x16_bf16 v[64:79], v[20:23], v[112:115], 0
    ds_read_b128 v[52:55], v3 offset:4096
    buffer_load_dwordx4 v[152:155], v3, s[8:11], s17 offen offset:1024 sc1
    v_mfma_f32_32x32x16_bf16 v[80:95], v[24:27], v[112:115], 0
    ds_read_b128 v[20:23], v3 offset:40960
    buffer_load_dwordx4 v[156:159], v3, s[8:11], s17 offen offset:2048 sc1
    s_waitcnt vmcnt(10) lgkmcnt(6)
    v_mfma_f32_32x32x16_bf16 v[64:79], v[28:31], v[116:119], v[64:79]
    ds_read_b128 v[24:27], v3 offset:5120
    buffer_load_dwordx4 v[160:163], v3, s[8:11], s17 offen offset:3072 sc1
    s_add_u32 s17, s17, 4096
    v_mfma_f32_32x32x16_bf16 v[80:95], v[32:35], v[116:119], v[80:95]
    ds_read_b128 v[28:31], v3 offset:41984
    buffer_load_dwordx4 v[164:167], v3, s[8:11], s17 offen offset:0 sc1
    s_waitcnt vmcnt(11) lgkmcnt(6)
    v_mfma_f32_32x32x16_bf16 v[64:79], v[36:39], v[120:123], v[64:79]
    ds_read_b128 v[32:35], v3 offset:6144
    buffer_load_dwordx4 v[168:171], v3, s[8:11], s17 offen offset:1024 sc1
    v_mfma_f32_32x32x16_bf16 v[80:95], v[40:43], v[120:123], v[80:95]
    ds_read_b128 v[36:39], v3 offset:43008
    buffer_load_dwordx4 v[172:175], v3, s[8:11], s17 offen offset:2048 sc1
    s_waitcnt vmcnt(12) lgkmcnt(6)
    v_mfma_f32_32x32x16_bf16 v[64:79], v[44:47], v[124:127], v[64:79]
    ds_read_b128 v[40:43], v3 offset:7168
    buffer_load_dwordx4 v[176:179], v3, s[8:11], s17 offen offset:3072 sc1
    s_add_u32 s17, s17, 4096
    v_mfma_f32_32x32x16_bf16 v[80:95], v[48:51], v[124:127], v[80:95]
    ds_read_b128 v[44:47], v3 offset:44032
    buffer_load_dwordx4 v[180:183], v3, s[8:11], s17 offen offset:0 sc1
    s_waitcnt vmcnt(13) lgkmcnt(6)
    v_mfma_f32_32x32x16_bf16 v[64:79], v[52:55], v[128:131], v[64:79]
    s_barrier
    ds_read_b128 v[48:51], v3 offset:8192
    s_add_u32 s17, s27, 2
    s_and_b32 s17, s17, 3
    s_mul_i32 s17, s17, 9216
    s_add_u32 s17, s17, s15
    buffer_load_dwordx4 v[184:187], v3, s[8:11], s17 offen offset:0 sc1
    v_mfma_f32_32x32x16_bf16 v[80:95], v[20:23], v[128:131], v[80:95]
    ds_read_b128 v[52:55], v3 offset:45056
    buffer_load_dwordx4 v[188:191], v3, s[8:11], s17 offen offset:1024 sc1
    s_waitcnt vmcnt(14) lgkmcnt(6)
    v_mfma_f32_32x32x16_bf16 v[64:79], v[24:27], v[132:135], v[64:79]
    ds_read_b128 v[20:23], v3 offset:9216
    buffer_load_dwordx4 v[192:195], v3, s[8:11], s17 offen offset:2048 sc1
    v_mfma_f32_32x32x16_bf16 v[80:95], v[28:31], v[132:135], v[80:95]
    ds_read_b128 v[24:27], v3 offset:46080
    buffer_load_dwordx4 v[196:199], v3, s[8:11], s17 offen offset:3072 sc1
    s_add_u32 s17, s17, 4096
    s_waitcnt vmcnt(15) lgkmcnt(6)
    v_mfma_f32_32x32x16_bf16 v[64:79], v[32:35], v[136:139], v[64:79]
    ds_read_b128 v[28:31], v3 offset:10240
    buffer_load_dwordx4 v[200:203], v3, s[8:11], s17 offen offset:0 sc1
    v_mfma_f32_32x32x16_bf16 v[80:95], v[36:39], v[136:139], v[80:95]
    ds_read_b128 v[32:35], v3 offset:47104
    buffer_load_dwordx4 v[204:207], v3, s[8:11], s17 offen offset:1024 sc1
    s_waitcnt vmcnt(16) lgkmcnt(6)
    v_mfma_f32_32x32x16_bf16 v[64:79], v[40:43], v[140:143], v[64:79]
    ds_read_b128 v[36:39], v3 offset:11264
    buffer_load_dwordx4 v[208:211], v3, s[8:11], s17 offen offset:2048 sc1
    v_mfma_f32_32x32x16_bf16 v[80:95], v[44:47], v[140:143], v[80:95]
    ds_read_b128 v[40:43], v3 offset:48128
    buffer_load_dwordx4 v[212:215], v3, s[8:11], s17 offen offset:3072 sc1
    s_add_u32 s17, s17, 4096
    s_waitcnt vmcnt(17) lgkmcnt(6)
    v_mfma_f32_32x32x16_bf16 v[64:79], v[48:51], v[144:147], v[64:79]
    ds_read_b128 v[44:47], v3 offset:12288
    buffer_load_dwordx4 v[216:219], v3, s[8:11], s17 offen offset:0 sc1
    v_mfma_f32_32x32x16_bf16 v[80:95], v[52:55], v[144:147], v[80:95]
    ds_read_b128 v[48:51], v3 offset:49152
    s_add_u32 s17, s27, 3
    s_and_b32 s17, s17, 3
    s_mul_i32 s17, s17, 9216
    s_add_u32 s17, s17, s15
    buffer_load_dwordx4 v[220:223], v3, s[8:11], s17 offen offset:0 sc1
    s_waitcnt vmcnt(18) lgkmcnt(6)
    v_mfma_f32_32x32x16_bf16 v[64:79], v[20:23], v[148:151], v[64:79]
    ds_read_b128 v[52:55], v3 offset:13312
    buffer_load_dwordx4 v[224:227], v3, s[8:11], s17 offen offset:1024 sc1
    v_mfma_f32_32x32x16_bf16 v[80:95], v[24:27], v[148:151], v[80:95]
    ds_read_b128 v[20:23], v3 offset:50176
    buffer_load_dwordx4 v[228:231], v3, s[8:11], s17 offen offset:2048 sc1
    s_waitcnt vmcnt(19) lgkmcnt(6)
    v_mfma_f32_32x32x16_bf16 v[64:79], v[28:31], v[152:155], v[64:79]
    ds_read_b128 v[24:27], v3 offset:14336
    buffer_load_dwordx4 v[232:235], v3, s[8:11], s17 offen offset:3072 sc1
    s_add_u32 s17, s17, 4096
    v_mfma_f32_32x32x16_bf16 v[80:95], v[32:35], v[152:155], v[80:95]
    ds_read_b128 v[28:31], v3 offset:51200
    buffer_load_dwordx4 v[236:239], v3, s[8:11], s17 offen offset:0 sc1
    s_waitcnt vmcnt(20) lgkmcnt(6)
    v_mfma_f32_32x32x16_bf16 v[64:79], v[36:39], v[156:159], v[64:79]
    ds_read_b128 v[32:35], v3 offset:15360
    buffer_load_dwordx4 v[240:243], v3, s[8:11], s17 offen offset:1024 sc1
    v_mfma_f32_32x32x16_bf16 v[80:95], v[40:43], v[156:159], v[80:95]
    ds_read_b128 v[36:39], v3 offset:52224
    buffer_load_dwordx4 v[244:247], v3, s[8:11], s17 offen offset:2048 sc1
    s_waitcnt vmcnt(21) lgkmcnt(6)
    v_mfma_f32_32x32x16_bf16 v[64:79], v[44:47], v[160:163], v[64:79]
    ds_read_b128 v[40:43], v3 offset:16384
    buffer_load_dwordx4 v[248:251], v3, s[8:11], s17 offen offset:3072 sc1
    s_add_u32 s17, s17, 4096
    v_mfma_f32_32x32x16_bf16 v[80:95], v[48:51], v[160:163], v[80:95]
    ds_read_b128 v[44:47], v3 offset:53248
    buffer_load_dwordx4 v[252:255], v3, s[8:11], s17 offen offset:0 sc1
    s_waitcnt vmcnt(22) lgkmcnt(6)
    v_mfma_f32_32x32x16_bf16 v[64:79], v[52:55], v[164:167], v[64:79]
    ds_read_b128 v[48:51], v3 offset:17408
    v_mfma_f32_32x32x16_bf16 v[80:95], v[20:23], v[164:167], v[80:95]
    ds_read_b128 v[52:55], v3 offset:54272
    s_waitcnt vmcnt(21) lgkmcnt(6)
    v_mfma_f32_32x32x16_bf16 v[64:79], v[24:27], v[168:171], v[64:79]
    ds_read_b128 v[20:23], v3 offset:18432
    v_mfma_f32_32x32x16_bf16 v[80:95], v[28:31], v[168:171], v[80:95]
    ds_read_b128 v[24:27], v3 offset:55296
    s_waitcnt vmcnt(20) lgkmcnt(6)
    v_mfma_f32_32x32x16_bf16 v[64:79], v[32:35], v[172:175], v[64:79]
    ds_read_b128 v[28:31], v3 offset:19456
    v_mfma_f32_32x32x16_bf16 v[80:95], v[36:39], v[172:175], v[80:95]
    ds_read_b128 v[32:35], v3 offset:56320
    s_waitcnt vmcnt(19) lgkmcnt(6)
    v_mfma_f32_32x32x16_bf16 v[64:79], v[40:43], v[176:179], v[64:79]
    ds_read_b128 v[36:39], v3 offset:20480
    v_mfma_f32_32x32x16_bf16 v[80:95], v[44:47], v[176:179], v[80:95]
    ds_read_b128 v[40:43], v3 offset:57344
    s_waitcnt vmcnt(18) lgkmcnt(6)
    v_mfma_f32_32x32x16_bf16 v[64:79], v[48:51], v[180:183], v[64:79]
    ds_read_b128 v[44:47], v3 offset:21504
    v_mfma_f32_32x32x16_bf16 v[80:95], v[52:55], v[180:183], v[80:95]
    ds_read_b128 v[48:51], v3 offset:58368
    s_waitcnt vmcnt(17) lgkmcnt(6)
    v_mfma_f32_32x32x16_bf16 v[64:79], v[20:23], v[184:187], v[64:79]
    ds_read_b128 v[52:55], v3 offset:22528
    v_mfma_f32_32x32x16_bf16 v[80:95], v[24:27], v[184:187], v[80:95]
    ds_read_b128 v[20:23], v3 offset:59392
    s_waitcnt vmcnt(16) lgkmcnt(6)
    v_mfma_f32_32x32x16_bf16 v[64:79], v[28:31], v[188:191], v[64:79]
    ds_read_b128 v[24:27], v3 offset:23552
    v_mfma_f32_32x32x16_bf16 v[80:95], v[32:35], v[188:191], v[80:95]
    ds_read_b128 v[28:31], v3 offset:60416
    s_waitcnt vmcnt(15) lgkmcnt(6)
    v_mfma_f32_32x32x16_bf16 v[64:79], v[36:39], v[192:195], v[64:79]
    ds_read_b128 v[32:35], v3 offset:24576
    v_mfma_f32_32x32x16_bf16 v[80:95], v[40:43], v[192:195], v[80:95]
    ds_read_b128 v[36:39], v3 offset:61440
    s_waitcnt vmcnt(14) lgkmcnt(6)
    v_mfma_f32_32x32x16_bf16 v[64:79], v[44:47], v[196:199], v[64:79]
    ds_read_b128 v[40:43], v3 offset:25600
    v_mfma_f32_32x32x16_bf16 v[80:95], v[48:51], v[196:199], v[80:95]
    ds_read_b128 v[44:47], v3 offset:62464
    s_waitcnt vmcnt(13) lgkmcnt(6)
    v_mfma_f32_32x32x16_bf16 v[64:79], v[52:55], v[200:203], v[64:79]
    ds_read_b128 v[48:51], v3 offset:26624
    v_mfma_f32_32x32x16_bf16 v[80:95], v[20:23], v[200:203], v[80:95]
    ds_read_b128 v[52:55], v3 offset:63488
    s_waitcnt vmcnt(12) lgkmcnt(6)
    v_mfma_f32_32x32x16_bf16 v[64:79], v[24:27], v[204:207], v[64:79]
    ds_read_b128 v[20:23], v3 offset:27648
    v_mfma_f32_32x32x16_bf16 v[80:95], v[28:31], v[204:207], v[80:95]
    ds_read_b128 v[24:27], v3 offset:64512
    s_waitcnt vmcnt(11) lgkmcnt(6)
    v_mfma_f32_32x32x16_bf16 v[64:79], v[32:35], v[208:211], v[64:79]
    ds_read_b128 v[28:31], v3 offset:28672
    v_mfma_f32_32x32x16_bf16 v[80:95], v[36:39], v[208:211], v[80:95]
    ds_read_b128 v[32:35], v18 offset:0
    s_waitcnt vmcnt(10) lgkmcnt(6)
    v_mfma_f32_32x32x16_bf16 v[64:79], v[40:43], v[212:215], v[64:79]
    ds_read_b128 v[36:39], v3 offset:29696
    v_mfma_f32_32x32x16_bf16 v[80:95], v[44:47], v[212:215], v[80:95]
    ds_read_b128 v[40:43], v18 offset:1024
    s_waitcnt vmcnt(9) lgkmcnt(6)
    v_mfma_f32_32x32x16_bf16 v[64:79], v[48:51], v[216:219], v[64:79]
    ds_read_b128 v[44:47], v3 offset:30720
    v_mfma_f32_32x32x16_bf16 v[80:95], v[52:55], v[216:219], v[80:95]
    ds_read_b128 v[48:51], v18 offset:2048
    s_waitcnt vmcnt(8) lgkmcnt(6)
    v_mfma_f32_32x32x16_bf16 v[64:79], v[20:23], v[220:223], v[64:79]
    ds_read_b128 v[52:55], v3 offset:31744
    v_mfma_f32_32x32x16_bf16 v[80:95], v[24:27], v[220:223], v[80:95]
    ds_read_b128 v[20:23], v18 offset:3072
    s_waitcnt vmcnt(7) lgkmcnt(6)
    v_mfma_f32_32x32x16_bf16 v[64:79], v[28:31], v[224:227], v[64:79]
    ds_read_b128 v[24:27], v3 offset:32768
    v_mfma_f32_32x32x16_bf16 v[80:95], v[32:35], v[224:227], v[80:95]
    ds_read_b128 v[28:31], v18 offset:4096
    s_waitcnt vmcnt(6) lgkmcnt(6)
    v_mfma_f32_32x32x16_bf16 v[64:79], v[36:39], v[228:231], v[64:79]
    ds_read_b128 v[32:35], v3 offset:33792
    v_mfma_f32_32x32x16_bf16 v[80:95], v[40:43], v[228:231], v[80:95]
    ds_read_b128 v[36:39], v18 offset:5120
    s_waitcnt vmcnt(5) lgkmcnt(6)
    v_mfma_f32_32x32x16_bf16 v[64:79], v[44:47], v[232:235], v[64:79]
    ds_read_b128 v[40:43], v3 offset:34816
    v_mfma_f32_32x32x16_bf16 v[80:95], v[48:51], v[232:235], v[80:95]
    ds_read_b128 v[44:47], v18 offset:6144
    s_waitcnt vmcnt(4) lgkmcnt(6)
    v_mfma_f32_32x32x16_bf16 v[64:79], v[52:55], v[236:239], v[64:79]
    ds_read_b128 v[48:51], v3 offset:35840
    v_mfma_f32_32x32x16_bf16 v[80:95], v[20:23], v[236:239], v[80:95]
    ds_read_b128 v[52:55], v18 offset:7168
    s_waitcnt vmcnt(3) lgkmcnt(6)
    v_mfma_f32_32x32x16_bf16 v[64:79], v[24:27], v[240:243], v[64:79]
    ds_read_b128 v[20:23], v18 offset:8192
    v_mfma_f32_32x32x16_bf16 v[80:95], v[28:31], v[240:243], v[80:95]
    ds_read_b128 v[24:27], v18 offset:9216
    s_waitcnt vmcnt(2) lgkmcnt(6)
    v_mfma_f32_32x32x16_bf16 v[64:79], v[32:35], v[244:247], v[64:79]
    ds_read_b128 v[28:31], v18 offset:10240
    v_mfma_f32_32x32x16_bf16 v[80:95], v[36:39], v[244:247], v[80:95]
    s_barrier
    ds_read_b128 v[12:15], v10
    ds_read_b128 v[32:35], v18 offset:11264
    s_waitcnt vmcnt(1) lgkmcnt(7)
    v_mfma_f32_32x32x16_bf16 v[64:79], v[40:43], v[248:251], v[64:79]
    ds_read_b128 v[36:39], v18 offset:12288
    v_mfma_f32_32x32x16_bf16 v[80:95], v[44:47], v[248:251], v[80:95]
    ds_read_b128 v[40:43], v18 offset:13312
    s_waitcnt vmcnt(0) lgkmcnt(7)
    v_mfma_f32_32x32x16_bf16 v[64:79], v[48:51], v[252:255], v[64:79]
    ds_read_b128 v[44:47], v18 offset:14336
    v_mfma_f32_32x32x16_bf16 v[80:95], v[52:55], v[252:255], v[80:95]
    ds_read_b128 v[48:51], v18 offset:15360
    s_waitcnt lgkmcnt(7)
    v_mfma_f32_32x32x16_bf16 v[96:111], v[20:23], v[112:115], 0
    s_waitcnt lgkmcnt(5)
    ds_read_b128 v[52:55], v18 offset:16384
    ds_read_b128 v[56:59], v9 offset:0
    ds_read_b128 v[60:63], v9 offset:32
    v_mfma_f32_32x32x16_bf16 v[96:111], v[24:27], v[116:119], v[96:111]
    ds_read_b128 v[20:23], v18 offset:17408
    s_waitcnt lgkmcnt(8)
    v_mfma_f32_32x32x16_bf16 v[96:111], v[28:31], v[120:123], v[96:111]
    ds_read_b128 v[24:27], v18 offset:18432
    ds_write_b128 v10, v[72:75] offset:0
    v_mfma_f32_32x32x16_bf16 v[96:111], v[32:35], v[124:127], v[96:111]
    ds_read_b128 v[28:31], v18 offset:19456
    s_waitcnt lgkmcnt(9)
    v_mfma_f32_32x32x16_bf16 v[96:111], v[36:39], v[128:131], v[96:111]
    ds_read_b128 v[32:35], v18 offset:20480
    v_mfma_f32_32x32x16_bf16 v[96:111], v[40:43], v[132:135], v[96:111]
    ds_read_b128 v[36:39], v18 offset:21504
    ds_write_b128 v10, v[76:79] offset:1024
    s_waitcnt lgkmcnt(10)
    v_mfma_f32_32x32x16_bf16 v[96:111], v[44:47], v[136:139], v[96:111]
    ds_read_b128 v[40:43], v18 offset:22528
    s_waitcnt lgkmcnt(8)
    v_fmac_f32 v64, v12, v56
    v_fmac_f32 v65, v12, v57
    v_mfma_f32_32x32x16_bf16 v[96:111], v[48:51], v[140:143], v[96:111]
    ds_read_b128 v[44:47], v18 offset:23552
    v_fmac_f32 v66, v12, v58
    v_fmac_f32 v67, v12, v59
    v_fmac_f32 v68, v12, v60
    s_waitcnt lgkmcnt(8)
    v_mfma_f32_32x32x16_bf16 v[96:111], v[52:55], v[144:147], v[96:111]
    ds_read_b128 v[48:51], v18 offset:24576
    v_fmac_f32 v69, v12, v61
    v_fmac_f32 v70, v12, v62
    v_fmac_f32 v71, v12, v63
    v_mul_f32 v56, v64, v64
    v_mfma_f32_32x32x16_bf16 v[96:111], v[20:23], v[148:151], v[96:111]
    ds_read_b128 v[52:55], v18 offset:25600
    v_mul_f32 v57, v65, v65
    v_mul_f32 v58, v66, v66
    v_mul_f32 v59, v67, v67
    s_waitcnt lgkmcnt(7)
    v_mfma_f32_32x32x16_bf16 v[96:111], v[24:27], v[152:155], v[96:111]
    ds_read_b128 v[20:23], v18 offset:26624
    v_mul_f32 v60, v68, v68
    v_mul_f32 v61, v69, v69
    v_mul_f32 v62, v70, v70
    v_mul_f32 v63, v71, v71
    v_mfma_f32_32x32x16_bf16 v[96:111], v[28:31], v[156:159], v[96:111]
    s_waitcnt lgkmcnt(5)
    s_barrier
    ds_read_b128 v[24:27], v18 offset:27648
    v_fma_f32 v56, v56, v14, v13
    v_mfma_f32_32x32x16_bf16 v[96:111], v[32:35], v[160:163], v[96:111]
    ds_read_b128 v[28:31], v18 offset:28672
    v_fma_f32 v57, v57, v14, v13
    v_fma_f32 v58, v58, v14, v13
    v_fma_f32 v59, v59, v14, v13
    v_fma_f32 v60, v60, v14, v13
    v_mfma_f32_32x32x16_bf16 v[96:111], v[36:39], v[164:167], v[96:111]
    ds_read_b128 v[32:35], v18 offset:29696
    v_fma_f32 v61, v61, v14, v13
    v_fma_f32 v62, v62, v14, v13
    v_fma_f32 v63, v63, v14, v13
    s_waitcnt lgkmcnt(6)
    v_mfma_f32_32x32x16_bf16 v[96:111], v[40:43], v[168:171], v[96:111]
    ds_read_b128 v[36:39], v18 offset:30720
    v_mul_f32 v56, v56, v64
    v_mul_f32 v57, v57, v65
    v_mul_f32 v58, v58, v66
    v_mul_f32 v59, v59, v67
    v_mfma_f32_32x32x16_bf16 v[96:111], v[44:47], v[172:175], v[96:111]
    s_barrier
    ds_read_b128 v[40:43], v18 offset:31744
    v_mul_f32 v60, v60, v68
    s_waitcnt lgkmcnt(6)
    v_mfma_f32_32x32x16_bf16 v[96:111], v[48:51], v[176:179], v[96:111]
    ds_read_b128 v[44:47], v18 offset:32768
    ds_write_b128 v10, v[88:91] offset:0
    v_mul_f32 v61, v61, v69
    v_mul_f32 v62, v62, v70
    v_mfma_f32_32x32x16_bf16 v[96:111], v[52:55], v[180:183], v[96:111]
    ds_read_b128 v[48:51], v18 offset:33792
    v_mul_f32 v63, v63, v71
    v_exp_f32 v56, v56
    s_waitcnt lgkmcnt(7)
    v_mfma_f32_32x32x16_bf16 v[96:111], v[20:23], v[184:187], v[96:111]
    ds_read_b128 v[52:55], v18 offset:34816
    v_exp_f32 v57, v57
    v_exp_f32 v58, v58
    v_mfma_f32_32x32x16_bf16 v[96:111], v[24:27], v[188:191], v[96:111]
    ds_read_b128 v[20:23], v18 offset:35840
    ds_write_b128 v10, v[92:95] offset:1024
    s_waitcnt lgkmcnt(8)
    v_mfma_f32_32x32x16_bf16 v[96:111], v[28:31], v[192:195], v[96:111]
    ds_read_b128 v[24:27], v18 offset:36864
    v_exp_f32 v59, v59
    v_exp_f32 v60, v60
    v_mfma_f32_32x32x16_bf16 v[96:111], v[32:35], v[196:199], v[96:111]
    ds_read_b128 v[28:31], v18 offset:37888
    v_exp_f32 v61, v61
    s_waitcnt lgkmcnt(8)
    v_mfma_f32_32x32x16_bf16 v[96:111], v[36:39], v[200:203], v[96:111]
    ds_read_b128 v[32:35], v18 offset:38912
    v_exp_f32 v62, v62
    v_exp_f32 v63, v63
    v_mfma_f32_32x32x16_bf16 v[96:111], v[40:43], v[204:207], v[96:111]
    ds_read_b128 v[36:39], v18 offset:39936
    v_add_f32 v56, 1.0, v56
    v_add_f32 v57, 1.0, v57
    v_add_f32 v58, 1.0, v58
    s_waitcnt lgkmcnt(7)
    v_mfma_f32_32x32x16_bf16 v[96:111], v[44:47], v[208:211], v[96:111]
    ds_read_b128 v[40:43], v18 offset:40960
    v_add_f32 v59, 1.0, v59
    v_add_f32 v60, 1.0, v60
    v_add_f32 v61, 1.0, v61
    v_add_f32 v62, 1.0, v62
    v_mfma_f32_32x32x16_bf16 v[96:111], v[48:51], v[212:215], v[96:111]
    s_waitcnt lgkmcnt(5)
    s_barrier
    ds_read_b128 v[44:47], v18 offset:41984
    v_add_f32 v63, 1.0, v63
    v_mfma_f32_32x32x16_bf16 v[96:111], v[52:55], v[216:219], v[96:111]
    ds_read_b128 v[48:51], v18 offset:43008
    v_rcp_f32 v56, v56
    v_rcp_f32 v57, v57
    v_mfma_f32_32x32x16_bf16 v[96:111], v[20:23], v[220:223], v[96:111]
    ds_read_b128 v[52:55], v18 offset:44032
    v_rcp_f32 v58, v58
    s_waitcnt lgkmcnt(6)
    v_mfma_f32_32x32x16_bf16 v[96:111], v[24:27], v[224:227], v[96:111]
    ds_read_b128 v[20:23], v18 offset:45056
    v_rcp_f32 v59, v59
    v_rcp_f32 v60, v60
    v_mfma_f32_32x32x16_bf16 v[96:111], v[28:31], v[228:231], v[96:111]
    s_barrier
    ds_read_b128 v[24:27], v18 offset:46080
    s_waitcnt lgkmcnt(6)
    v_mfma_f32_32x32x16_bf16 v[96:111], v[32:35], v[232:235], v[96:111]
    ds_read_b128 v[28:31], v18 offset:47104
    v_rcp_f32 v61, v61
    v_rcp_f32 v62, v62
    v_mfma_f32_32x32x16_bf16 v[96:111], v[36:39], v[236:239], v[96:111]
    ds_read_b128 v[32:35], v18 offset:48128
    v_rcp_f32 v63, v63
    v_mul_f32 v56, v56, v64
    s_waitcnt lgkmcnt(6)
    v_mfma_f32_32x32x16_bf16 v[96:111], v[40:43], v[240:243], v[96:111]
    ds_read_b128 v[36:39], v18 offset:49152
    v_mul_f32 v57, v57, v65
    v_mul_f32 v58, v58, v66
    v_mul_f32 v59, v59, v67
    v_mul_f32 v60, v60, v68
    v_mfma_f32_32x32x16_bf16 v[96:111], v[44:47], v[244:247], v[96:111]
    ds_read_b128 v[40:43], v18 offset:50176
    v_mul_f32 v61, v61, v69
    v_mul_f32 v62, v62, v70
    v_mul_f32 v63, v63, v71
    s_waitcnt lgkmcnt(6)
    v_mfma_f32_32x32x16_bf16 v[96:111], v[48:51], v[248:251], v[96:111]
    ds_read_b128 v[44:47], v18 offset:51200
    v_cvt_pk_bf16_f32 v64, v56, v57
    v_cvt_pk_bf16_f32 v65, v58, v59
    v_cvt_pk_bf16_f32 v66, v60, v61
    v_cvt_pk_bf16_f32 v67, v62, v63
    v_mfma_f32_32x32x16_bf16 v[96:111], v[52:55], v[252:255], v[96:111]
    ds_read_b128 v[48:51], v18 offset:52224
    s_add_u32 s23, s21, 0
    buffer_store_dwordx4 v[64:67], v7, s[8:11], s23 offen offset:0 sc1
    s_waitcnt lgkmcnt(6)
    s_nop 0
    v_mfma_f32_32x32x16_bf16 v[64:79], v[20:23], v[112:115], 0
    ds_read_b128 v[52:55], v18 offset:53248
    ds_read_b128 v[56:59], v9 offset:128
    ds_read_b128 v[60:63], v9 offset:160
    v_mfma_f32_32x32x16_bf16 v[64:79], v[24:27], v[116:119], v[64:79]
    ds_read_b128 v[20:23], v18 offset:54272
    s_waitcnt lgkmcnt(8)
    v_mfma_f32_32x32x16_bf16 v[64:79], v[28:31], v[120:123], v[64:79]
    ds_read_b128 v[24:27], v18 offset:55296
    ds_write_b128 v10, v[104:107] offset:0
    v_mfma_f32_32x32x16_bf16 v[64:79], v[32:35], v[124:127], v[64:79]
    ds_read_b128 v[28:31], v18 offset:56320
    s_waitcnt lgkmcnt(9)
    v_mfma_f32_32x32x16_bf16 v[64:79], v[36:39], v[128:131], v[64:79]
    ds_read_b128 v[32:35], v18 offset:57344
    v_mfma_f32_32x32x16_bf16 v[64:79], v[40:43], v[132:135], v[64:79]
    ds_read_b128 v[36:39], v18 offset:58368
    ds_write_b128 v10, v[108:111] offset:1024
    s_waitcnt lgkmcnt(10)
    v_mfma_f32_32x32x16_bf16 v[64:79], v[44:47], v[136:139], v[64:79]
    ds_read_b128 v[40:43], v18 offset:59392
    s_waitcnt lgkmcnt(8)
    v_fmac_f32 v80, v12, v56
    v_fmac_f32 v81, v12, v57
    v_fmac_f32 v82, v12, v58
    v_fmac_f32 v83, v12, v59
    v_mfma_f32_32x32x16_bf16 v[64:79], v[48:51], v[140:143], v[64:79]
    ds_read_b128 v[44:47], v18 offset:60416
    v_fmac_f32 v84, v12, v60
    v_fmac_f32 v85, v12, v61
    v_fmac_f32 v86, v12, v62
    s_waitcnt lgkmcnt(8)
    v_mfma_f32_32x32x16_bf16 v[64:79], v[52:55], v[144:147], v[64:79]
    ds_read_b128 v[48:51], v18 offset:61440
    v_fmac_f32 v87, v12, v63
    v_mul_f32 v56, v80, v80
    v_mul_f32 v57, v81, v81
    v_mul_f32 v58, v82, v82
    v_mfma_f32_32x32x16_bf16 v[64:79], v[20:23], v[148:151], v[64:79]
    ds_read_b128 v[52:55], v18 offset:62464
    v_mul_f32 v59, v83, v83
    v_mul_f32 v60, v84, v84
    v_mul_f32 v61, v85, v85
    s_waitcnt lgkmcnt(7)
    v_mfma_f32_32x32x16_bf16 v[64:79], v[24:27], v[152:155], v[64:79]
    ds_read_b128 v[20:23], v18 offset:63488
    v_mul_f32 v62, v86, v86
    v_mul_f32 v63, v87, v87
    v_fma_f32 v56, v56, v14, v13
    v_fma_f32 v57, v57, v14, v13
    v_mfma_f32_32x32x16_bf16 v[64:79], v[28:31], v[156:159], v[64:79]
    s_waitcnt lgkmcnt(5)
    s_barrier
    ds_read_b128 v[24:27], v18 offset:64512
    v_fma_f32 v58, v58, v14, v13
    v_mfma_f32_32x32x16_bf16 v[64:79], v[32:35], v[160:163], v[64:79]
    ds_read_b128 v[28:31], v19 offset:0
    v_fma_f32 v59, v59, v14, v13
    v_fma_f32 v60, v60, v14, v13
    v_fma_f32 v61, v61, v14, v13
    v_fma_f32 v62, v62, v14, v13
    v_mfma_f32_32x32x16_bf16 v[64:79], v[36:39], v[164:167], v[64:79]
    ds_read_b128 v[32:35], v19 offset:1024
    v_fma_f32 v63, v63, v14, v13
    v_mul_f32 v56, v56, v80
    v_mul_f32 v57, v57, v81
    s_waitcnt lgkmcnt(6)
    v_mfma_f32_32x32x16_bf16 v[64:79], v[40:43], v[168:171], v[64:79]
    ds_read_b128 v[36:39], v19 offset:2048
    v_mul_f32 v58, v58, v82
    v_mul_f32 v59, v59, v83
    v_mul_f32 v60, v60, v84
    v_mul_f32 v61, v61, v85
    v_mfma_f32_32x32x16_bf16 v[64:79], v[44:47], v[172:175], v[64:79]
    s_barrier
    ds_read_b128 v[40:43], v19 offset:3072
    v_mul_f32 v62, v62, v86
    s_waitcnt lgkmcnt(6)
    v_mfma_f32_32x32x16_bf16 v[64:79], v[48:51], v[176:179], v[64:79]
    ds_read_b128 v[44:47], v19 offset:4096
    v_mul_f32 v63, v63, v87
    v_exp_f32 v56, v56
    v_mfma_f32_32x32x16_bf16 v[64:79], v[52:55], v[180:183], v[64:79]
    ds_read_b128 v[48:51], v19 offset:5120
    v_exp_f32 v57, v57
    s_waitcnt lgkmcnt(6)
    v_mfma_f32_32x32x16_bf16 v[64:79], v[20:23], v[184:187], v[64:79]
    ds_read_b128 v[52:55], v19 offset:6144
    v_exp_f32 v58, v58
    v_exp_f32 v59, v59
    v_mfma_f32_32x32x16_bf16 v[64:79], v[24:27], v[188:191], v[64:79]
    ds_read_b128 v[20:23], v19 offset:7168
    v_exp_f32 v60, v60
    s_waitcnt lgkmcnt(6)
    v_mfma_f32_32x32x16_bf16 v[64:79], v[28:31], v[192:195], v[64:79]
    ds_read_b128 v[24:27], v19 offset:8192
    v_exp_f32 v61, v61
    v_exp_f32 v62, v62
    v_mfma_f32_32x32x16_bf16 v[64:79], v[32:35], v[196:199], v[64:79]
    ds_read_b128 v[28:31], v19 offset:9216
    v_exp_f32 v63, v63
    v_add_f32 v56, 1.0, v56
    s_waitcnt lgkmcnt(6)
    v_mfma_f32_32x32x16_bf16 v[64:79], v[36:39], v[200:203], v[64:79]
    ds_read_b128 v[32:35], v19 offset:10240
    v_add_f32 v57, 1.0, v57
    v_add_f32 v58, 1.0, v58
    v_add_f32 v59, 1.0, v59
    v_add_f32 v60, 1.0, v60
    v_mfma_f32_32x32x16_bf16 v[64:79], v[40:43], v[204:207], v[64:79]
    ds_read_b128 v[36:39], v19 offset:11264
    v_add_f32 v61, 1.0, v61
    v_add_f32 v62, 1.0, v62
    v_add_f32 v63, 1.0, v63
    s_waitcnt lgkmcnt(6)
    v_mfma_f32_32x32x16_bf16 v[64:79], v[44:47], v[208:211], v[64:79]
    ds_read_b128 v[40:43], v19 offset:12288
    v_rcp_f32 v56, v56
    v_rcp_f32 v57, v57
    v_mfma_f32_32x32x16_bf16 v[64:79], v[48:51], v[212:215], v[64:79]
    ds_read_b128 v[44:47], v19 offset:13312
    v_rcp_f32 v58, v58
    s_waitcnt lgkmcnt(6)
    v_mfma_f32_32x32x16_bf16 v[64:79], v[52:55], v[216:219], v[64:79]
    ds_read_b128 v[48:51], v19 offset:14336
    v_rcp_f32 v59, v59
    v_rcp_f32 v60, v60
    v_mfma_f32_32x32x16_bf16 v[64:79], v[20:23], v[220:223], v[64:79]
    ds_read_b128 v[52:55], v19 offset:15360
    v_rcp_f32 v61, v61
    s_waitcnt lgkmcnt(6)
    v_mfma_f32_32x32x16_bf16 v[64:79], v[24:27], v[224:227], v[64:79]
    ds_read_b128 v[20:23], v3 offset:0
    v_rcp_f32 v62, v62
    v_rcp_f32 v63, v63
    v_mfma_f32_32x32x16_bf16 v[64:79], v[28:31], v[228:231], v[64:79]
    ds_read_b128 v[24:27], v3 offset:1024
    v_mul_f32 v56, v56, v80
    v_mul_f32 v57, v57, v81
    v_mul_f32 v58, v58, v82
    s_waitcnt lgkmcnt(6)
    v_mfma_f32_32x32x16_bf16 v[64:79], v[32:35], v[232:235], v[64:79]
    ds_read_b128 v[28:31], v3 offset:2048
    v_mul_f32 v59, v59, v83
    v_mul_f32 v60, v60, v84
    v_mul_f32 v61, v61, v85
    v_mul_f32 v62, v62, v86
    v_mfma_f32_32x32x16_bf16 v[64:79], v[36:39], v[236:239], v[64:79]
    ds_read_b128 v[32:35], v3 offset:3072
    v_mul_f32 v63, v63, v87
    v_cvt_pk_bf16_f32 v80, v56, v57
    v_cvt_pk_bf16_f32 v81, v58, v59
    s_waitcnt lgkmcnt(6)
    v_mfma_f32_32x32x16_bf16 v[64:79], v[40:43], v[240:243], v[64:79]
    ds_read_b128 v[36:39], v3 offset:4096
    v_cvt_pk_bf16_f32 v82, v60, v61
    v_cvt_pk_bf16_f32 v83, v62, v63
    s_add_u32 s23, s21, 8192
    v_mfma_f32_32x32x16_bf16 v[64:79], v[44:47], v[244:247], v[64:79]
    ds_read_b128 v[40:43], v3 offset:5120
    buffer_store_dwordx4 v[80:83], v7, s[8:11], s23 offen offset:0 sc1
    ds_read_b128 v[56:59], v9 offset:256
    s_waitcnt lgkmcnt(7)
    v_mfma_f32_32x32x16_bf16 v[64:79], v[48:51], v[248:251], v[64:79]
    ds_read_b128 v[44:47], v3 offset:6144
    ds_read_b128 v[60:63], v9 offset:288
    v_mfma_f32_32x32x16_bf16 v[64:79], v[52:55], v[252:255], v[64:79]
    ds_read_b128 v[48:51], v3 offset:7168
    s_waitcnt lgkmcnt(8)
    v_mfma_f32_32x32x16_bf16 v[80:95], v[20:23], v[112:115], 0
    ds_read_b128 v[52:55], v3 offset:8192
    v_mfma_f32_32x32x16_bf16 v[80:95], v[24:27], v[116:119], v[80:95]
    ds_read_b128 v[20:23], v3 offset:9216
    s_waitcnt lgkmcnt(8)
    v_mfma_f32_32x32x16_bf16 v[80:95], v[28:31], v[120:123], v[80:95]
    ds_read_b128 v[24:27], v3 offset:10240
    s_nop 2
    ds_write_b128 v10, v[72:75] offset:0
    v_mfma_f32_32x32x16_bf16 v[80:95], v[32:35], v[124:127], v[80:95]
    ds_read_b128 v[28:31], v3 offset:11264
    s_waitcnt lgkmcnt(6)
    v_fmac_f32 v96, v12, v56
    v_fmac_f32 v97, v12, v57
    v_fmac_f32 v98, v12, v58
    v_mfma_f32_32x32x16_bf16 v[80:95], v[36:39], v[128:131], v[80:95]
    ds_read_b128 v[32:35], v3 offset:12288
    v_fmac_f32 v99, v12, v59
    v_fmac_f32 v100, v12, v60
    v_fmac_f32 v101, v12, v61
    v_fmac_f32 v102, v12, v62
    v_mfma_f32_32x32x16_bf16 v[80:95], v[40:43], v[132:135], v[80:95]
    ds_read_b128 v[36:39], v3 offset:13312
    ds_write_b128 v10, v[76:79] offset:1024
    v_fmac_f32 v103, v12, v63
    s_waitcnt lgkmcnt(8)
    v_mfma_f32_32x32x16_bf16 v[80:95], v[44:47], v[136:139], v[80:95]
    ds_read_b128 v[40:43], v3 offset:14336
    v_mul_f32 v56, v96, v96
    v_mul_f32 v57, v97, v97
    v_mul_f32 v58, v98, v98
    v_mul_f32 v59, v99, v99
    v_mfma_f32_32x32x16_bf16 v[80:95], v[48:51], v[140:143], v[80:95]
    ds_read_b128 v[44:47], v3 offset:15360
    v_mul_f32 v60, v100, v100
    v_mul_f32 v61, v101, v101
    v_mul_f32 v62, v102, v102
    s_waitcnt lgkmcnt(8)
    v_mfma_f32_32x32x16_bf16 v[80:95], v[52:55], v[144:147], v[80:95]
    ds_read_b128 v[48:51], v3 offset:16384
    v_mul_f32 v63, v103, v103
    v_fma_f32 v56, v56, v14, v13
    v_fma_f32 v57, v57, v14, v13
    v_fma_f32 v58, v58, v14, v13
    v_mfma_f32_32x32x16_bf16 v[80:95], v[20:23], v[148:151], v[80:95]
    ds_read_b128 v[52:55], v3 offset:17408
    v_fma_f32 v59, v59, v14, v13
    v_fma_f32 v60, v60, v14, v13
    v_fma_f32 v61, v61, v14, v13
    s_waitcnt lgkmcnt(7)
    v_mfma_f32_32x32x16_bf16 v[80:95], v[24:27], v[152:155], v[80:95]
    ds_read_b128 v[20:23], v3 offset:18432
    v_fma_f32 v62, v62, v14, v13
    v_fma_f32 v63, v63, v14, v13
    v_mul_f32 v56, v56, v96
    v_mul_f32 v57, v57, v97
    v_mfma_f32_32x32x16_bf16 v[80:95], v[28:31], v[156:159], v[80:95]
    s_waitcnt lgkmcnt(5)
    s_barrier
    ds_read_b128 v[24:27], v3 offset:19456
    v_mul_f32 v58, v58, v98
    v_mfma_f32_32x32x16_bf16 v[80:95], v[32:35], v[160:163], v[80:95]
    ds_read_b128 v[28:31], v3 offset:20480
    v_mul_f32 v59, v59, v99
    v_mul_f32 v60, v60, v100
    v_mul_f32 v61, v61, v101
    v_mul_f32 v62, v62, v102
    v_mfma_f32_32x32x16_bf16 v[80:95], v[36:39], v[164:167], v[80:95]
    ds_read_b128 v[32:35], v3 offset:21504
    v_mul_f32 v63, v63, v103
    v_exp_f32 v56, v56
    s_waitcnt lgkmcnt(6)
    v_mfma_f32_32x32x16_bf16 v[80:95], v[40:43], v[168:171], v[80:95]
    ds_read_b128 v[36:39], v3 offset:22528
    v_exp_f32 v57, v57
    v_exp_f32 v58, v58
    v_mfma_f32_32x32x16_bf16 v[80:95], v[44:47], v[172:175], v[80:95]
    s_barrier
    ds_read_b128 v[40:43], v3 offset:23552
    s_waitcnt lgkmcnt(6)
    v_mfma_f32_32x32x16_bf16 v[80:95], v[48:51], v[176:179], v[80:95]
    ds_read_b128 v[44:47], v3 offset:24576
    v_exp_f32 v59, v59
    v_exp_f32 v60, v60
    v_mfma_f32_32x32x16_bf16 v[80:95], v[52:55], v[180:183], v[80:95]
    ds_read_b128 v[48:51], v3 offset:25600
    v_exp_f32 v61, v61
    s_waitcnt lgkmcnt(6)
    v_mfma_f32_32x32x16_bf16 v[80:95], v[20:23], v[184:187], v[80:95]
    ds_read_b128 v[52:55], v3 offset:26624
    v_exp_f32 v62, v62
    v_exp_f32 v63, v63
    v_mfma_f32_32x32x16_bf16 v[80:95], v[24:27], v[188:191], v[80:95]
    ds_read_b128 v[20:23], v3 offset:27648
    v_add_f32 v56, 1.0, v56
    v_add_f32 v57, 1.0, v57
    v_add_f32 v58, 1.0, v58
    s_waitcnt lgkmcnt(6)
    v_mfma_f32_32x32x16_bf16 v[80:95], v[28:31], v[192:195], v[80:95]
    ds_read_b128 v[24:27], v3 offset:28672
    v_add_f32 v59, 1.0, v59
    v_add_f32 v60, 1.0, v60
    v_add_f32 v61, 1.0, v61
    v_add_f32 v62, 1.0, v62
    v_mfma_f32_32x32x16_bf16 v[80:95], v[32:35], v[196:199], v[80:95]
    ds_read_b128 v[28:31], v3 offset:29696
    v_add_f32 v63, 1.0, v63
    v_rcp_f32 v56, v56
    s_waitcnt lgkmcnt(6)
    v_mfma_f32_32x32x16_bf16 v[80:95], v[36:39], v[200:203], v[80:95]
    ds_read_b128 v[32:35], v3 offset:30720
    v_rcp_f32 v57, v57
    v_rcp_f32 v58, v58
    v_mfma_f32_32x32x16_bf16 v[80:95], v[40:43], v[204:207], v[80:95]
    ds_read_b128 v[36:39], v3 offset:31744
    v_rcp_f32 v59, v59
    s_waitcnt lgkmcnt(6)
    v_mfma_f32_32x32x16_bf16 v[80:95], v[44:47], v[208:211], v[80:95]
    ds_read_b128 v[40:43], v3 offset:32768
    v_rcp_f32 v60, v60
    v_rcp_f32 v61, v61
    v_mfma_f32_32x32x16_bf16 v[80:95], v[48:51], v[212:215], v[80:95]
    ds_read_b128 v[44:47], v3 offset:33792
    v_rcp_f32 v62, v62
    s_waitcnt lgkmcnt(6)
    v_mfma_f32_32x32x16_bf16 v[80:95], v[52:55], v[216:219], v[80:95]
    ds_read_b128 v[48:51], v3 offset:34816
    v_rcp_f32 v63, v63
    v_mul_f32 v56, v56, v96
    v_mul_f32 v57, v57, v97
    v_mfma_f32_32x32x16_bf16 v[80:95], v[20:23], v[220:223], v[80:95]
    ds_read_b128 v[52:55], v3 offset:35840
    v_mul_f32 v58, v58, v98
    v_mul_f32 v59, v59, v99
    v_mul_f32 v60, v60, v100
    s_waitcnt lgkmcnt(6)
    v_mfma_f32_32x32x16_bf16 v[80:95], v[24:27], v[224:227], v[80:95]
    ds_read_b128 v[20:23], v3 offset:36864
    v_mul_f32 v61, v61, v101
    v_mul_f32 v62, v62, v102
    v_mul_f32 v63, v63, v103
    v_cvt_pk_bf16_f32 v96, v56, v57
    v_mfma_f32_32x32x16_bf16 v[80:95], v[28:31], v[228:231], v[80:95]
    ds_read_b128 v[24:27], v3 offset:37888
    v_cvt_pk_bf16_f32 v97, v58, v59
    v_cvt_pk_bf16_f32 v98, v60, v61
    v_cvt_pk_bf16_f32 v99, v62, v63
    s_waitcnt lgkmcnt(6)
    v_mfma_f32_32x32x16_bf16 v[80:95], v[32:35], v[232:235], v[80:95]
    ds_read_b128 v[28:31], v3 offset:38912
    s_add_u32 s23, s21, 16384
    buffer_store_dwordx4 v[96:99], v7, s[8:11], s23 offen offset:0 sc1
    ds_read_b128 v[56:59], v9 offset:384
    v_mfma_f32_32x32x16_bf16 v[80:95], v[36:39], v[236:239], v[80:95]
    ds_read_b128 v[32:35], v3 offset:39936
    ds_read_b128 v[60:63], v9 offset:416
    s_waitcnt lgkmcnt(8)
    v_mfma_f32_32x32x16_bf16 v[80:95], v[40:43], v[240:243], v[80:95]
    ds_read_b128 v[36:39], v3 offset:40960
    v_mfma_f32_32x32x16_bf16 v[80:95], v[44:47], v[244:247], v[80:95]
    ds_read_b128 v[40:43], v3 offset:41984
    s_waitcnt lgkmcnt(8)
    v_mfma_f32_32x32x16_bf16 v[80:95], v[48:51], v[248:251], v[80:95]
    ds_read_b128 v[44:47], v3 offset:43008
    v_mfma_f32_32x32x16_bf16 v[80:95], v[52:55], v[252:255], v[80:95]
    ds_read_b128 v[48:51], v3 offset:44032
    s_waitcnt lgkmcnt(4)
    v_fmac_f32 v64, v12, v56
    v_mfma_f32_32x32x16_bf16 v[96:111], v[20:23], v[112:115], 0
    ds_read_b128 v[52:55], v3 offset:45056
    v_fmac_f32 v65, v12, v57
    v_fmac_f32 v66, v12, v58
    v_fmac_f32 v67, v12, v59
    v_fmac_f32 v68, v12, v60
    v_mfma_f32_32x32x16_bf16 v[96:111], v[24:27], v[116:119], v[96:111]
    ds_read_b128 v[20:23], v3 offset:46080
    v_fmac_f32 v69, v12, v61
    v_fmac_f32 v70, v12, v62
    v_fmac_f32 v71, v12, v63
    v_mfma_f32_32x32x16_bf16 v[96:111], v[28:31], v[120:123], v[96:111]
    ds_read_b128 v[24:27], v3 offset:47104
    ds_write_b128 v10, v[88:91] offset:0
    v_mul_f32 v56, v64, v64
    v_mul_f32 v57, v65, v65
    v_mfma_f32_32x32x16_bf16 v[96:111], v[32:35], v[124:127], v[96:111]
    ds_read_b128 v[28:31], v3 offset:48128
    v_mul_f32 v58, v66, v66
    v_mul_f32 v59, v67, v67
    v_mul_f32 v60, v68, v68
    s_waitcnt lgkmcnt(7)
    v_mfma_f32_32x32x16_bf16 v[96:111], v[36:39], v[128:131], v[96:111]
    ds_read_b128 v[32:35], v3 offset:49152
    v_mul_f32 v61, v69, v69
    v_mul_f32 v62, v70, v70
    v_mul_f32 v63, v71, v71
    v_fma_f32 v56, v56, v14, v13
    v_mfma_f32_32x32x16_bf16 v[96:111], v[40:43], v[132:135], v[96:111]
    ds_read_b128 v[36:39], v3 offset:50176
    ds_write_b128 v10, v[92:95] offset:1024
    v_fma_f32 v57, v57, v14, v13
    s_waitcnt lgkmcnt(8)
    v_mfma_f32_32x32x16_bf16 v[96:111], v[44:47], v[136:139], v[96:111]
    ds_read_b128 v[40:43], v3 offset:51200
    v_fma_f32 v58, v58, v14, v13
    v_fma_f32 v59, v59, v14, v13
    v_fma_f32 v60, v60, v14, v13
    v_fma_f32 v61, v61, v14, v13
    v_mfma_f32_32x32x16_bf16 v[96:111], v[48:51], v[140:143], v[96:111]
    ds_read_b128 v[44:47], v3 offset:52224
    v_fma_f32 v62, v62, v14, v13
    v_fma_f32 v63, v63, v14, v13
    v_mul_f32 v56, v56, v64
    s_waitcnt lgkmcnt(8)
    v_mfma_f32_32x32x16_bf16 v[96:111], v[52:55], v[144:147], v[96:111]
    ds_read_b128 v[48:51], v3 offset:53248
    v_mul_f32 v57, v57, v65
    v_mul_f32 v58, v58, v66
    v_mul_f32 v59, v59, v67
    v_mul_f32 v60, v60, v68
    v_mfma_f32_32x32x16_bf16 v[96:111], v[20:23], v[148:151], v[96:111]
    ds_read_b128 v[52:55], v3 offset:54272
    v_mul_f32 v61, v61, v69
    v_mul_f32 v62, v62, v70
    v_mul_f32 v63, v63, v71
    s_waitcnt lgkmcnt(7)
    v_mfma_f32_32x32x16_bf16 v[96:111], v[24:27], v[152:155], v[96:111]
    ds_read_b128 v[20:23], v3 offset:55296
    v_exp_f32 v56, v56
    v_exp_f32 v57, v57
    v_mfma_f32_32x32x16_bf16 v[96:111], v[28:31], v[156:159], v[96:111]
    s_waitcnt lgkmcnt(5)
    s_barrier
    ds_read_b128 v[24:27], v3 offset:56320
    v_mfma_f32_32x32x16_bf16 v[96:111], v[32:35], v[160:163], v[96:111]
    ds_read_b128 v[28:31], v3 offset:57344
    v_exp_f32 v58, v58
    v_exp_f32 v59, v59
    v_mfma_f32_32x32x16_bf16 v[96:111], v[36:39], v[164:167], v[96:111]
    ds_read_b128 v[32:35], v3 offset:58368
    v_exp_f32 v60, v60
    s_waitcnt lgkmcnt(6)
    v_mfma_f32_32x32x16_bf16 v[96:111], v[40:43], v[168:171], v[96:111]
    ds_read_b128 v[36:39], v3 offset:59392
    v_exp_f32 v61, v61
    v_exp_f32 v62, v62
    v_mfma_f32_32x32x16_bf16 v[96:111], v[44:47], v[172:175], v[96:111]
    s_barrier
    ds_read_b128 v[40:43], v3 offset:60416
    s_waitcnt lgkmcnt(6)
    v_mfma_f32_32x32x16_bf16 v[96:111], v[48:51], v[176:179], v[96:111]
    ds_read_b128 v[44:47], v3 offset:61440
    v_exp_f32 v63, v63
    v_add_f32 v56, 1.0, v56
    v_add_f32 v57, 1.0, v57
    v_mfma_f32_32x32x16_bf16 v[96:111], v[52:55], v[180:183], v[96:111]
    ds_read_b128 v[48:51], v3 offset:62464
    v_add_f32 v58, 1.0, v58
    v_add_f32 v59, 1.0, v59
    v_add_f32 v60, 1.0, v60
    s_waitcnt lgkmcnt(6)
    v_mfma_f32_32x32x16_bf16 v[96:111], v[20:23], v[184:187], v[96:111]
    ds_read_b128 v[52:55], v3 offset:63488
    v_add_f32 v61, 1.0, v61
    v_add_f32 v62, 1.0, v62
    v_add_f32 v63, 1.0, v63
    v_mfma_f32_32x32x16_bf16 v[96:111], v[24:27], v[188:191], v[96:111]
    ds_read_b128 v[20:23], v3 offset:64512
    v_rcp_f32 v56, v56
    s_waitcnt lgkmcnt(6)
    v_mfma_f32_32x32x16_bf16 v[96:111], v[28:31], v[192:195], v[96:111]
    ds_read_b128 v[24:27], v18 offset:0
    v_rcp_f32 v57, v57
    v_rcp_f32 v58, v58
    v_mfma_f32_32x32x16_bf16 v[96:111], v[32:35], v[196:199], v[96:111]
    ds_read_b128 v[28:31], v18 offset:1024
    v_rcp_f32 v59, v59
    s_waitcnt lgkmcnt(6)
    v_mfma_f32_32x32x16_bf16 v[96:111], v[36:39], v[200:203], v[96:111]
    ds_read_b128 v[32:35], v18 offset:2048
    v_rcp_f32 v60, v60
    v_rcp_f32 v61, v61
    v_mfma_f32_32x32x16_bf16 v[96:111], v[40:43], v[204:207], v[96:111]
    ds_read_b128 v[36:39], v18 offset:3072
    v_rcp_f32 v62, v62
    s_waitcnt lgkmcnt(6)
    v_mfma_f32_32x32x16_bf16 v[96:111], v[44:47], v[208:211], v[96:111]
    ds_read_b128 v[40:43], v18 offset:4096
    v_rcp_f32 v63, v63
    v_mul_f32 v56, v56, v64
    v_mul_f32 v57, v57, v65
    v_mfma_f32_32x32x16_bf16 v[96:111], v[48:51], v[212:215], v[96:111]
    ds_read_b128 v[44:47], v18 offset:5120
    v_mul_f32 v58, v58, v66
    v_mul_f32 v59, v59, v67
    v_mul_f32 v60, v60, v68
    s_waitcnt lgkmcnt(6)
    v_mfma_f32_32x32x16_bf16 v[96:111], v[52:55], v[216:219], v[96:111]
    ds_read_b128 v[48:51], v18 offset:6144
    v_mul_f32 v61, v61, v69
    v_mul_f32 v62, v62, v70
    v_mul_f32 v63, v63, v71
    v_cvt_pk_bf16_f32 v64, v56, v57
    v_mfma_f32_32x32x16_bf16 v[96:111], v[20:23], v[220:223], v[96:111]
    ds_read_b128 v[52:55], v18 offset:7168
    v_cvt_pk_bf16_f32 v65, v58, v59
    v_cvt_pk_bf16_f32 v66, v60, v61
    v_cvt_pk_bf16_f32 v67, v62, v63
    s_waitcnt lgkmcnt(6)
    v_mfma_f32_32x32x16_bf16 v[96:111], v[24:27], v[224:227], v[96:111]
    ds_read_b128 v[20:23], v18 offset:8192
    s_add_u32 s23, s21, 24576
    buffer_store_dwordx4 v[64:67], v7, s[8:11], s23 offen offset:0 sc1
    ds_read_b128 v[56:59], v9 offset:512
    v_mfma_f32_32x32x16_bf16 v[96:111], v[28:31], v[228:231], v[96:111]
    ds_read_b128 v[24:27], v18 offset:9216
    ds_read_b128 v[60:63], v9 offset:544
    s_waitcnt lgkmcnt(8)
    v_mfma_f32_32x32x16_bf16 v[96:111], v[32:35], v[232:235], v[96:111]
    ds_read_b128 v[28:31], v18 offset:10240
    v_mfma_f32_32x32x16_bf16 v[96:111], v[36:39], v[236:239], v[96:111]
    ds_read_b128 v[32:35], v18 offset:11264
    s_waitcnt lgkmcnt(8)
    v_mfma_f32_32x32x16_bf16 v[96:111], v[40:43], v[240:243], v[96:111]
    ds_read_b128 v[36:39], v18 offset:12288
    v_mfma_f32_32x32x16_bf16 v[96:111], v[44:47], v[244:247], v[96:111]
    ds_read_b128 v[40:43], v18 offset:13312
    s_waitcnt lgkmcnt(4)
    v_fmac_f32 v80, v12, v56
    v_mfma_f32_32x32x16_bf16 v[96:111], v[48:51], v[248:251], v[96:111]
    ds_read_b128 v[44:47], v18 offset:14336
    v_fmac_f32 v81, v12, v57
    v_fmac_f32 v82, v12, v58
    v_fmac_f32 v83, v12, v59
    v_fmac_f32 v84, v12, v60
    v_mfma_f32_32x32x16_bf16 v[96:111], v[52:55], v[252:255], v[96:111]
    ds_read_b128 v[48:51], v18 offset:15360
    v_fmac_f32 v85, v12, v61
    v_fmac_f32 v86, v12, v62
    v_fmac_f32 v87, v12, v63
    v_mfma_f32_32x32x16_bf16 v[64:79], v[20:23], v[112:115], 0
    ds_read_b128 v[52:55], v18 offset:16384
    v_mul_f32 v56, v80, v80
    v_mul_f32 v57, v81, v81
    v_mul_f32 v58, v82, v82
    v_mul_f32 v59, v83, v83
    v_mfma_f32_32x32x16_bf16 v[64:79], v[24:27], v[116:119], v[64:79]
    ds_read_b128 v[20:23], v18 offset:17408
    v_mul_f32 v60, v84, v84
    v_mul_f32 v61, v85, v85
    v_mul_f32 v62, v86, v86
    s_waitcnt lgkmcnt(6)
    v_mfma_f32_32x32x16_bf16 v[64:79], v[28:31], v[120:123], v[64:79]
    ds_read_b128 v[24:27], v18 offset:18432
    ds_write_b128 v10, v[104:107] offset:0
    v_mul_f32 v63, v87, v87
    v_fma_f32 v56, v56, v14, v13
    v_mfma_f32_32x32x16_bf16 v[64:79], v[32:35], v[124:127], v[64:79]
    ds_read_b128 v[28:31], v18 offset:19456
    v_fma_f32 v57, v57, v14, v13
    v_fma_f32 v58, v58, v14, v13
    v_fma_f32 v59, v59, v14, v13
    s_waitcnt lgkmcnt(7)
    v_mfma_f32_32x32x16_bf16 v[64:79], v[36:39], v[128:131], v[64:79]
    ds_read_b128 v[32:35], v18 offset:20480
    v_fma_f32 v60, v60, v14, v13
    v_fma_f32 v61, v61, v14, v13
    v_fma_f32 v62, v62, v14, v13
    v_fma_f32 v63, v63, v14, v13
    v_mfma_f32_32x32x16_bf16 v[64:79], v[40:43], v[132:135], v[64:79]
    ds_read_b128 v[36:39], v18 offset:21504
    ds_write_b128 v10, v[108:111] offset:1024
    v_mul_f32 v56, v56, v80
    s_waitcnt lgkmcnt(8)
    v_mfma_f32_32x32x16_bf16 v[64:79], v[44:47], v[136:139], v[64:79]
    ds_read_b128 v[40:43], v18 offset:22528
    v_mul_f32 v57, v57, v81
    v_mul_f32 v58, v58, v82
    v_mul_f32 v59, v59, v83
    v_mul_f32 v60, v60, v84
    v_mfma_f32_32x32x16_bf16 v[64:79], v[48:51], v[140:143], v[64:79]
    ds_read_b128 v[44:47], v18 offset:23552
    v_mul_f32 v61, v61, v85
    v_mul_f32 v62, v62, v86
    v_mul_f32 v63, v63, v87
    s_waitcnt lgkmcnt(8)
    v_mfma_f32_32x32x16_bf16 v[64:79], v[52:55], v[144:147], v[64:79]
    ds_read_b128 v[48:51], v18 offset:24576
    v_exp_f32 v56, v56
    v_exp_f32 v57, v57
    v_mfma_f32_32x32x16_bf16 v[64:79], v[20:23], v[148:151], v[64:79]
    ds_read_b128 v[52:55], v18 offset:25600
    v_exp_f32 v58, v58
    s_waitcnt lgkmcnt(7)
    v_mfma_f32_32x32x16_bf16 v[64:79], v[24:27], v[152:155], v[64:79]
    ds_read_b128 v[20:23], v18 offset:26624
    v_exp_f32 v59, v59
    v_exp_f32 v60, v60
    v_mfma_f32_32x32x16_bf16 v[64:79], v[28:31], v[156:159], v[64:79]
    s_waitcnt lgkmcnt(5)
    s_barrier
    ds_read_b128 v[24:27], v18 offset:27648
    v_mfma_f32_32x32x16_bf16 v[64:79], v[32:35], v[160:163], v[64:79]
    ds_read_b128 v[28:31], v18 offset:28672
    v_exp_f32 v61, v61
    v_exp_f32 v62, v62
    v_mfma_f32_32x32x16_bf16 v[64:79], v[36:39], v[164:167], v[64:79]
    ds_read_b128 v[32:35], v18 offset:29696
    v_exp_f32 v63, v63
    v_add_f32 v56, 1.0, v56
    s_waitcnt lgkmcnt(6)
    v_mfma_f32_32x32x16_bf16 v[64:79], v[40:43], v[168:171], v[64:79]
    ds_read_b128 v[36:39], v18 offset:30720
    v_add_f32 v57, 1.0, v57
    v_add_f32 v58, 1.0, v58
    v_add_f32 v59, 1.0, v59
    v_add_f32 v60, 1.0, v60
    v_mfma_f32_32x32x16_bf16 v[64:79], v[44:47], v[172:175], v[64:79]
    s_barrier
    ds_read_b128 v[40:43], v18 offset:31744
    v_add_f32 v61, 1.0, v61
    s_waitcnt lgkmcnt(6)
    v_mfma_f32_32x32x16_bf16 v[64:79], v[48:51], v[176:179], v[64:79]
    ds_read_b128 v[44:47], v18 offset:32768
    v_add_f32 v62, 1.0, v62
    v_add_f32 v63, 1.0, v63
    v_rcp_f32 v56, v56
    v_mfma_f32_32x32x16_bf16 v[64:79], v[52:55], v[180:183], v[64:79]
    ds_read_b128 v[48:51], v18 offset:33792
    v_rcp_f32 v57, v57
    s_waitcnt lgkmcnt(6)
    v_mfma_f32_32x32x16_bf16 v[64:79], v[20:23], v[184:187], v[64:79]
    ds_read_b128 v[52:55], v18 offset:34816
    v_rcp_f32 v58, v58
    v_rcp_f32 v59, v59
    v_mfma_f32_32x32x16_bf16 v[64:79], v[24:27], v[188:191], v[64:79]
    ds_read_b128 v[20:23], v18 offset:35840
    v_rcp_f32 v60, v60
    s_waitcnt lgkmcnt(6)
    v_mfma_f32_32x32x16_bf16 v[64:79], v[28:31], v[192:195], v[64:79]
    ds_read_b128 v[24:27], v18 offset:36864
    v_rcp_f32 v61, v61
    v_rcp_f32 v62, v62
    v_mfma_f32_32x32x16_bf16 v[64:79], v[32:35], v[196:199], v[64:79]
    ds_read_b128 v[28:31], v18 offset:37888
    v_rcp_f32 v63, v63
    v_mul_f32 v56, v56, v80
    s_waitcnt lgkmcnt(6)
    v_mfma_f32_32x32x16_bf16 v[64:79], v[36:39], v[200:203], v[64:79]
    ds_read_b128 v[32:35], v18 offset:38912
    v_mul_f32 v57, v57, v81
    v_mul_f32 v58, v58, v82
    v_mul_f32 v59, v59, v83
    v_mul_f32 v60, v60, v84
    v_mfma_f32_32x32x16_bf16 v[64:79], v[40:43], v[204:207], v[64:79]
    ds_read_b128 v[36:39], v18 offset:39936
    v_mul_f32 v61, v61, v85
    v_mul_f32 v62, v62, v86
    v_mul_f32 v63, v63, v87
    s_waitcnt lgkmcnt(6)
    v_mfma_f32_32x32x16_bf16 v[64:79], v[44:47], v[208:211], v[64:79]
    ds_read_b128 v[40:43], v18 offset:40960
    v_cvt_pk_bf16_f32 v80, v56, v57
    v_cvt_pk_bf16_f32 v81, v58, v59
    v_cvt_pk_bf16_f32 v82, v60, v61
    v_cvt_pk_bf16_f32 v83, v62, v63
    v_mfma_f32_32x32x16_bf16 v[64:79], v[48:51], v[212:215], v[64:79]
    ds_read_b128 v[44:47], v18 offset:41984
    s_add_u32 s23, s21, 32768
    buffer_store_dwordx4 v[80:83], v7, s[8:11], s23 offen offset:0 sc1
    s_waitcnt lgkmcnt(6)
    v_mfma_f32_32x32x16_bf16 v[64:79], v[52:55], v[216:219], v[64:79]
    ds_read_b128 v[48:51], v18 offset:43008
    ds_read_b128 v[56:59], v9 offset:640
    ds_read_b128 v[60:63], v9 offset:672
    v_mfma_f32_32x32x16_bf16 v[64:79], v[20:23], v[220:223], v[64:79]
    ds_read_b128 v[52:55], v18 offset:44032
    s_waitcnt lgkmcnt(8)
    v_mfma_f32_32x32x16_bf16 v[64:79], v[24:27], v[224:227], v[64:79]
    ds_read_b128 v[20:23], v18 offset:45056
    v_mfma_f32_32x32x16_bf16 v[64:79], v[28:31], v[228:231], v[64:79]
    ds_read_b128 v[24:27], v18 offset:46080
    s_waitcnt lgkmcnt(8)
    v_mfma_f32_32x32x16_bf16 v[64:79], v[32:35], v[232:235], v[64:79]
    ds_read_b128 v[28:31], v18 offset:47104
    s_waitcnt lgkmcnt(4)
    v_fmac_f32 v96, v12, v56
    v_mfma_f32_32x32x16_bf16 v[64:79], v[36:39], v[236:239], v[64:79]
    ds_read_b128 v[32:35], v18 offset:48128
    v_fmac_f32 v97, v12, v57
    v_fmac_f32 v98, v12, v58
    v_fmac_f32 v99, v12, v59
    v_mfma_f32_32x32x16_bf16 v[64:79], v[40:43], v[240:243], v[64:79]
    ds_read_b128 v[36:39], v18 offset:49152
    v_fmac_f32 v100, v12, v60
    v_fmac_f32 v101, v12, v61
    v_fmac_f32 v102, v12, v62
    v_fmac_f32 v103, v12, v63
    v_mfma_f32_32x32x16_bf16 v[64:79], v[44:47], v[244:247], v[64:79]
    ds_read_b128 v[40:43], v18 offset:50176
    v_mul_f32 v56, v96, v96
    v_mul_f32 v57, v97, v97
    v_mul_f32 v58, v98, v98
    s_waitcnt lgkmcnt(6)
    v_mfma_f32_32x32x16_bf16 v[64:79], v[48:51], v[248:251], v[64:79]
    ds_read_b128 v[44:47], v18 offset:51200
    v_mul_f32 v59, v99, v99
    v_mul_f32 v60, v100, v100
    v_mul_f32 v61, v101, v101
    v_mul_f32 v62, v102, v102
    v_mfma_f32_32x32x16_bf16 v[64:79], v[52:55], v[252:255], v[64:79]
    ds_read_b128 v[48:51], v18 offset:52224
    v_mul_f32 v63, v103, v103
    v_fma_f32 v56, v56, v14, v13
    v_fma_f32 v57, v57, v14, v13
    s_waitcnt lgkmcnt(6)
    v_mfma_f32_32x32x16_bf16 v[80:95], v[20:23], v[112:115], 0
    ds_read_b128 v[52:55], v18 offset:53248
    v_fma_f32 v58, v58, v14, v13
    v_fma_f32 v59, v59, v14, v13
    v_fma_f32 v60, v60, v14, v13
    v_fma_f32 v61, v61, v14, v13
    v_mfma_f32_32x32x16_bf16 v[80:95], v[24:27], v[116:119], v[80:95]
    ds_read_b128 v[20:23], v18 offset:54272
    v_fma_f32 v62, v62, v14, v13
    v_fma_f32 v63, v63, v14, v13
    v_mul_f32 v56, v56, v96
    s_waitcnt lgkmcnt(6)
    v_mfma_f32_32x32x16_bf16 v[80:95], v[28:31], v[120:123], v[80:95]
    ds_read_b128 v[24:27], v18 offset:55296
    ds_write_b128 v10, v[72:75] offset:0
    v_mul_f32 v57, v57, v97
    v_mul_f32 v58, v58, v98
    v_mfma_f32_32x32x16_bf16 v[80:95], v[32:35], v[124:127], v[80:95]
    ds_read_b128 v[28:31], v18 offset:56320
    v_mul_f32 v59, v59, v99
    v_mul_f32 v60, v60, v100
    v_mul_f32 v61, v61, v101
    s_waitcnt lgkmcnt(7)
    v_mfma_f32_32x32x16_bf16 v[80:95], v[36:39], v[128:131], v[80:95]
    ds_read_b128 v[32:35], v18 offset:57344
    v_mul_f32 v62, v62, v102
    v_mul_f32 v63, v63, v103
    v_exp_f32 v56, v56
    v_mfma_f32_32x32x16_bf16 v[80:95], v[40:43], v[132:135], v[80:95]
    ds_read_b128 v[36:39], v18 offset:58368
    ds_write_b128 v10, v[76:79] offset:1024
    s_waitcnt lgkmcnt(8)
    v_mfma_f32_32x32x16_bf16 v[80:95], v[44:47], v[136:139], v[80:95]
    ds_read_b128 v[40:43], v18 offset:59392
    v_exp_f32 v57, v57
    v_exp_f32 v58, v58
    v_mfma_f32_32x32x16_bf16 v[80:95], v[48:51], v[140:143], v[80:95]
    ds_read_b128 v[44:47], v18 offset:60416
    v_exp_f32 v59, v59
    s_waitcnt lgkmcnt(8)
    v_mfma_f32_32x32x16_bf16 v[80:95], v[52:55], v[144:147], v[80:95]
    ds_read_b128 v[48:51], v18 offset:61440
    v_exp_f32 v60, v60
    v_exp_f32 v61, v61
    v_mfma_f32_32x32x16_bf16 v[80:95], v[20:23], v[148:151], v[80:95]
    ds_read_b128 v[52:55], v18 offset:62464
    v_exp_f32 v62, v62
    s_waitcnt lgkmcnt(7)
    v_mfma_f32_32x32x16_bf16 v[80:95], v[24:27], v[152:155], v[80:95]
    ds_read_b128 v[20:23], v18 offset:63488
    v_exp_f32 v63, v63
    v_add_f32 v56, 1.0, v56
    v_add_f32 v57, 1.0, v57
    v_mfma_f32_32x32x16_bf16 v[80:95], v[28:31], v[156:159], v[80:95]
    s_waitcnt vmcnt(1) lgkmcnt(5)
    s_barrier
    ds_read_b128 v[24:27], v18 offset:64512
    v_add_f32 v58, 1.0, v58
    v_mfma_f32_32x32x16_bf16 v[80:95], v[32:35], v[160:163], v[80:95]
    ds_read_b128 v[28:31], v19 offset:0
    v_add_f32 v59, 1.0, v59
    v_add_f32 v60, 1.0, v60
    v_add_f32 v61, 1.0, v61
    v_add_f32 v62, 1.0, v62
    v_mfma_f32_32x32x16_bf16 v[80:95], v[36:39], v[164:167], v[80:95]
    ds_read_b128 v[32:35], v19 offset:1024
    v_add_f32 v63, 1.0, v63
    v_rcp_f32 v56, v56
    s_waitcnt lgkmcnt(6)
    v_mfma_f32_32x32x16_bf16 v[80:95], v[40:43], v[168:171], v[80:95]
    ds_read_b128 v[36:39], v19 offset:2048
    v_rcp_f32 v57, v57
    v_rcp_f32 v58, v58
    v_mfma_f32_32x32x16_bf16 v[80:95], v[44:47], v[172:175], v[80:95]
    s_barrier
    ds_read_b128 v[40:43], v19 offset:3072
    s_waitcnt lgkmcnt(6)
    v_mfma_f32_32x32x16_bf16 v[80:95], v[48:51], v[176:179], v[80:95]
    ds_read_b128 v[44:47], v19 offset:4096
    v_rcp_f32 v59, v59
    v_rcp_f32 v60, v60
    v_mfma_f32_32x32x16_bf16 v[80:95], v[52:55], v[180:183], v[80:95]
    ds_read_b128 v[48:51], v19 offset:5120
    v_rcp_f32 v61, v61
    s_waitcnt lgkmcnt(6)
    v_mfma_f32_32x32x16_bf16 v[80:95], v[20:23], v[184:187], v[80:95]
    ds_read_b128 v[52:55], v19 offset:6144
    v_rcp_f32 v62, v62
    v_rcp_f32 v63, v63
    v_mfma_f32_32x32x16_bf16 v[80:95], v[24:27], v[188:191], v[80:95]
    ds_read_b128 v[20:23], v19 offset:7168
    v_mul_f32 v56, v56, v96
    v_mul_f32 v57, v57, v97
    v_mul_f32 v58, v58, v98
    s_waitcnt lgkmcnt(6)
    v_mfma_f32_32x32x16_bf16 v[80:95], v[28:31], v[192:195], v[80:95]
    ds_read_b128 v[24:27], v19 offset:8192
    v_mul_f32 v59, v59, v99
    v_mul_f32 v60, v60, v100
    v_mul_f32 v61, v61, v101
    v_mul_f32 v62, v62, v102
    v_mfma_f32_32x32x16_bf16 v[80:95], v[32:35], v[196:199], v[80:95]
    ds_read_b128 v[28:31], v19 offset:9216
    v_mul_f32 v63, v63, v103
    v_cvt_pk_bf16_f32 v96, v56, v57
    v_cvt_pk_bf16_f32 v97, v58, v59
    s_waitcnt lgkmcnt(6)
    v_mfma_f32_32x32x16_bf16 v[80:95], v[36:39], v[200:203], v[80:95]
    ds_read_b128 v[32:35], v19 offset:10240
    v_cvt_pk_bf16_f32 v98, v60, v61
    v_cvt_pk_bf16_f32 v99, v62, v63
    s_add_u32 s23, s21, 40960
    v_mfma_f32_32x32x16_bf16 v[80:95], v[40:43], v[204:207], v[80:95]
    ds_read_b128 v[36:39], v19 offset:11264
    buffer_store_dwordx4 v[96:99], v7, s[8:11], s23 offen offset:0 sc1
    ds_read_b128 v[56:59], v9 offset:768
    s_waitcnt lgkmcnt(7)
    v_mfma_f32_32x32x16_bf16 v[80:95], v[44:47], v[208:211], v[80:95]
    ds_read_b128 v[40:43], v19 offset:12288
    ds_read_b128 v[60:63], v9 offset:800
    v_mfma_f32_32x32x16_bf16 v[80:95], v[48:51], v[212:215], v[80:95]
    ds_read_b128 v[44:47], v19 offset:13312
    s_waitcnt lgkmcnt(8)
    v_mfma_f32_32x32x16_bf16 v[80:95], v[52:55], v[216:219], v[80:95]
    ds_read_b128 v[48:51], v19 offset:14336
    v_mfma_f32_32x32x16_bf16 v[80:95], v[20:23], v[220:223], v[80:95]
    ds_read_b128 v[52:55], v19 offset:15360
    s_waitcnt lgkmcnt(8)
    v_mfma_f32_32x32x16_bf16 v[80:95], v[24:27], v[224:227], v[80:95]
    ds_read_b128 v[20:23], v3 offset:0
    s_waitcnt lgkmcnt(4)
    v_fmac_f32 v64, v12, v56
    v_fmac_f32 v65, v12, v57
    v_mfma_f32_32x32x16_bf16 v[80:95], v[28:31], v[228:231], v[80:95]
    ds_read_b128 v[24:27], v3 offset:1024
    v_fmac_f32 v66, v12, v58
    v_fmac_f32 v67, v12, v59
    v_fmac_f32 v68, v12, v60
    v_mfma_f32_32x32x16_bf16 v[80:95], v[32:35], v[232:235], v[80:95]
    ds_read_b128 v[28:31], v3 offset:2048
    v_fmac_f32 v69, v12, v61
    v_fmac_f32 v70, v12, v62
    v_fmac_f32 v71, v12, v63
    v_mul_f32 v56, v64, v64
    v_mfma_f32_32x32x16_bf16 v[80:95], v[36:39], v[236:239], v[80:95]
    ds_read_b128 v[32:35], v3 offset:3072
    v_mul_f32 v57, v65, v65
    v_mul_f32 v58, v66, v66
    v_mul_f32 v59, v67, v67
    s_waitcnt lgkmcnt(6)
    v_mfma_f32_32x32x16_bf16 v[80:95], v[40:43], v[240:243], v[80:95]
    ds_read_b128 v[36:39], v3 offset:4096
    v_mul_f32 v60, v68, v68
    v_mul_f32 v61, v69, v69
    v_mul_f32 v62, v70, v70
    v_mul_f32 v63, v71, v71
    v_mfma_f32_32x32x16_bf16 v[80:95], v[44:47], v[244:247], v[80:95]
    ds_read_b128 v[40:43], v3 offset:5120
    v_fma_f32 v56, v56, v14, v13
    v_fma_f32 v57, v57, v14, v13
    v_fma_f32 v58, v58, v14, v13
    s_waitcnt lgkmcnt(6)
    v_mfma_f32_32x32x16_bf16 v[80:95], v[48:51], v[248:251], v[80:95]
    ds_read_b128 v[44:47], v3 offset:6144
    v_fma_f32 v59, v59, v14, v13
    v_fma_f32 v60, v60, v14, v13
    v_fma_f32 v61, v61, v14, v13
    v_fma_f32 v62, v62, v14, v13
    v_mfma_f32_32x32x16_bf16 v[80:95], v[52:55], v[252:255], v[80:95]
    ds_read_b128 v[48:51], v3 offset:7168
    v_fma_f32 v63, v63, v14, v13
    v_mul_f32 v56, v56, v64
    v_mul_f32 v57, v57, v65
    s_waitcnt lgkmcnt(6)
    v_mfma_f32_32x32x16_bf16 v[96:111], v[20:23], v[112:115], 0
    ds_read_b128 v[52:55], v3 offset:8192
    v_mul_f32 v58, v58, v66
    v_mul_f32 v59, v59, v67
    v_mul_f32 v60, v60, v68
    v_mul_f32 v61, v61, v69
    v_mfma_f32_32x32x16_bf16 v[96:111], v[24:27], v[116:119], v[96:111]
    ds_read_b128 v[20:23], v3 offset:9216
    v_mul_f32 v62, v62, v70
    v_mul_f32 v63, v63, v71
    s_waitcnt lgkmcnt(6)
    v_mfma_f32_32x32x16_bf16 v[96:111], v[28:31], v[120:123], v[96:111]
    ds_read_b128 v[24:27], v3 offset:10240
    ds_write_b128 v10, v[88:91] offset:0
    v_exp_f32 v56, v56
    v_mfma_f32_32x32x16_bf16 v[96:111], v[32:35], v[124:127], v[96:111]
    ds_read_b128 v[28:31], v3 offset:11264
    v_exp_f32 v57, v57
    s_waitcnt lgkmcnt(7)
    v_mfma_f32_32x32x16_bf16 v[96:111], v[36:39], v[128:131], v[96:111]
    ds_read_b128 v[32:35], v3 offset:12288
    v_exp_f32 v58, v58
    v_exp_f32 v59, v59
    v_mfma_f32_32x32x16_bf16 v[96:111], v[40:43], v[132:135], v[96:111]
    ds_read_b128 v[36:39], v3 offset:13312
    ds_write_b128 v10, v[92:95] offset:1024
    s_waitcnt lgkmcnt(8)
    v_mfma_f32_32x32x16_bf16 v[96:111], v[44:47], v[136:139], v[96:111]
    ds_read_b128 v[40:43], v3 offset:14336
    v_exp_f32 v60, v60
    v_exp_f32 v61, v61
    v_mfma_f32_32x32x16_bf16 v[96:111], v[48:51], v[140:143], v[96:111]
    ds_read_b128 v[44:47], v3 offset:15360
    v_exp_f32 v62, v62
    s_waitcnt lgkmcnt(8)
    v_mfma_f32_32x32x16_bf16 v[96:111], v[52:55], v[144:147], v[96:111]
    ds_read_b128 v[48:51], v3 offset:16384
    v_exp_f32 v63, v63
    v_add_f32 v56, 1.0, v56
    v_add_f32 v57, 1.0, v57
    v_mfma_f32_32x32x16_bf16 v[96:111], v[20:23], v[148:151], v[96:111]
    ds_read_b128 v[52:55], v3 offset:17408
    v_add_f32 v58, 1.0, v58
    v_add_f32 v59, 1.0, v59
    v_add_f32 v60, 1.0, v60
    s_waitcnt lgkmcnt(7)
    v_mfma_f32_32x32x16_bf16 v[96:111], v[24:27], v[152:155], v[96:111]
    ds_read_b128 v[20:23], v3 offset:18432
    v_add_f32 v61, 1.0, v61
    v_add_f32 v62, 1.0, v62
    v_add_f32 v63, 1.0, v63
    v_mfma_f32_32x32x16_bf16 v[96:111], v[28:31], v[156:159], v[96:111]
    s_waitcnt vmcnt(0) lgkmcnt(5)
    s_barrier
    ds_read_b128 v[24:27], v3 offset:19456
    v_mfma_f32_32x32x16_bf16 v[96:111], v[32:35], v[160:163], v[96:111]
    ds_read_b128 v[28:31], v3 offset:20480
    v_rcp_f32 v56, v56
    v_rcp_f32 v57, v57
    v_mfma_f32_32x32x16_bf16 v[96:111], v[36:39], v[164:167], v[96:111]
    ds_read_b128 v[32:35], v3 offset:21504
    v_rcp_f32 v58, v58
    s_waitcnt lgkmcnt(6)
    v_mfma_f32_32x32x16_bf16 v[96:111], v[40:43], v[168:171], v[96:111]
    ds_read_b128 v[36:39], v3 offset:22528
    v_rcp_f32 v59, v59
    v_rcp_f32 v60, v60
    v_mfma_f32_32x32x16_bf16 v[96:111], v[44:47], v[172:175], v[96:111]
    s_barrier
    ds_read_b128 v[40:43], v3 offset:23552
    s_waitcnt lgkmcnt(6)
    v_mfma_f32_32x32x16_bf16 v[96:111], v[48:51], v[176:179], v[96:111]
    ds_read_b128 v[44:47], v3 offset:24576
    v_rcp_f32 v61, v61
    v_rcp_f32 v62, v62
    v_mfma_f32_32x32x16_bf16 v[96:111], v[52:55], v[180:183], v[96:111]
    ds_read_b128 v[48:51], v3 offset:25600
    v_rcp_f32 v63, v63
    v_mul_f32 v56, v56, v64
    s_waitcnt lgkmcnt(6)
    v_mfma_f32_32x32x16_bf16 v[96:111], v[20:23], v[184:187], v[96:111]
    ds_read_b128 v[52:55], v3 offset:26624
    v_mul_f32 v57, v57, v65
    v_mul_f32 v58, v58, v66
    v_mul_f32 v59, v59, v67
    v_mul_f32 v60, v60, v68
    v_mfma_f32_32x32x16_bf16 v[96:111], v[24:27], v[188:191], v[96:111]
    ds_read_b128 v[20:23], v3 offset:27648
    v_mul_f32 v61, v61, v69
    v_mul_f32 v62, v62, v70
    v_mul_f32 v63, v63, v71
    s_waitcnt lgkmcnt(6)
    v_mfma_f32_32x32x16_bf16 v[96:111], v[28:31], v[192:195], v[96:111]
    ds_read_b128 v[24:27], v3 offset:28672
    v_cvt_pk_bf16_f32 v64, v56, v57
    v_cvt_pk_bf16_f32 v65, v58, v59
    v_cvt_pk_bf16_f32 v66, v60, v61
    v_cvt_pk_bf16_f32 v67, v62, v63
    v_mfma_f32_32x32x16_bf16 v[96:111], v[32:35], v[196:199], v[96:111]
    ds_read_b128 v[28:31], v3 offset:29696
    s_add_u32 s23, s21, 49152
    buffer_store_dwordx4 v[64:67], v7, s[8:11], s23 offen offset:0 sc1
    s_waitcnt lgkmcnt(6)
    v_mfma_f32_32x32x16_bf16 v[96:111], v[36:39], v[200:203], v[96:111]
    ds_read_b128 v[32:35], v3 offset:30720
    ds_read_b128 v[56:59], v9 offset:896
    ds_read_b128 v[60:63], v9 offset:928
    v_mfma_f32_32x32x16_bf16 v[96:111], v[40:43], v[204:207], v[96:111]
    ds_read_b128 v[36:39], v3 offset:31744
    s_waitcnt lgkmcnt(8)
    v_mfma_f32_32x32x16_bf16 v[96:111], v[44:47], v[208:211], v[96:111]
    ds_read_b128 v[40:43], v3 offset:32768
    v_mfma_f32_32x32x16_bf16 v[96:111], v[48:51], v[212:215], v[96:111]
    ds_read_b128 v[44:47], v3 offset:33792
    s_waitcnt lgkmcnt(8)
    v_mfma_f32_32x32x16_bf16 v[96:111], v[52:55], v[216:219], v[96:111]
    ds_read_b128 v[48:51], v3 offset:34816
    s_waitcnt lgkmcnt(4)
    v_fmac_f32 v80, v12, v56
    v_mfma_f32_32x32x16_bf16 v[96:111], v[20:23], v[220:223], v[96:111]
    ds_read_b128 v[52:55], v3 offset:35840
    v_fmac_f32 v81, v12, v57
    v_fmac_f32 v82, v12, v58
    v_fmac_f32 v83, v12, v59
    v_mfma_f32_32x32x16_bf16 v[96:111], v[24:27], v[224:227], v[96:111]
    v_fmac_f32 v84, v12, v60
    v_fmac_f32 v85, v12, v61
    v_fmac_f32 v86, v12, v62
    v_fmac_f32 v87, v12, v63
    v_mul_f32 v56, v80, v80
    v_mfma_f32_32x32x16_bf16 v[96:111], v[28:31], v[228:231], v[96:111]
    v_mul_f32 v57, v81, v81
    v_mul_f32 v58, v82, v82
    v_mul_f32 v59, v83, v83
    v_mul_f32 v60, v84, v84
    s_waitcnt lgkmcnt(4)
    v_mfma_f32_32x32x16_bf16 v[96:111], v[32:35], v[232:235], v[96:111]
    v_mul_f32 v61, v85, v85
    v_mul_f32 v62, v86, v86
    v_mul_f32 v63, v87, v87
    v_fma_f32 v56, v56, v14, v13
    v_fma_f32 v57, v57, v14, v13
    v_mfma_f32_32x32x16_bf16 v[96:111], v[36:39], v[236:239], v[96:111]
    v_fma_f32 v58, v58, v14, v13
    v_fma_f32 v59, v59, v14, v13
    v_fma_f32 v60, v60, v14, v13
    v_fma_f32 v61, v61, v14, v13
    s_waitcnt lgkmcnt(2)
    v_mfma_f32_32x32x16_bf16 v[96:111], v[40:43], v[240:243], v[96:111]
    v_fma_f32 v62, v62, v14, v13
    v_fma_f32 v63, v63, v14, v13
    v_mul_f32 v56, v56, v80
    v_mul_f32 v57, v57, v81
    v_mul_f32 v58, v58, v82
    v_mfma_f32_32x32x16_bf16 v[96:111], v[44:47], v[244:247], v[96:111]
    v_mul_f32 v59, v59, v83
    v_mul_f32 v60, v60, v84
    v_mul_f32 v61, v61, v85
    v_mul_f32 v62, v62, v86
    s_waitcnt lgkmcnt(0)
    v_mfma_f32_32x32x16_bf16 v[96:111], v[48:51], v[248:251], v[96:111]
    v_mul_f32 v63, v63, v87
    v_exp_f32 v56, v56
    v_exp_f32 v57, v57
    v_mfma_f32_32x32x16_bf16 v[96:111], v[52:55], v[252:255], v[96:111]
    v_exp_f32 v58, v58
    v_exp_f32 v59, v59
    v_exp_f32 v60, v60
    v_exp_f32 v61, v61
    v_exp_f32 v62, v62
    v_exp_f32 v63, v63
    v_add_f32 v56, 1.0, v56
    v_add_f32 v57, 1.0, v57
    v_add_f32 v58, 1.0, v58
    v_add_f32 v59, 1.0, v59
    v_add_f32 v60, 1.0, v60
    v_add_f32 v61, 1.0, v61
    v_add_f32 v62, 1.0, v62
    v_add_f32 v63, 1.0, v63
    v_rcp_f32 v56, v56
    v_rcp_f32 v57, v57
    v_rcp_f32 v58, v58
    v_rcp_f32 v59, v59
    v_rcp_f32 v60, v60
    v_rcp_f32 v61, v61
    v_rcp_f32 v62, v62
    v_rcp_f32 v63, v63
    v_mul_f32 v56, v56, v80
    v_mul_f32 v57, v57, v81
    v_mul_f32 v58, v58, v82
    v_mul_f32 v59, v59, v83
    v_mul_f32 v60, v60, v84
    v_mul_f32 v61, v61, v85
    v_mul_f32 v62, v62, v86
    v_mul_f32 v63, v63, v87
    v_cvt_pk_bf16_f32 v80, v56, v57
    v_cvt_pk_bf16_f32 v81, v58, v59
    v_cvt_pk_bf16_f32 v82, v60, v61
    v_cvt_pk_bf16_f32 v83, v62, v63
    s_add_u32 s23, s21, 57344
    buffer_store_dwordx4 v[80:83], v7, s[8:11], s23 offen offset:0 sc1
    ds_read_b128 v[56:59], v9 offset:1024
    ds_read_b128 v[60:63], v9 offset:1056
    ds_write_b128 v10, v[104:107] offset:0
    ds_write_b128 v10, v[108:111] offset:1024
    s_waitcnt lgkmcnt(0)
    s_barrier
    v_fmac_f32 v96, v12, v56
    v_fmac_f32 v97, v12, v57
    v_fmac_f32 v98, v12, v58
    v_fmac_f32 v99, v12, v59
    v_fmac_f32 v100, v12, v60
    v_fmac_f32 v101, v12, v61
    v_fmac_f32 v102, v12, v62
    v_fmac_f32 v103, v12, v63
    v_mul_f32 v56, v96, v96
    v_mul_f32 v57, v97, v97
    v_mul_f32 v58, v98, v98
    v_mul_f32 v59, v99, v99
    v_mul_f32 v60, v100, v100
    v_mul_f32 v61, v101, v101
    v_mul_f32 v62, v102, v102
    v_mul_f32 v63, v103, v103
    v_fma_f32 v56, v56, v14, v13
    v_fma_f32 v57, v57, v14, v13
    v_fma_f32 v58, v58, v14, v13
    v_fma_f32 v59, v59, v14, v13
    v_fma_f32 v60, v60, v14, v13
    v_fma_f32 v61, v61, v14, v13
    v_fma_f32 v62, v62, v14, v13
    v_fma_f32 v63, v63, v14, v13
    v_mul_f32 v56, v56, v96
    v_mul_f32 v57, v57, v97
    v_mul_f32 v58, v58, v98
    v_mul_f32 v59, v59, v99
    v_mul_f32 v60, v60, v100
    v_mul_f32 v61, v61, v101
    v_mul_f32 v62, v62, v102
    v_mul_f32 v63, v63, v103
    v_exp_f32 v56, v56
    v_exp_f32 v57, v57
    v_exp_f32 v58, v58
    v_exp_f32 v59, v59
    v_exp_f32 v60, v60
    v_exp_f32 v61, v61
    v_exp_f32 v62, v62
    v_exp_f32 v63, v63
    v_add_f32 v56, 1.0, v56
    v_add_f32 v57, 1.0, v57
    v_add_f32 v58, 1.0, v58
    v_add_f32 v59, 1.0, v59
    v_add_f32 v60, 1.0, v60
    v_add_f32 v61, 1.0, v61
    v_add_f32 v62, 1.0, v62
    v_add_f32 v63, 1.0, v63
    v_rcp_f32 v56, v56
    v_rcp_f32 v57, v57
    v_rcp_f32 v58, v58
    v_rcp_f32 v59, v59
    v_rcp_f32 v60, v60
    v_rcp_f32 v61, v61
    v_rcp_f32 v62, v62
    v_rcp_f32 v63, v63
    v_mul_f32 v56, v56, v96
    v_mul_f32 v57, v57, v97
    v_mul_f32 v58, v58, v98
    v_mul_f32 v59, v59, v99
    v_mul_f32 v60, v60, v100
    v_mul_f32 v61, v61, v101
    v_mul_f32 v62, v62, v102
    v_mul_f32 v63, v63, v103
    v_cvt_pk_bf16_f32 v96, v56, v57
    v_cvt_pk_bf16_f32 v97, v58, v59
    v_cvt_pk_bf16_f32 v98, v60, v61
    v_cvt_pk_bf16_f32 v99, v62, v63
    s_add_u32 s23, s21, 65536
    buffer_store_dwordx4 v[96:99], v7, s[8:11], s23 offen offset:0 sc1
    s_waitcnt vmcnt(2)
    s_load_dwordx2 s[6:7], s[0:1], 112
    s_lshl_b32 s16, s24, 11
    s_add_u32 s16, s16, 9216
    v_add_u32 v35, s16, v3
    v_add_u32 v24, 8192, v3
    s_add_u32 s16, s26, 0
    s_and_b32 s16, s16, 3
    s_lshl_b32 s16, s16, 11
    v_add_u32 v20, s16, v3
    s_add_u32 s16, s26, 1
    s_and_b32 s16, s16, 3
    s_lshl_b32 s16, s16, 11
    v_add_u32 v21, s16, v3
    s_add_u32 s16, s26, 2
    s_and_b32 s16, s16, 3
    s_lshl_b32 s16, s16, 11
    v_add_u32 v22, s16, v3
    s_add_u32 s16, s26, 3
    s_and_b32 s16, s16, 3
    s_lshl_b32 s16, s16, 11
    v_add_u32 v23, s16, v3
    s_waitcnt lgkmcnt(0)
    s_barrier
    ds_read_b128 v[40:43], v20 offset:36864
    ds_read_b128 v[76:79], v35 offset:36864
    ds_read_b128 v[44:47], v20 offset:37888
    ds_read_b128 v[80:83], v35 offset:37888
    ds_read_b128 v[48:51], v21 offset:36864
    ds_read_b128 v[52:55], v21 offset:37888
    v_add_u32 v36, 0x10000, v35
    v_add_u32 v37, 0x20000, v35
    v_add_u32 v25, 0x10000, v20
    v_add_u32 v30, 0x20000, v20
    v_add_u32 v26, 0x10000, v21
    v_add_u32 v31, 0x20000, v21
    v_add_u32 v27, 0x10000, v22
    v_add_u32 v32, 0x20000, v22
    v_add_u32 v28, 0x10000, v23
    v_add_u32 v33, 0x20000, v23
    v_add_u32 v29, 0x10000, v24
    v_add_u32 v34, 0x20000, v24
    s_waitcnt lgkmcnt(2)
    v_mfma_f32_16x16x32_bf16 v[96:99], v[40:43], v[76:79], 0
    ds_read_b128 v[56:59], v22 offset:36864
    v_mfma_f32_16x16x32_bf16 v[100:103], v[40:43], v[80:83], 0
    v_mfma_f32_16x16x32_bf16 v[104:107], v[44:47], v[76:79], 0
    ds_read_b128 v[60:63], v22 offset:37888
    v_mfma_f32_16x16x32_bf16 v[108:111], v[44:47], v[80:83], 0
    s_waitcnt lgkmcnt(3)
    v_mfma_f32_16x16x32_bf16 v[112:115], v[48:51], v[76:79], 0
    ds_read_b128 v[64:67], v23 offset:36864
    v_mfma_f32_16x16x32_bf16 v[116:119], v[48:51], v[80:83], 0
    s_waitcnt lgkmcnt(3)
    v_mfma_f32_16x16x32_bf16 v[120:123], v[52:55], v[76:79], 0
    ds_read_b128 v[68:71], v23 offset:37888
    v_mfma_f32_16x16x32_bf16 v[124:127], v[52:55], v[80:83], 0
    s_waitcnt lgkmcnt(3)
    v_mfma_f32_16x16x32_bf16 v[128:131], v[56:59], v[76:79], 0
    ds_read_b128 v[72:75], v24 offset:36864
    v_mfma_f32_16x16x32_bf16 v[132:135], v[56:59], v[80:83], 0
    s_waitcnt lgkmcnt(3)
    v_mfma_f32_16x16x32_bf16 v[136:139], v[60:63], v[76:79], 0
    ds_read_b128 v[40:43], v20 offset:54272
    v_mfma_f32_16x16x32_bf16 v[140:143], v[60:63], v[80:83], 0
    ds_read_b128 v[84:87], v35 offset:54272
    s_waitcnt lgkmcnt(4)
    v_mfma_f32_16x16x32_bf16 v[144:147], v[64:67], v[76:79], 0
    ds_read_b128 v[44:47], v20 offset:55296
    v_mfma_f32_16x16x32_bf16 v[148:151], v[64:67], v[80:83], 0
    ds_read_b128 v[88:91], v35 offset:55296
    s_waitcnt lgkmcnt(5)
    v_mfma_f32_16x16x32_bf16 v[152:155], v[68:71], v[76:79], 0
    ds_read_b128 v[48:51], v21 offset:54272
    v_mfma_f32_16x16x32_bf16 v[156:159], v[68:71], v[80:83], 0
    s_waitcnt lgkmcnt(5)
    v_mfma_f32_16x16x32_bf16 v[160:163], v[72:75], v[76:79], 0
    ds_read_b128 v[52:55], v21 offset:55296
    v_mfma_f32_16x16x32_bf16 v[164:167], v[72:75], v[80:83], 0
    s_waitcnt lgkmcnt(2)
    v_mfma_f32_16x16x32_bf16 v[96:99], v[40:43], v[84:87], v[96:99]
    ds_read_b128 v[56:59], v22 offset:54272
    v_mfma_f32_16x16x32_bf16 v[100:103], v[40:43], v[88:91], v[100:103]
    v_mfma_f32_16x16x32_bf16 v[104:107], v[44:47], v[84:87], v[104:107]
    ds_read_b128 v[60:63], v22 offset:55296
    v_mfma_f32_16x16x32_bf16 v[108:111], v[44:47], v[88:91], v[108:111]
    s_waitcnt lgkmcnt(3)
    v_mfma_f32_16x16x32_bf16 v[112:115], v[48:51], v[84:87], v[112:115]
    ds_read_b128 v[64:67], v23 offset:54272
    v_mfma_f32_16x16x32_bf16 v[116:119], v[48:51], v[88:91], v[116:119]
    s_waitcnt lgkmcnt(3)
    v_mfma_f32_16x16x32_bf16 v[120:123], v[52:55], v[84:87], v[120:123]
    ds_read_b128 v[68:71], v23 offset:55296
    v_mfma_f32_16x16x32_bf16 v[124:127], v[52:55], v[88:91], v[124:127]
    s_waitcnt lgkmcnt(3)
    v_mfma_f32_16x16x32_bf16 v[128:131], v[56:59], v[84:87], v[128:131]
    ds_read_b128 v[72:75], v24 offset:54272
    v_mfma_f32_16x16x32_bf16 v[132:135], v[56:59], v[88:91], v[132:135]
    s_waitcnt lgkmcnt(3)
    v_mfma_f32_16x16x32_bf16 v[136:139], v[60:63], v[84:87], v[136:139]
    ds_read_b128 v[40:43], v25 offset:6144
    v_mfma_f32_16x16x32_bf16 v[140:143], v[60:63], v[88:91], v[140:143]
    ds_read_b128 v[76:79], v36 offset:6144
    s_waitcnt lgkmcnt(4)
    v_mfma_f32_16x16x32_bf16 v[144:147], v[64:67], v[84:87], v[144:147]
    ds_read_b128 v[44:47], v25 offset:7168
    v_mfma_f32_16x16x32_bf16 v[148:151], v[64:67], v[88:91], v[148:151]
    ds_read_b128 v[80:83], v36 offset:7168
    s_waitcnt lgkmcnt(5)
    v_mfma_f32_16x16x32_bf16 v[152:155], v[68:71], v[84:87], v[152:155]
    ds_read_b128 v[48:51], v26 offset:6144
    v_mfma_f32_16x16x32_bf16 v[156:159], v[68:71], v[88:91], v[156:159]
    s_waitcnt lgkmcnt(5)
    v_mfma_f32_16x16x32_bf16 v[160:163], v[72:75], v[84:87], v[160:163]
    ds_read_b128 v[52:55], v26 offset:7168
    v_mfma_f32_16x16x32_bf16 v[164:167], v[72:75], v[88:91], v[164:167]
    s_waitcnt lgkmcnt(2)
    v_mfma_f32_16x16x32_bf16 v[96:99], v[40:43], v[76:79], v[96:99]
    ds_read_b128 v[56:59], v27 offset:6144
    v_mfma_f32_16x16x32_bf16 v[100:103], v[40:43], v[80:83], v[100:103]
    v_mfma_f32_16x16x32_bf16 v[104:107], v[44:47], v[76:79], v[104:107]
    ds_read_b128 v[60:63], v27 offset:7168
    v_mfma_f32_16x16x32_bf16 v[108:111], v[44:47], v[80:83], v[108:111]
    s_waitcnt lgkmcnt(3)
    v_mfma_f32_16x16x32_bf16 v[112:115], v[48:51], v[76:79], v[112:115]
    ds_read_b128 v[64:67], v28 offset:6144
    v_mfma_f32_16x16x32_bf16 v[116:119], v[48:51], v[80:83], v[116:119]
    s_waitcnt lgkmcnt(3)
    v_mfma_f32_16x16x32_bf16 v[120:123], v[52:55], v[76:79], v[120:123]
    ds_read_b128 v[68:71], v28 offset:7168
    v_mfma_f32_16x16x32_bf16 v[124:127], v[52:55], v[80:83], v[124:127]
    s_waitcnt lgkmcnt(3)
    v_mfma_f32_16x16x32_bf16 v[128:131], v[56:59], v[76:79], v[128:131]
    ds_read_b128 v[72:75], v29 offset:6144
    v_mfma_f32_16x16x32_bf16 v[132:135], v[56:59], v[80:83], v[132:135]
    s_barrier
    s_waitcnt lgkmcnt(3)
    v_mfma_f32_16x16x32_bf16 v[136:139], v[60:63], v[76:79], v[136:139]
    ds_read_b128 v[40:43], v25 offset:23552
    v_mfma_f32_16x16x32_bf16 v[140:143], v[60:63], v[80:83], v[140:143]
    ds_read_b128 v[84:87], v36 offset:23552
    s_waitcnt lgkmcnt(4)
    v_mfma_f32_16x16x32_bf16 v[144:147], v[64:67], v[76:79], v[144:147]
    ds_read_b128 v[44:47], v25 offset:24576
    v_mfma_f32_16x16x32_bf16 v[148:151], v[64:67], v[80:83], v[148:151]
    ds_read_b128 v[88:91], v36 offset:24576
    s_waitcnt lgkmcnt(5)
    v_mfma_f32_16x16x32_bf16 v[152:155], v[68:71], v[76:79], v[152:155]
    ds_read_b128 v[48:51], v26 offset:23552
    v_mfma_f32_16x16x32_bf16 v[156:159], v[68:71], v[80:83], v[156:159]
    s_waitcnt lgkmcnt(5)
    v_mfma_f32_16x16x32_bf16 v[160:163], v[72:75], v[76:79], v[160:163]
    ds_read_b128 v[52:55], v26 offset:24576
    v_mfma_f32_16x16x32_bf16 v[164:167], v[72:75], v[80:83], v[164:167]
    s_waitcnt lgkmcnt(2)
    v_mfma_f32_16x16x32_bf16 v[96:99], v[40:43], v[84:87], v[96:99]
    ds_read_b128 v[56:59], v27 offset:23552
    v_mfma_f32_16x16x32_bf16 v[100:103], v[40:43], v[88:91], v[100:103]
    v_mfma_f32_16x16x32_bf16 v[104:107], v[44:47], v[84:87], v[104:107]
    ds_read_b128 v[60:63], v27 offset:24576
    v_mfma_f32_16x16x32_bf16 v[108:111], v[44:47], v[88:91], v[108:111]
    s_waitcnt lgkmcnt(3)
    v_mfma_f32_16x16x32_bf16 v[112:115], v[48:51], v[84:87], v[112:115]
    ds_read_b128 v[64:67], v28 offset:23552
    v_mfma_f32_16x16x32_bf16 v[116:119], v[48:51], v[88:91], v[116:119]
    s_waitcnt lgkmcnt(3)
    v_mfma_f32_16x16x32_bf16 v[120:123], v[52:55], v[84:87], v[120:123]
    ds_read_b128 v[68:71], v28 offset:24576
    v_mfma_f32_16x16x32_bf16 v[124:127], v[52:55], v[88:91], v[124:127]
    s_waitcnt lgkmcnt(3)
    v_mfma_f32_16x16x32_bf16 v[128:131], v[56:59], v[84:87], v[128:131]
    ds_read_b128 v[72:75], v29 offset:23552
    v_mfma_f32_16x16x32_bf16 v[132:135], v[56:59], v[88:91], v[132:135]
    s_barrier
    s_waitcnt lgkmcnt(3)
    v_mfma_f32_16x16x32_bf16 v[136:139], v[60:63], v[84:87], v[136:139]
    ds_read_b128 v[40:43], v25 offset:40960
    v_mfma_f32_16x16x32_bf16 v[140:143], v[60:63], v[88:91], v[140:143]
    ds_read_b128 v[76:79], v36 offset:40960
    s_waitcnt lgkmcnt(4)
    v_mfma_f32_16x16x32_bf16 v[144:147], v[64:67], v[84:87], v[144:147]
    ds_read_b128 v[44:47], v25 offset:41984
    v_mfma_f32_16x16x32_bf16 v[148:151], v[64:67], v[88:91], v[148:151]
    ds_read_b128 v[80:83], v36 offset:41984
    s_waitcnt lgkmcnt(5)
    v_mfma_f32_16x16x32_bf16 v[152:155], v[68:71], v[84:87], v[152:155]
    ds_read_b128 v[48:51], v26 offset:40960
    v_mfma_f32_16x16x32_bf16 v[156:159], v[68:71], v[88:91], v[156:159]
    s_waitcnt lgkmcnt(5)
    v_mfma_f32_16x16x32_bf16 v[160:163], v[72:75], v[84:87], v[160:163]
    ds_read_b128 v[52:55], v26 offset:41984
    v_mfma_f32_16x16x32_bf16 v[164:167], v[72:75], v[88:91], v[164:167]
    s_waitcnt lgkmcnt(2)
    v_mfma_f32_16x16x32_bf16 v[96:99], v[40:43], v[76:79], v[96:99]
    ds_read_b128 v[56:59], v27 offset:40960
    v_mfma_f32_16x16x32_bf16 v[100:103], v[40:43], v[80:83], v[100:103]
    v_mfma_f32_16x16x32_bf16 v[104:107], v[44:47], v[76:79], v[104:107]
    ds_read_b128 v[60:63], v27 offset:41984
    v_mfma_f32_16x16x32_bf16 v[108:111], v[44:47], v[80:83], v[108:111]
    s_waitcnt lgkmcnt(3)
    v_mfma_f32_16x16x32_bf16 v[112:115], v[48:51], v[76:79], v[112:115]
    ds_read_b128 v[64:67], v28 offset:40960
    v_mfma_f32_16x16x32_bf16 v[116:119], v[48:51], v[80:83], v[116:119]
    s_waitcnt lgkmcnt(3)
    v_mfma_f32_16x16x32_bf16 v[120:123], v[52:55], v[76:79], v[120:123]
    ds_read_b128 v[68:71], v28 offset:41984
    v_mfma_f32_16x16x32_bf16 v[124:127], v[52:55], v[80:83], v[124:127]
    s_waitcnt lgkmcnt(3)
    v_mfma_f32_16x16x32_bf16 v[128:131], v[56:59], v[76:79], v[128:131]
    ds_read_b128 v[72:75], v29 offset:40960
    v_mfma_f32_16x16x32_bf16 v[132:135], v[56:59], v[80:83], v[132:135]
    s_barrier
    s_waitcnt lgkmcnt(3)
    v_mfma_f32_16x16x32_bf16 v[136:139], v[60:63], v[76:79], v[136:139]
    ds_read_b128 v[40:43], v25 offset:58368
    v_mfma_f32_16x16x32_bf16 v[140:143], v[60:63], v[80:83], v[140:143]
    ds_read_b128 v[84:87], v36 offset:58368
    s_waitcnt lgkmcnt(4)
    v_mfma_f32_16x16x32_bf16 v[144:147], v[64:67], v[76:79], v[144:147]
    ds_read_b128 v[44:47], v25 offset:59392
    v_mfma_f32_16x16x32_bf16 v[148:151], v[64:67], v[80:83], v[148:151]
    ds_read_b128 v[88:91], v36 offset:59392
    s_waitcnt lgkmcnt(5)
    v_mfma_f32_16x16x32_bf16 v[152:155], v[68:71], v[76:79], v[152:155]
    ds_read_b128 v[48:51], v26 offset:58368
    v_mfma_f32_16x16x32_bf16 v[156:159], v[68:71], v[80:83], v[156:159]
    s_waitcnt lgkmcnt(5)
    v_mfma_f32_16x16x32_bf16 v[160:163], v[72:75], v[76:79], v[160:163]
    ds_read_b128 v[52:55], v26 offset:59392
    v_mfma_f32_16x16x32_bf16 v[164:167], v[72:75], v[80:83], v[164:167]
    s_waitcnt lgkmcnt(2)
    v_mfma_f32_16x16x32_bf16 v[96:99], v[40:43], v[84:87], v[96:99]
    ds_read_b128 v[56:59], v27 offset:58368
    v_mfma_f32_16x16x32_bf16 v[100:103], v[40:43], v[88:91], v[100:103]
    v_mfma_f32_16x16x32_bf16 v[104:107], v[44:47], v[84:87], v[104:107]
    ds_read_b128 v[60:63], v27 offset:59392
    v_mfma_f32_16x16x32_bf16 v[108:111], v[44:47], v[88:91], v[108:111]
    s_waitcnt lgkmcnt(3)
    v_mfma_f32_16x16x32_bf16 v[112:115], v[48:51], v[84:87], v[112:115]
    ds_read_b128 v[64:67], v28 offset:58368
    v_mfma_f32_16x16x32_bf16 v[116:119], v[48:51], v[88:91], v[116:119]
    s_waitcnt lgkmcnt(3)
    v_mfma_f32_16x16x32_bf16 v[120:123], v[52:55], v[84:87], v[120:123]
    ds_read_b128 v[68:71], v28 offset:59392
    v_mfma_f32_16x16x32_bf16 v[124:127], v[52:55], v[88:91], v[124:127]
    s_waitcnt lgkmcnt(3)
    v_mfma_f32_16x16x32_bf16 v[128:131], v[56:59], v[84:87], v[128:131]
    ds_read_b128 v[72:75], v29 offset:58368
    v_mfma_f32_16x16x32_bf16 v[132:135], v[56:59], v[88:91], v[132:135]
    s_barrier
    s_waitcnt lgkmcnt(3)
    v_mfma_f32_16x16x32_bf16 v[136:139], v[60:63], v[84:87], v[136:139]
    ds_read_b128 v[40:43], v30 offset:10240
    v_mfma_f32_16x16x32_bf16 v[140:143], v[60:63], v[88:91], v[140:143]
    ds_read_b128 v[76:79], v37 offset:10240
    s_waitcnt lgkmcnt(4)
    v_mfma_f32_16x16x32_bf16 v[144:147], v[64:67], v[84:87], v[144:147]
    ds_read_b128 v[44:47], v30 offset:11264
    v_mfma_f32_16x16x32_bf16 v[148:151], v[64:67], v[88:91], v[148:151]
    ds_read_b128 v[80:83], v37 offset:11264
    s_waitcnt lgkmcnt(5)
    v_mfma_f32_16x16x32_bf16 v[152:155], v[68:71], v[84:87], v[152:155]
    ds_read_b128 v[48:51], v31 offset:10240
    v_mfma_f32_16x16x32_bf16 v[156:159], v[68:71], v[88:91], v[156:159]
    s_waitcnt lgkmcnt(5)
    v_mfma_f32_16x16x32_bf16 v[160:163], v[72:75], v[84:87], v[160:163]
    ds_read_b128 v[52:55], v31 offset:11264
    v_mfma_f32_16x16x32_bf16 v[164:167], v[72:75], v[88:91], v[164:167]
    s_waitcnt lgkmcnt(2)
    v_mfma_f32_16x16x32_bf16 v[96:99], v[40:43], v[76:79], v[96:99]
    ds_read_b128 v[56:59], v32 offset:10240
    v_mfma_f32_16x16x32_bf16 v[100:103], v[40:43], v[80:83], v[100:103]
    s_lshl_b32 s16, s12, 2
    v_mfma_f32_16x16x32_bf16 v[104:107], v[44:47], v[76:79], v[104:107]
    ds_read_b128 v[60:63], v32 offset:11264
    v_mfma_f32_16x16x32_bf16 v[108:111], v[44:47], v[80:83], v[108:111]
    s_add_u32 s16, s16, s24
    s_waitcnt lgkmcnt(3)
    v_mfma_f32_16x16x32_bf16 v[112:115], v[48:51], v[76:79], v[112:115]
    ds_read_b128 v[64:67], v33 offset:10240
    v_mfma_f32_16x16x32_bf16 v[116:119], v[48:51], v[80:83], v[116:119]
    s_mul_i32 s17, s16, 36864
    s_waitcnt lgkmcnt(3)
    v_mfma_f32_16x16x32_bf16 v[120:123], v[52:55], v[76:79], v[120:123]
    ds_read_b128 v[68:71], v33 offset:11264
    v_mfma_f32_16x16x32_bf16 v[124:127], v[52:55], v[80:83], v[124:127]
    s_mul_i32 s18, s27, 9
    s_waitcnt lgkmcnt(3)
    v_mfma_f32_16x16x32_bf16 v[128:131], v[56:59], v[76:79], v[128:131]
    ds_read_b128 v[72:75], v34 offset:10240
    v_mfma_f32_16x16x32_bf16 v[132:135], v[56:59], v[80:83], v[132:135]
    s_waitcnt vmcnt(0)
    s_barrier
    s_waitcnt lgkmcnt(3)
    v_mfma_f32_16x16x32_bf16 v[136:139], v[60:63], v[76:79], v[136:139]
    ds_read_b128 v[40:43], v20 offset:0
    v_mfma_f32_16x16x32_bf16 v[140:143], v[60:63], v[80:83], v[140:143]
    ds_read_b128 v[84:87], v35 offset:0
    s_waitcnt lgkmcnt(4)
    v_mfma_f32_16x16x32_bf16 v[144:147], v[64:67], v[76:79], v[144:147]
    ds_read_b128 v[44:47], v20 offset:1024
    v_mfma_f32_16x16x32_bf16 v[148:151], v[64:67], v[80:83], v[148:151]
    ds_read_b128 v[88:91], v35 offset:1024
    s_waitcnt lgkmcnt(5)
    v_mfma_f32_16x16x32_bf16 v[152:155], v[68:71], v[76:79], v[152:155]
    ds_read_b128 v[48:51], v21 offset:0
    v_mfma_f32_16x16x32_bf16 v[156:159], v[68:71], v[80:83], v[156:159]
    s_lshl_b32 s19, s26, 1
    s_waitcnt lgkmcnt(5)
    v_mfma_f32_16x16x32_bf16 v[160:163], v[72:75], v[76:79], v[160:163]
    ds_read_b128 v[52:55], v21 offset:1024
    v_mfma_f32_16x16x32_bf16 v[164:167], v[72:75], v[80:83], v[164:167]
    s_add_u32 s19, s19, s18
    s_waitcnt lgkmcnt(2)
    v_mfma_f32_16x16x32_bf16 v[96:99], v[40:43], v[84:87], v[96:99]
    ds_read_b128 v[56:59], v22 offset:0
    v_mfma_f32_16x16x32_bf16 v[100:103], v[40:43], v[88:91], v[100:103]
    s_add_u32 s18, s18, 8
    v_mfma_f32_16x16x32_bf16 v[104:107], v[44:47], v[84:87], v[104:107]
    ds_read_b128 v[60:63], v22 offset:1024
    v_mfma_f32_16x16x32_bf16 v[108:111], v[44:47], v[88:91], v[108:111]
    s_lshl_b32 s20, s19, 10
    s_waitcnt lgkmcnt(3)
    v_mfma_f32_16x16x32_bf16 v[112:115], v[48:51], v[84:87], v[112:115]
    ds_read_b128 v[64:67], v23 offset:0
    v_mfma_f32_16x16x32_bf16 v[116:119], v[48:51], v[88:91], v[116:119]
    s_add_u32 s20, s20, s17
    s_waitcnt lgkmcnt(3)
    v_mfma_f32_16x16x32_bf16 v[120:123], v[52:55], v[84:87], v[120:123]
    ds_read_b128 v[68:71], v23 offset:1024
    v_mfma_f32_16x16x32_bf16 v[124:127], v[52:55], v[88:91], v[124:127]
    s_lshl_b32 s21, s18, 10
    s_waitcnt lgkmcnt(3)
    v_mfma_f32_16x16x32_bf16 v[128:131], v[56:59], v[84:87], v[128:131]
    ds_read_b128 v[72:75], v24 offset:0
    v_mfma_f32_16x16x32_bf16 v[132:135], v[56:59], v[88:91], v[132:135]
    s_barrier
    s_waitcnt lgkmcnt(3)
    v_mfma_f32_16x16x32_bf16 v[136:139], v[60:63], v[84:87], v[136:139]
    ds_read_b128 v[40:43], v20 offset:17408
    v_mfma_f32_16x16x32_bf16 v[140:143], v[60:63], v[88:91], v[140:143]
    ds_read_b128 v[76:79], v35 offset:17408
    s_waitcnt lgkmcnt(4)
    v_mfma_f32_16x16x32_bf16 v[144:147], v[64:67], v[84:87], v[144:147]
    ds_read_b128 v[44:47], v20 offset:18432
    v_mfma_f32_16x16x32_bf16 v[148:151], v[64:67], v[88:91], v[148:151]
    ds_read_b128 v[80:83], v35 offset:18432
    s_waitcnt lgkmcnt(5)
    v_mfma_f32_16x16x32_bf16 v[152:155], v[68:71], v[84:87], v[152:155]
    ds_read_b128 v[48:51], v21 offset:17408
    v_mfma_f32_16x16x32_bf16 v[156:159], v[68:71], v[88:91], v[156:159]
    s_add_u32 s21, s21, s17
    s_waitcnt lgkmcnt(5)
    v_mfma_f32_16x16x32_bf16 v[160:163], v[72:75], v[84:87], v[160:163]
    ds_read_b128 v[52:55], v21 offset:18432
    v_mfma_f32_16x16x32_bf16 v[164:167], v[72:75], v[88:91], v[164:167]
    s_add_u32 s22, s20, 27414528
    s_waitcnt lgkmcnt(2)
    v_mfma_f32_16x16x32_bf16 v[96:99], v[40:43], v[76:79], v[96:99]
    ds_read_b128 v[56:59], v22 offset:17408
    v_mfma_f32_16x16x32_bf16 v[100:103], v[40:43], v[80:83], v[100:103]
    s_add_u32 s23, s21, 27414528
    v_mfma_f32_16x16x32_bf16 v[104:107], v[44:47], v[76:79], v[104:107]
    ds_read_b128 v[60:63], v22 offset:18432
    v_mfma_f32_16x16x32_bf16 v[108:111], v[44:47], v[80:83], v[108:111]
    s_add_u32 s20, s20, 20336640
    s_waitcnt lgkmcnt(3)
    v_mfma_f32_16x16x32_bf16 v[112:115], v[48:51], v[76:79], v[112:115]
    ds_read_b128 v[64:67], v23 offset:17408
    v_mfma_f32_16x16x32_bf16 v[116:119], v[48:51], v[80:83], v[116:119]
    s_add_u32 s21, s21, 20336640
    s_waitcnt lgkmcnt(3)
    v_mfma_f32_16x16x32_bf16 v[120:123], v[52:55], v[76:79], v[120:123]
    ds_read_b128 v[68:71], v23 offset:18432
    v_mfma_f32_16x16x32_bf16 v[124:127], v[52:55], v[80:83], v[124:127]
    s_lshl_b32 s29, s12, 2
    s_waitcnt lgkmcnt(3)
    v_mfma_f32_16x16x32_bf16 v[128:131], v[56:59], v[76:79], v[128:131]
    ds_read_b128 v[72:75], v24 offset:17408
    v_mfma_f32_16x16x32_bf16 v[132:135], v[56:59], v[80:83], v[132:135]
    s_barrier
    s_waitcnt lgkmcnt(3)
    v_mfma_f32_16x16x32_bf16 v[136:139], v[60:63], v[76:79], v[136:139]
    ds_read_b128 v[40:43], v20 offset:36864
    v_mfma_f32_16x16x32_bf16 v[140:143], v[60:63], v[80:83], v[140:143]
    ds_read_b128 v[84:87], v35 offset:36864
    s_waitcnt lgkmcnt(4)
    v_mfma_f32_16x16x32_bf16 v[144:147], v[64:67], v[76:79], v[144:147]
    ds_read_b128 v[44:47], v20 offset:37888
    v_mfma_f32_16x16x32_bf16 v[148:151], v[64:67], v[80:83], v[148:151]
    ds_read_b128 v[88:91], v35 offset:37888
    s_waitcnt lgkmcnt(5)
    v_mfma_f32_16x16x32_bf16 v[152:155], v[68:71], v[76:79], v[152:155]
    ds_read_b128 v[48:51], v21 offset:36864
    v_mfma_f32_16x16x32_bf16 v[156:159], v[68:71], v[80:83], v[156:159]
    s_add_u32 s29, s29, s27
    s_waitcnt lgkmcnt(5)
    v_mfma_f32_16x16x32_bf16 v[160:163], v[72:75], v[76:79], v[160:163]
    ds_read_b128 v[52:55], v21 offset:37888
    v_mfma_f32_16x16x32_bf16 v[164:167], v[72:75], v[80:83], v[164:167]
    s_mul_i32 s30, s29, 147456
    s_waitcnt lgkmcnt(2)
    v_mfma_f32_16x16x32_bf16 v[96:99], v[40:43], v[84:87], v[96:99]
    ds_read_b128 v[56:59], v22 offset:36864
    v_mfma_f32_16x16x32_bf16 v[100:103], v[40:43], v[88:91], v[100:103]
    s_mul_i32 s31, s24, 3072
    v_mfma_f32_16x16x32_bf16 v[104:107], v[44:47], v[84:87], v[104:107]
    ds_read_b128 v[60:63], v22 offset:37888
    v_mfma_f32_16x16x32_bf16 v[108:111], v[44:47], v[88:91], v[108:111]
    s_add_u32 s30, s30, s31
    s_waitcnt lgkmcnt(3)
    v_mfma_f32_16x16x32_bf16 v[112:115], v[48:51], v[84:87], v[112:115]
    ds_read_b128 v[64:67], v23 offset:36864
    v_mfma_f32_16x16x32_bf16 v[116:119], v[48:51], v[88:91], v[116:119]
    s_add_u32 s30, s30, 48984064
    s_waitcnt lgkmcnt(3)
    v_mfma_f32_16x16x32_bf16 v[120:123], v[52:55], v[84:87], v[120:123]
    ds_read_b128 v[68:71], v23 offset:37888
    v_mfma_f32_16x16x32_bf16 v[124:127], v[52:55], v[88:91], v[124:127]
    s_add_u32 s41, s26, 1
    s_waitcnt lgkmcnt(3)
    v_mfma_f32_16x16x32_bf16 v[128:131], v[56:59], v[84:87], v[128:131]
    ds_read_b128 v[72:75], v24 offset:36864
    v_mfma_f32_16x16x32_bf16 v[132:135], v[56:59], v[88:91], v[132:135]
    s_barrier
    s_waitcnt lgkmcnt(3)
    v_mfma_f32_16x16x32_bf16 v[136:139], v[60:63], v[84:87], v[136:139]
    ds_read_b128 v[40:43], v20 offset:54272
    v_mfma_f32_16x16x32_bf16 v[140:143], v[60:63], v[88:91], v[140:143]
    ds_read_b128 v[76:79], v35 offset:54272
    s_waitcnt lgkmcnt(4)
    v_mfma_f32_16x16x32_bf16 v[144:147], v[64:67], v[84:87], v[144:147]
    ds_read_b128 v[44:47], v20 offset:55296
    v_mfma_f32_16x16x32_bf16 v[148:151], v[64:67], v[88:91], v[148:151]
    ds_read_b128 v[80:83], v35 offset:55296
    s_waitcnt lgkmcnt(5)
    v_mfma_f32_16x16x32_bf16 v[152:155], v[68:71], v[84:87], v[152:155]
    ds_read_b128 v[48:51], v21 offset:54272
    v_mfma_f32_16x16x32_bf16 v[156:159], v[68:71], v[88:91], v[156:159]
    s_and_b32 s41, s41, 3
    s_waitcnt lgkmcnt(5)
    v_mfma_f32_16x16x32_bf16 v[160:163], v[72:75], v[84:87], v[160:163]
    ds_read_b128 v[52:55], v21 offset:55296
    v_mfma_f32_16x16x32_bf16 v[164:167], v[72:75], v[88:91], v[164:167]
    s_mul_i32 s41, s41, 36864
    s_waitcnt lgkmcnt(2)
    v_mfma_f32_16x16x32_bf16 v[96:99], v[40:43], v[76:79], v[96:99]
    ds_read_b128 v[56:59], v22 offset:54272
    v_mfma_f32_16x16x32_bf16 v[100:103], v[40:43], v[80:83], v[100:103]
    s_add_u32 s41, s41, s30
    v_mfma_f32_16x16x32_bf16 v[104:107], v[44:47], v[76:79], v[104:107]
    ds_read_b128 v[60:63], v22 offset:55296
    v_mfma_f32_16x16x32_bf16 v[108:111], v[44:47], v[80:83], v[108:111]
    s_add_u32 s41, s41, 0
    s_waitcnt lgkmcnt(3)
    v_mfma_f32_16x16x32_bf16 v[112:115], v[48:51], v[76:79], v[112:115]
    ds_read_b128 v[64:67], v23 offset:54272
    v_mfma_f32_16x16x32_bf16 v[116:119], v[48:51], v[80:83], v[116:119]
    s_add_u32 s42, s26, 2
    s_waitcnt lgkmcnt(3)
    v_mfma_f32_16x16x32_bf16 v[120:123], v[52:55], v[76:79], v[120:123]
    ds_read_b128 v[68:71], v23 offset:55296
    v_mfma_f32_16x16x32_bf16 v[124:127], v[52:55], v[80:83], v[124:127]
    s_and_b32 s42, s42, 3
    s_waitcnt lgkmcnt(3)
    v_mfma_f32_16x16x32_bf16 v[128:131], v[56:59], v[76:79], v[128:131]
    ds_read_b128 v[72:75], v24 offset:54272
    v_mfma_f32_16x16x32_bf16 v[132:135], v[56:59], v[80:83], v[132:135]
    s_barrier
    s_waitcnt lgkmcnt(3)
    v_mfma_f32_16x16x32_bf16 v[136:139], v[60:63], v[76:79], v[136:139]
    ds_read_b128 v[40:43], v25 offset:6144
    v_mfma_f32_16x16x32_bf16 v[140:143], v[60:63], v[80:83], v[140:143]
    ds_read_b128 v[84:87], v36 offset:6144
    s_waitcnt lgkmcnt(4)
    v_mfma_f32_16x16x32_bf16 v[144:147], v[64:67], v[76:79], v[144:147]
    ds_read_b128 v[44:47], v25 offset:7168
    v_mfma_f32_16x16x32_bf16 v[148:151], v[64:67], v[80:83], v[148:151]
    ds_read_b128 v[88:91], v36 offset:7168
    s_waitcnt lgkmcnt(5)
    v_mfma_f32_16x16x32_bf16 v[152:155], v[68:71], v[76:79], v[152:155]
    ds_read_b128 v[48:51], v26 offset:6144
    v_mfma_f32_16x16x32_bf16 v[156:159], v[68:71], v[80:83], v[156:159]
    s_mul_i32 s42, s42, 36864
    s_waitcnt lgkmcnt(5)
    v_mfma_f32_16x16x32_bf16 v[160:163], v[72:75], v[76:79], v[160:163]
    ds_read_b128 v[52:55], v26 offset:7168
    v_mfma_f32_16x16x32_bf16 v[164:167], v[72:75], v[80:83], v[164:167]
    s_add_u32 s42, s42, s30
    s_waitcnt lgkmcnt(2)
    v_mfma_f32_16x16x32_bf16 v[96:99], v[40:43], v[84:87], v[96:99]
    ds_read_b128 v[56:59], v27 offset:6144
    v_mfma_f32_16x16x32_bf16 v[100:103], v[40:43], v[88:91], v[100:103]
    s_add_u32 s42, s42, 12288
    v_mfma_f32_16x16x32_bf16 v[104:107], v[44:47], v[84:87], v[104:107]
    ds_read_b128 v[60:63], v27 offset:7168
    v_mfma_f32_16x16x32_bf16 v[108:111], v[44:47], v[88:91], v[108:111]
    s_add_u32 s43, s26, 3
    s_waitcnt lgkmcnt(3)
    v_mfma_f32_16x16x32_bf16 v[112:115], v[48:51], v[84:87], v[112:115]
    ds_read_b128 v[64:67], v28 offset:6144
    v_mfma_f32_16x16x32_bf16 v[116:119], v[48:51], v[88:91], v[116:119]
    s_and_b32 s43, s43, 3
    s_waitcnt lgkmcnt(3)
    v_mfma_f32_16x16x32_bf16 v[120:123], v[52:55], v[84:87], v[120:123]
    ds_read_b128 v[68:71], v28 offset:7168
    v_mfma_f32_16x16x32_bf16 v[124:127], v[52:55], v[88:91], v[124:127]
    s_mul_i32 s43, s43, 36864
    s_waitcnt lgkmcnt(3)
    v_mfma_f32_16x16x32_bf16 v[128:131], v[56:59], v[84:87], v[128:131]
    ds_read_b128 v[72:75], v29 offset:6144
    v_mfma_f32_16x16x32_bf16 v[132:135], v[56:59], v[88:91], v[132:135]
    s_barrier
    s_waitcnt lgkmcnt(3)
    v_mfma_f32_16x16x32_bf16 v[136:139], v[60:63], v[84:87], v[136:139]
    ds_read_b128 v[40:43], v25 offset:23552
    v_mfma_f32_16x16x32_bf16 v[140:143], v[60:63], v[88:91], v[140:143]
    ds_read_b128 v[76:79], v36 offset:23552
    s_waitcnt lgkmcnt(4)
    v_mfma_f32_16x16x32_bf16 v[144:147], v[64:67], v[84:87], v[144:147]
    ds_read_b128 v[44:47], v25 offset:24576
    v_mfma_f32_16x16x32_bf16 v[148:151], v[64:67], v[88:91], v[148:151]
    ds_read_b128 v[80:83], v36 offset:24576
    s_waitcnt lgkmcnt(5)
    v_mfma_f32_16x16x32_bf16 v[152:155], v[68:71], v[84:87], v[152:155]
    ds_read_b128 v[48:51], v26 offset:23552
    v_mfma_f32_16x16x32_bf16 v[156:159], v[68:71], v[88:91], v[156:159]
    s_add_u32 s43, s43, s30
    s_waitcnt lgkmcnt(5)
    v_mfma_f32_16x16x32_bf16 v[160:163], v[72:75], v[84:87], v[160:163]
    ds_read_b128 v[52:55], v26 offset:24576
    v_mfma_f32_16x16x32_bf16 v[164:167], v[72:75], v[88:91], v[164:167]
    s_add_u32 s43, s43, 24576
    s_waitcnt lgkmcnt(2)
    v_mfma_f32_16x16x32_bf16 v[96:99], v[40:43], v[76:79], v[96:99]
    ds_read_b128 v[56:59], v27 offset:23552
    v_mfma_f32_16x16x32_bf16 v[100:103], v[40:43], v[80:83], v[100:103]
    s_sub_u32 s44, s24, s26
    v_mfma_f32_16x16x32_bf16 v[104:107], v[44:47], v[76:79], v[104:107]
    ds_read_b128 v[60:63], v27 offset:24576
    v_mfma_f32_16x16x32_bf16 v[108:111], v[44:47], v[80:83], v[108:111]
    s_and_b32 s44, s44, 3
    s_waitcnt lgkmcnt(3)
    v_mfma_f32_16x16x32_bf16 v[112:115], v[48:51], v[76:79], v[112:115]
    ds_read_b128 v[64:67], v28 offset:23552
    v_mfma_f32_16x16x32_bf16 v[116:119], v[48:51], v[80:83], v[116:119]
    s_mul_i32 s44, s44, 12288
    s_waitcnt lgkmcnt(3)
    v_mfma_f32_16x16x32_bf16 v[120:123], v[52:55], v[76:79], v[120:123]
    ds_read_b128 v[68:71], v28 offset:24576
    v_mfma_f32_16x16x32_bf16 v[124:127], v[52:55], v[80:83], v[124:127]
    s_mul_i32 s32, s24, 36864
    s_waitcnt lgkmcnt(3)
    v_mfma_f32_16x16x32_bf16 v[128:131], v[56:59], v[76:79], v[128:131]
    ds_read_b128 v[72:75], v29 offset:23552
    v_mfma_f32_16x16x32_bf16 v[132:135], v[56:59], v[80:83], v[132:135]
    s_barrier
    s_waitcnt lgkmcnt(3)
    v_mfma_f32_16x16x32_bf16 v[136:139], v[60:63], v[76:79], v[136:139]
    ds_read_b128 v[40:43], v25 offset:40960
    v_mfma_f32_16x16x32_bf16 v[140:143], v[60:63], v[80:83], v[140:143]
    ds_read_b128 v[84:87], v36 offset:40960
    s_waitcnt lgkmcnt(4)
    v_mfma_f32_16x16x32_bf16 v[144:147], v[64:67], v[76:79], v[144:147]
    ds_read_b128 v[44:47], v25 offset:41984
    v_mfma_f32_16x16x32_bf16 v[148:151], v[64:67], v[80:83], v[148:151]
    ds_read_b128 v[88:91], v36 offset:41984
    s_waitcnt lgkmcnt(5)
    v_mfma_f32_16x16x32_bf16 v[152:155], v[68:71], v[76:79], v[152:155]
    ds_read_b128 v[48:51], v26 offset:40960
    v_mfma_f32_16x16x32_bf16 v[156:159], v[68:71], v[80:83], v[156:159]
    s_add_u32 s44, s44, s32
    s_waitcnt lgkmcnt(5)
    v_mfma_f32_16x16x32_bf16 v[160:163], v[72:75], v[76:79], v[160:163]
    ds_read_b128 v[52:55], v26 offset:41984
    v_mfma_f32_16x16x32_bf16 v[164:167], v[72:75], v[80:83], v[164:167]
    s_add_u32 s44, s44, s30
    s_waitcnt lgkmcnt(2)
    v_mfma_f32_16x16x32_bf16 v[96:99], v[40:43], v[84:87], v[96:99]
    ds_read_b128 v[56:59], v27 offset:40960
    v_mfma_f32_16x16x32_bf16 v[100:103], v[40:43], v[88:91], v[100:103]
    s_sub_u32 s44, s44, 12288
    v_mfma_f32_16x16x32_bf16 v[104:107], v[44:47], v[84:87], v[104:107]
    ds_read_b128 v[60:63], v27 offset:41984
    v_mfma_f32_16x16x32_bf16 v[108:111], v[44:47], v[88:91], v[108:111]
    v_min_u32 v10, 2, v1
    s_waitcnt lgkmcnt(3)
    v_mfma_f32_16x16x32_bf16 v[112:115], v[48:51], v[84:87], v[112:115]
    ds_read_b128 v[64:67], v28 offset:40960
    v_mfma_f32_16x16x32_bf16 v[116:119], v[48:51], v[88:91], v[116:119]
    v_add3_u32 v10, v10, s26, 1
    s_waitcnt lgkmcnt(3)
    v_mfma_f32_16x16x32_bf16 v[120:123], v[52:55], v[84:87], v[120:123]
    ds_read_b128 v[68:71], v28 offset:41984
    v_mfma_f32_16x16x32_bf16 v[124:127], v[52:55], v[88:91], v[124:127]
    v_and_b32 v10, 3, v10
    s_waitcnt lgkmcnt(3)
    v_mfma_f32_16x16x32_bf16 v[128:131], v[56:59], v[84:87], v[128:131]
    ds_read_b128 v[72:75], v29 offset:40960
    v_mfma_f32_16x16x32_bf16 v[132:135], v[56:59], v[88:91], v[132:135]
    s_barrier
    s_waitcnt lgkmcnt(3)
    v_mfma_f32_16x16x32_bf16 v[136:139], v[60:63], v[84:87], v[136:139]
    ds_read_b128 v[40:43], v25 offset:58368
    v_mfma_f32_16x16x32_bf16 v[140:143], v[60:63], v[88:91], v[140:143]
    ds_read_b128 v[76:79], v36 offset:58368
    s_waitcnt lgkmcnt(4)
    v_mfma_f32_16x16x32_bf16 v[144:147], v[64:67], v[84:87], v[144:147]
    ds_read_b128 v[44:47], v25 offset:59392
    v_mfma_f32_16x16x32_bf16 v[148:151], v[64:67], v[88:91], v[148:151]
    ds_read_b128 v[80:83], v36 offset:59392
    s_waitcnt lgkmcnt(5)
    v_mfma_f32_16x16x32_bf16 v[152:155], v[68:71], v[84:87], v[152:155]
    ds_read_b128 v[48:51], v26 offset:58368
    v_mfma_f32_16x16x32_bf16 v[156:159], v[68:71], v[88:91], v[156:159]
    s_andn2_b32 s31, s2, 3
    s_waitcnt lgkmcnt(5)
    v_mfma_f32_16x16x32_bf16 v[160:163], v[72:75], v[84:87], v[160:163]
    ds_read_b128 v[52:55], v26 offset:59392
    v_mfma_f32_16x16x32_bf16 v[164:167], v[72:75], v[88:91], v[164:167]
    v_add_u32 v10, s31, v10
    s_waitcnt lgkmcnt(2)
    v_mfma_f32_16x16x32_bf16 v[96:99], v[40:43], v[76:79], v[96:99]
    ds_read_b128 v[56:59], v27 offset:58368
    v_mfma_f32_16x16x32_bf16 v[100:103], v[40:43], v[80:83], v[100:103]
    v_lshlrev_b32 v10, 11, v10
    v_mfma_f32_16x16x32_bf16 v[104:107], v[44:47], v[76:79], v[104:107]
    ds_read_b128 v[60:63], v27 offset:59392
    v_mfma_f32_16x16x32_bf16 v[108:111], v[44:47], v[80:83], v[108:111]
    s_add_u32 s45, s24, 4
    s_waitcnt lgkmcnt(3)
    v_mfma_f32_16x16x32_bf16 v[112:115], v[48:51], v[76:79], v[112:115]
    ds_read_b128 v[64:67], v28 offset:58368
    v_mfma_f32_16x16x32_bf16 v[116:119], v[48:51], v[80:83], v[116:119]
    s_lshl_b32 s31, s45, 8
    s_waitcnt lgkmcnt(3)
    v_mfma_f32_16x16x32_bf16 v[120:123], v[52:55], v[76:79], v[120:123]
    ds_read_b128 v[68:71], v28 offset:59392
    v_mfma_f32_16x16x32_bf16 v[124:127], v[52:55], v[80:83], v[124:127]
    s_add_u32 s31, s31, 32896
    s_waitcnt lgkmcnt(3)
    v_mfma_f32_16x16x32_bf16 v[128:131], v[56:59], v[76:79], v[128:131]
    ds_read_b128 v[72:75], v29 offset:58368
    v_mfma_f32_16x16x32_bf16 v[132:135], v[56:59], v[80:83], v[132:135]
    s_barrier
    s_waitcnt lgkmcnt(3)
    v_mfma_f32_16x16x32_bf16 v[136:139], v[60:63], v[76:79], v[136:139]
    ds_read_b128 v[40:43], v30 offset:10240
    v_mfma_f32_16x16x32_bf16 v[140:143], v[60:63], v[80:83], v[140:143]
    ds_read_b128 v[84:87], v37 offset:10240
    s_waitcnt lgkmcnt(4)
    v_mfma_f32_16x16x32_bf16 v[144:147], v[64:67], v[76:79], v[144:147]
    ds_read_b128 v[44:47], v30 offset:11264
    v_mfma_f32_16x16x32_bf16 v[148:151], v[64:67], v[80:83], v[148:151]
    ds_read_b128 v[88:91], v37 offset:11264
    s_waitcnt lgkmcnt(5)
    v_mfma_f32_16x16x32_bf16 v[152:155], v[68:71], v[76:79], v[152:155]
    ds_read_b128 v[48:51], v31 offset:10240
    v_mfma_f32_16x16x32_bf16 v[156:159], v[68:71], v[80:83], v[156:159]
    v_add_u32 v10, s31, v10
    s_waitcnt lgkmcnt(5)
    v_mfma_f32_16x16x32_bf16 v[160:163], v[72:75], v[76:79], v[160:163]
    ds_read_b128 v[52:55], v31 offset:11264
    v_mfma_f32_16x16x32_bf16 v[164:167], v[72:75], v[80:83], v[164:167]
    v_mov_b32 v12, v15
    s_waitcnt lgkmcnt(2)
    v_mfma_f32_16x16x32_bf16 v[96:99], v[40:43], v[84:87], v[96:99]
    ds_read_b128 v[56:59], v32 offset:10240
    v_mfma_f32_16x16x32_bf16 v[100:103], v[40:43], v[88:91], v[100:103]
    v_mov_b32 v13, v15
    v_mfma_f32_16x16x32_bf16 v[104:107], v[44:47], v[84:87], v[104:107]
    ds_read_b128 v[60:63], v32 offset:11264
    v_mfma_f32_16x16x32_bf16 v[108:111], v[44:47], v[88:91], v[108:111]
    s_mul_i32 s33, s26, 36864
    s_waitcnt lgkmcnt(3)
    v_mfma_f32_16x16x32_bf16 v[112:115], v[48:51], v[84:87], v[112:115]
    ds_read_b128 v[64:67], v33 offset:10240
    v_mfma_f32_16x16x32_bf16 v[116:119], v[48:51], v[88:91], v[116:119]
    s_add_u32 s33, s33, s30
    s_waitcnt lgkmcnt(3)
    v_mfma_f32_16x16x32_bf16 v[120:123], v[52:55], v[84:87], v[120:123]
    ds_read_b128 v[68:71], v33 offset:11264
    v_mfma_f32_16x16x32_bf16 v[124:127], v[52:55], v[88:91], v[124:127]
    v_permlane16_swap_b32 v12, v13
    s_waitcnt lgkmcnt(3)
    v_mfma_f32_16x16x32_bf16 v[128:131], v[56:59], v[84:87], v[128:131]
    ds_read_b128 v[72:75], v34 offset:10240
    v_mfma_f32_16x16x32_bf16 v[132:135], v[56:59], v[88:91], v[132:135]
    s_barrier
    s_waitcnt lgkmcnt(3)
    v_mfma_f32_16x16x32_bf16 v[136:139], v[60:63], v[84:87], v[136:139]
    ds_read_b128 v[40:43], v20 offset:0
    v_mfma_f32_16x16x32_bf16 v[140:143], v[60:63], v[88:91], v[140:143]
    ds_read_b128 v[76:79], v35 offset:0
    s_waitcnt lgkmcnt(4)
    v_mfma_f32_16x16x32_bf16 v[144:147], v[64:67], v[84:87], v[144:147]
    ds_read_b128 v[44:47], v20 offset:1024
    v_mfma_f32_16x16x32_bf16 v[148:151], v[64:67], v[88:91], v[148:151]
    ds_read_b128 v[80:83], v35 offset:1024
    s_waitcnt lgkmcnt(5)
    v_mfma_f32_16x16x32_bf16 v[152:155], v[68:71], v[84:87], v[152:155]
    ds_read_b128 v[48:51], v21 offset:0
    v_mfma_f32_16x16x32_bf16 v[156:159], v[68:71], v[88:91], v[156:159]
    s_mov_b32 s34, 0x00003f80
    s_waitcnt lgkmcnt(5)
    v_mfma_f32_16x16x32_bf16 v[160:163], v[72:75], v[84:87], v[160:163]
    ds_read_b128 v[52:55], v21 offset:1024
    v_mfma_f32_16x16x32_bf16 v[164:167], v[72:75], v[88:91], v[164:167]
    s_mov_b32 s35, 0x3f800000
    s_waitcnt lgkmcnt(2)
    v_mfma_f32_16x16x32_bf16 v[96:99], v[40:43], v[76:79], v[96:99]
    ds_read_b128 v[56:59], v22 offset:0
    v_mfma_f32_16x16x32_bf16 v[100:103], v[40:43], v[80:83], v[100:103]
    s_add_u32 s31, s33, 12288
    v_mfma_f32_16x16x32_bf16 v[104:107], v[44:47], v[76:79], v[104:107]
    ds_read_b128 v[60:63], v22 offset:1024
    v_mfma_f32_16x16x32_bf16 v[108:111], v[44:47], v[80:83], v[108:111]
    s_add_u32 s32, s33, 24576
    s_waitcnt lgkmcnt(3)
    v_mfma_f32_16x16x32_bf16 v[112:115], v[48:51], v[76:79], v[112:115]
    ds_read_b128 v[64:67], v23 offset:0
    v_mfma_f32_16x16x32_bf16 v[116:119], v[48:51], v[80:83], v[116:119]
    v_and_b32 v4, 31, v1
    s_waitcnt lgkmcnt(3)
    v_mfma_f32_16x16x32_bf16 v[120:123], v[52:55], v[76:79], v[120:123]
    ds_read_b128 v[68:71], v23 offset:1024
    v_mfma_f32_16x16x32_bf16 v[124:127], v[52:55], v[80:83], v[124:127]
    v_mul_u32_u24 v14, 1152, v4
    s_waitcnt lgkmcnt(3)
    v_mfma_f32_16x16x32_bf16 v[128:131], v[56:59], v[76:79], v[128:131]
    ds_read_b128 v[72:75], v24 offset:0
    v_mfma_f32_16x16x32_bf16 v[132:135], v[56:59], v[80:83], v[132:135]
    s_barrier
    s_waitcnt lgkmcnt(3)
    v_mfma_f32_16x16x32_bf16 v[136:139], v[60:63], v[76:79], v[136:139]
    ds_read_b128 v[40:43], v20 offset:17408
    v_mfma_f32_16x16x32_bf16 v[140:143], v[60:63], v[80:83], v[140:143]
    ds_read_b128 v[84:87], v35 offset:17408
    s_waitcnt lgkmcnt(4)
    v_mfma_f32_16x16x32_bf16 v[144:147], v[64:67], v[76:79], v[144:147]
    ds_read_b128 v[44:47], v20 offset:18432
    v_mfma_f32_16x16x32_bf16 v[148:151], v[64:67], v[80:83], v[148:151]
    ds_read_b128 v[88:91], v35 offset:18432
    s_waitcnt lgkmcnt(5)
    v_mfma_f32_16x16x32_bf16 v[152:155], v[68:71], v[76:79], v[152:155]
    ds_read_b128 v[48:51], v21 offset:17408
    v_mfma_f32_16x16x32_bf16 v[156:159], v[68:71], v[80:83], v[156:159]
    v_lshrrev_b32 v5, 5, v1
    s_waitcnt lgkmcnt(5)
    v_mfma_f32_16x16x32_bf16 v[160:163], v[72:75], v[76:79], v[160:163]
    ds_read_b128 v[52:55], v21 offset:18432
    v_mfma_f32_16x16x32_bf16 v[164:167], v[72:75], v[80:83], v[164:167]
    v_lshl_add_u32 v14, v5, 4, v14
    s_waitcnt lgkmcnt(2)
    v_mfma_f32_16x16x32_bf16 v[96:99], v[40:43], v[84:87], v[96:99]
    ds_read_b128 v[56:59], v22 offset:17408
    v_mfma_f32_16x16x32_bf16 v[100:103], v[40:43], v[88:91], v[100:103]
    s_mul_i32 s16, s16, 36864
    v_mfma_f32_16x16x32_bf16 v[104:107], v[44:47], v[84:87], v[104:107]
    ds_read_b128 v[60:63], v22 offset:18432
    v_mfma_f32_16x16x32_bf16 v[108:111], v[44:47], v[88:91], v[108:111]
    s_lshl_b32 s19, s19, 5
    s_waitcnt lgkmcnt(3)
    v_mfma_f32_16x16x32_bf16 v[112:115], v[48:51], v[84:87], v[112:115]
    ds_read_b128 v[64:67], v23 offset:17408
    v_mfma_f32_16x16x32_bf16 v[116:119], v[48:51], v[88:91], v[116:119]
    s_add_u32 s19, s19, s16
    s_waitcnt lgkmcnt(3)
    v_mfma_f32_16x16x32_bf16 v[120:123], v[52:55], v[84:87], v[120:123]
    ds_read_b128 v[68:71], v23 offset:18432
    v_mfma_f32_16x16x32_bf16 v[124:127], v[52:55], v[88:91], v[124:127]
    s_lshl_b32 s18, s18, 5
    s_waitcnt lgkmcnt(3)
    v_mfma_f32_16x16x32_bf16 v[128:131], v[56:59], v[84:87], v[128:131]
    ds_read_b128 v[72:75], v24 offset:17408
    v_mfma_f32_16x16x32_bf16 v[132:135], v[56:59], v[88:91], v[132:135]
    s_barrier
    s_waitcnt lgkmcnt(3)
    v_mfma_f32_16x16x32_bf16 v[136:139], v[60:63], v[84:87], v[136:139]
    ds_read_b128 v[40:43], v20 offset:36864
    v_mfma_f32_16x16x32_bf16 v[140:143], v[60:63], v[88:91], v[140:143]
    ds_read_b128 v[76:79], v35 offset:36864
    s_waitcnt lgkmcnt(4)
    v_mfma_f32_16x16x32_bf16 v[144:147], v[64:67], v[84:87], v[144:147]
    ds_read_b128 v[44:47], v20 offset:37888
    v_mfma_f32_16x16x32_bf16 v[148:151], v[64:67], v[88:91], v[148:151]
    ds_read_b128 v[80:83], v35 offset:37888
    s_waitcnt lgkmcnt(5)
    v_mfma_f32_16x16x32_bf16 v[152:155], v[68:71], v[84:87], v[152:155]
    ds_read_b128 v[48:51], v21 offset:36864
    v_mfma_f32_16x16x32_bf16 v[156:159], v[68:71], v[88:91], v[156:159]
    s_add_u32 s18, s18, s16
    s_waitcnt lgkmcnt(5)
    v_mfma_f32_16x16x32_bf16 v[160:163], v[72:75], v[84:87], v[160:163]
    ds_read_b128 v[52:55], v21 offset:37888
    v_mfma_f32_16x16x32_bf16 v[164:167], v[72:75], v[88:91], v[164:167]
    s_mov_b32 s48, s6
    s_waitcnt lgkmcnt(2)
    v_mfma_f32_16x16x32_bf16 v[96:99], v[40:43], v[76:79], v[96:99]
    ds_read_b128 v[56:59], v22 offset:36864
    v_mfma_f32_16x16x32_bf16 v[100:103], v[40:43], v[80:83], v[100:103]
    s_mov_b32 s49, s7
    v_mfma_f32_16x16x32_bf16 v[104:107], v[44:47], v[76:79], v[104:107]
    ds_read_b128 v[60:63], v22 offset:37888
    v_mfma_f32_16x16x32_bf16 v[108:111], v[44:47], v[80:83], v[108:111]
    s_mov_b32 s50, 2359296
    s_waitcnt lgkmcnt(3)
    v_mfma_f32_16x16x32_bf16 v[112:115], v[48:51], v[76:79], v[112:115]
    ds_read_b128 v[64:67], v23 offset:36864
    v_mfma_f32_16x16x32_bf16 v[116:119], v[48:51], v[80:83], v[116:119]
    s_mov_b32 s51, 0x00020000
    s_waitcnt lgkmcnt(3)
    v_mfma_f32_16x16x32_bf16 v[120:123], v[52:55], v[76:79], v[120:123]
    ds_read_b128 v[68:71], v23 offset:37888
    v_mfma_f32_16x16x32_bf16 v[124:127], v[52:55], v[80:83], v[124:127]
    s_waitcnt lgkmcnt(3)
    v_mfma_f32_16x16x32_bf16 v[128:131], v[56:59], v[76:79], v[128:131]
    ds_read_b128 v[72:75], v24 offset:36864
    v_mfma_f32_16x16x32_bf16 v[132:135], v[56:59], v[80:83], v[132:135]
    s_barrier
    s_waitcnt lgkmcnt(3)
    v_mfma_f32_16x16x32_bf16 v[136:139], v[60:63], v[76:79], v[136:139]
    ds_read_b128 v[40:43], v20 offset:54272
    v_mfma_f32_16x16x32_bf16 v[140:143], v[60:63], v[80:83], v[140:143]
    ds_read_b128 v[84:87], v35 offset:54272
    s_waitcnt lgkmcnt(4)
    v_mfma_f32_16x16x32_bf16 v[144:147], v[64:67], v[76:79], v[144:147]
    ds_read_b128 v[44:47], v20 offset:55296
    v_mfma_f32_16x16x32_bf16 v[148:151], v[64:67], v[80:83], v[148:151]
    ds_read_b128 v[88:91], v35 offset:55296
    s_waitcnt lgkmcnt(5)
    v_mfma_f32_16x16x32_bf16 v[152:155], v[68:71], v[76:79], v[152:155]
    ds_read_b128 v[48:51], v21 offset:54272
    v_mfma_f32_16x16x32_bf16 v[156:159], v[68:71], v[80:83], v[156:159]
    s_waitcnt lgkmcnt(5)
    v_mfma_f32_16x16x32_bf16 v[160:163], v[72:75], v[76:79], v[160:163]
    ds_read_b128 v[52:55], v21 offset:55296
    v_mfma_f32_16x16x32_bf16 v[164:167], v[72:75], v[80:83], v[164:167]
    s_waitcnt lgkmcnt(2)
    v_mfma_f32_16x16x32_bf16 v[96:99], v[40:43], v[84:87], v[96:99]
    ds_read_b128 v[56:59], v22 offset:54272
    v_mfma_f32_16x16x32_bf16 v[100:103], v[40:43], v[88:91], v[100:103]
    v_mfma_f32_16x16x32_bf16 v[104:107], v[44:47], v[84:87], v[104:107]
    ds_read_b128 v[60:63], v22 offset:55296
    v_mfma_f32_16x16x32_bf16 v[108:111], v[44:47], v[88:91], v[108:111]
    s_waitcnt lgkmcnt(3)
    v_mfma_f32_16x16x32_bf16 v[112:115], v[48:51], v[84:87], v[112:115]
    ds_read_b128 v[64:67], v23 offset:54272
    v_mfma_f32_16x16x32_bf16 v[116:119], v[48:51], v[88:91], v[116:119]
    s_waitcnt lgkmcnt(3)
    v_mfma_f32_16x16x32_bf16 v[120:123], v[52:55], v[84:87], v[120:123]
    ds_read_b128 v[68:71], v23 offset:55296
    v_mfma_f32_16x16x32_bf16 v[124:127], v[52:55], v[88:91], v[124:127]
    s_waitcnt lgkmcnt(3)
    v_mfma_f32_16x16x32_bf16 v[128:131], v[56:59], v[84:87], v[128:131]
    ds_read_b128 v[72:75], v24 offset:54272
    v_mfma_f32_16x16x32_bf16 v[132:135], v[56:59], v[88:91], v[132:135]
    s_barrier
    s_waitcnt lgkmcnt(3)
    v_mfma_f32_16x16x32_bf16 v[136:139], v[60:63], v[84:87], v[136:139]
    ds_read_b128 v[40:43], v25 offset:6144
    v_mfma_f32_16x16x32_bf16 v[140:143], v[60:63], v[88:91], v[140:143]
    ds_read_b128 v[76:79], v36 offset:6144
    s_waitcnt lgkmcnt(4)
    v_mfma_f32_16x16x32_bf16 v[144:147], v[64:67], v[84:87], v[144:147]
    ds_read_b128 v[44:47], v25 offset:7168
    v_mfma_f32_16x16x32_bf16 v[148:151], v[64:67], v[88:91], v[148:151]
    ds_read_b128 v[80:83], v36 offset:7168
    s_waitcnt lgkmcnt(5)
    v_mfma_f32_16x16x32_bf16 v[152:155], v[68:71], v[84:87], v[152:155]
    ds_read_b128 v[48:51], v26 offset:6144
    v_mfma_f32_16x16x32_bf16 v[156:159], v[68:71], v[88:91], v[156:159]
    s_waitcnt lgkmcnt(5)
    v_mfma_f32_16x16x32_bf16 v[160:163], v[72:75], v[84:87], v[160:163]
    ds_read_b128 v[52:55], v26 offset:7168
    v_mfma_f32_16x16x32_bf16 v[164:167], v[72:75], v[88:91], v[164:167]
    s_waitcnt lgkmcnt(2)
    v_mfma_f32_16x16x32_bf16 v[96:99], v[40:43], v[76:79], v[96:99]
    ds_read_b128 v[56:59], v27 offset:6144
    v_mfma_f32_16x16x32_bf16 v[100:103], v[40:43], v[80:83], v[100:103]
    v_mfma_f32_16x16x32_bf16 v[104:107], v[44:47], v[76:79], v[104:107]
    ds_read_b128 v[60:63], v27 offset:7168
    v_mfma_f32_16x16x32_bf16 v[108:111], v[44:47], v[80:83], v[108:111]
    s_waitcnt lgkmcnt(3)
    v_mfma_f32_16x16x32_bf16 v[112:115], v[48:51], v[76:79], v[112:115]
    ds_read_b128 v[64:67], v28 offset:6144
    v_mfma_f32_16x16x32_bf16 v[116:119], v[48:51], v[80:83], v[116:119]
    s_waitcnt lgkmcnt(3)
    v_mfma_f32_16x16x32_bf16 v[120:123], v[52:55], v[76:79], v[120:123]
    ds_read_b128 v[68:71], v28 offset:7168
    v_mfma_f32_16x16x32_bf16 v[124:127], v[52:55], v[80:83], v[124:127]
    s_waitcnt lgkmcnt(3)
    v_mfma_f32_16x16x32_bf16 v[128:131], v[56:59], v[76:79], v[128:131]
    ds_read_b128 v[72:75], v29 offset:6144
    v_mfma_f32_16x16x32_bf16 v[132:135], v[56:59], v[80:83], v[132:135]
    s_barrier
    s_waitcnt lgkmcnt(3)
    v_mfma_f32_16x16x32_bf16 v[136:139], v[60:63], v[76:79], v[136:139]
    ds_read_b128 v[40:43], v25 offset:23552
    v_mfma_f32_16x16x32_bf16 v[140:143], v[60:63], v[80:83], v[140:143]
    ds_read_b128 v[84:87], v36 offset:23552
    s_waitcnt lgkmcnt(4)
    v_mfma_f32_16x16x32_bf16 v[144:147], v[64:67], v[76:79], v[144:147]
    ds_read_b128 v[44:47], v25 offset:24576
    v_mfma_f32_16x16x32_bf16 v[148:151], v[64:67], v[80:83], v[148:151]
    ds_read_b128 v[88:91], v36 offset:24576
    s_waitcnt lgkmcnt(5)
    v_mfma_f32_16x16x32_bf16 v[152:155], v[68:71], v[76:79], v[152:155]
    ds_read_b128 v[48:51], v26 offset:23552
    v_mfma_f32_16x16x32_bf16 v[156:159], v[68:71], v[80:83], v[156:159]
    s_waitcnt lgkmcnt(5)
    v_mfma_f32_16x16x32_bf16 v[160:163], v[72:75], v[76:79], v[160:163]
    ds_read_b128 v[52:55], v26 offset:24576
    v_mfma_f32_16x16x32_bf16 v[164:167], v[72:75], v[80:83], v[164:167]
    s_waitcnt lgkmcnt(2)
    v_mfma_f32_16x16x32_bf16 v[96:99], v[40:43], v[84:87], v[96:99]
    ds_read_b128 v[56:59], v27 offset:23552
    v_mfma_f32_16x16x32_bf16 v[100:103], v[40:43], v[88:91], v[100:103]
    v_mfma_f32_16x16x32_bf16 v[104:107], v[44:47], v[84:87], v[104:107]
    ds_read_b128 v[60:63], v27 offset:24576
    v_mfma_f32_16x16x32_bf16 v[108:111], v[44:47], v[88:91], v[108:111]
    s_waitcnt lgkmcnt(3)
    v_mfma_f32_16x16x32_bf16 v[112:115], v[48:51], v[84:87], v[112:115]
    ds_read_b128 v[64:67], v28 offset:23552
    v_mfma_f32_16x16x32_bf16 v[116:119], v[48:51], v[88:91], v[116:119]
    s_waitcnt lgkmcnt(3)
    v_mfma_f32_16x16x32_bf16 v[120:123], v[52:55], v[84:87], v[120:123]
    ds_read_b128 v[68:71], v28 offset:24576
    v_mfma_f32_16x16x32_bf16 v[124:127], v[52:55], v[88:91], v[124:127]
    s_waitcnt lgkmcnt(3)
    v_mfma_f32_16x16x32_bf16 v[128:131], v[56:59], v[84:87], v[128:131]
    ds_read_b128 v[72:75], v29 offset:23552
    v_mfma_f32_16x16x32_bf16 v[132:135], v[56:59], v[88:91], v[132:135]
    s_barrier
    s_waitcnt lgkmcnt(3)
    v_mfma_f32_16x16x32_bf16 v[136:139], v[60:63], v[84:87], v[136:139]
    ds_read_b128 v[40:43], v25 offset:40960
    v_mfma_f32_16x16x32_bf16 v[140:143], v[60:63], v[88:91], v[140:143]
    ds_read_b128 v[76:79], v36 offset:40960
    s_waitcnt lgkmcnt(4)
    v_mfma_f32_16x16x32_bf16 v[144:147], v[64:67], v[84:87], v[144:147]
    ds_read_b128 v[44:47], v25 offset:41984
    v_mfma_f32_16x16x32_bf16 v[148:151], v[64:67], v[88:91], v[148:151]
    ds_read_b128 v[80:83], v36 offset:41984
    s_waitcnt lgkmcnt(5)
    v_mfma_f32_16x16x32_bf16 v[152:155], v[68:71], v[84:87], v[152:155]
    ds_read_b128 v[48:51], v26 offset:40960
    v_mfma_f32_16x16x32_bf16 v[156:159], v[68:71], v[88:91], v[156:159]
    s_waitcnt lgkmcnt(5)
    v_mfma_f32_16x16x32_bf16 v[160:163], v[72:75], v[84:87], v[160:163]
    ds_read_b128 v[52:55], v26 offset:41984
    v_mfma_f32_16x16x32_bf16 v[164:167], v[72:75], v[88:91], v[164:167]
    s_waitcnt lgkmcnt(2)
    v_mfma_f32_16x16x32_bf16 v[96:99], v[40:43], v[76:79], v[96:99]
    ds_read_b128 v[56:59], v27 offset:40960
    v_mfma_f32_16x16x32_bf16 v[100:103], v[40:43], v[80:83], v[100:103]
    v_mfma_f32_16x16x32_bf16 v[104:107], v[44:47], v[76:79], v[104:107]
    ds_read_b128 v[60:63], v27 offset:41984
    v_mfma_f32_16x16x32_bf16 v[108:111], v[44:47], v[80:83], v[108:111]
    s_waitcnt lgkmcnt(3)
    v_mfma_f32_16x16x32_bf16 v[112:115], v[48:51], v[76:79], v[112:115]
    ds_read_b128 v[64:67], v28 offset:40960
    v_mfma_f32_16x16x32_bf16 v[116:119], v[48:51], v[80:83], v[116:119]
    s_waitcnt lgkmcnt(3)
    v_mfma_f32_16x16x32_bf16 v[120:123], v[52:55], v[76:79], v[120:123]
    ds_read_b128 v[68:71], v28 offset:41984
    v_mfma_f32_16x16x32_bf16 v[124:127], v[52:55], v[80:83], v[124:127]
    s_waitcnt lgkmcnt(3)
    v_mfma_f32_16x16x32_bf16 v[128:131], v[56:59], v[76:79], v[128:131]
    ds_read_b128 v[72:75], v29 offset:40960
    v_mfma_f32_16x16x32_bf16 v[132:135], v[56:59], v[80:83], v[132:135]
    s_barrier
    s_waitcnt lgkmcnt(3)
    v_mfma_f32_16x16x32_bf16 v[136:139], v[60:63], v[76:79], v[136:139]
    ds_read_b128 v[40:43], v25 offset:58368
    v_mfma_f32_16x16x32_bf16 v[140:143], v[60:63], v[80:83], v[140:143]
    ds_read_b128 v[84:87], v36 offset:58368
    s_waitcnt lgkmcnt(4)
    v_mfma_f32_16x16x32_bf16 v[144:147], v[64:67], v[76:79], v[144:147]
    ds_read_b128 v[44:47], v25 offset:59392
    v_mfma_f32_16x16x32_bf16 v[148:151], v[64:67], v[80:83], v[148:151]
    ds_read_b128 v[88:91], v36 offset:59392
    s_waitcnt lgkmcnt(5)
    v_mfma_f32_16x16x32_bf16 v[152:155], v[68:71], v[76:79], v[152:155]
    ds_read_b128 v[48:51], v26 offset:58368
    v_mfma_f32_16x16x32_bf16 v[156:159], v[68:71], v[80:83], v[156:159]
    s_waitcnt lgkmcnt(5)
    v_mfma_f32_16x16x32_bf16 v[160:163], v[72:75], v[76:79], v[160:163]
    ds_read_b128 v[52:55], v26 offset:59392
    v_mfma_f32_16x16x32_bf16 v[164:167], v[72:75], v[80:83], v[164:167]
    s_waitcnt lgkmcnt(2)
    v_mfma_f32_16x16x32_bf16 v[96:99], v[40:43], v[84:87], v[96:99]
    ds_read_b128 v[56:59], v27 offset:58368
    v_mfma_f32_16x16x32_bf16 v[100:103], v[40:43], v[88:91], v[100:103]
    v_mfma_f32_16x16x32_bf16 v[104:107], v[44:47], v[84:87], v[104:107]
    ds_read_b128 v[60:63], v27 offset:59392
    v_mfma_f32_16x16x32_bf16 v[108:111], v[44:47], v[88:91], v[108:111]
    s_waitcnt lgkmcnt(3)
    v_mfma_f32_16x16x32_bf16 v[112:115], v[48:51], v[84:87], v[112:115]
    ds_read_b128 v[64:67], v28 offset:58368
    v_mfma_f32_16x16x32_bf16 v[116:119], v[48:51], v[88:91], v[116:119]
    s_waitcnt lgkmcnt(3)
    v_mfma_f32_16x16x32_bf16 v[120:123], v[52:55], v[84:87], v[120:123]
    ds_read_b128 v[68:71], v28 offset:59392
    v_mfma_f32_16x16x32_bf16 v[124:127], v[52:55], v[88:91], v[124:127]
    s_waitcnt lgkmcnt(3)
    v_mfma_f32_16x16x32_bf16 v[128:131], v[56:59], v[84:87], v[128:131]
    ds_read_b128 v[72:75], v29 offset:58368
    v_mfma_f32_16x16x32_bf16 v[132:135], v[56:59], v[88:91], v[132:135]
    s_barrier
    s_waitcnt lgkmcnt(3)
    v_mfma_f32_16x16x32_bf16 v[136:139], v[60:63], v[84:87], v[136:139]
    ds_read_b128 v[40:43], v30 offset:10240
    v_mfma_f32_16x16x32_bf16 v[140:143], v[60:63], v[88:91], v[140:143]
    ds_read_b128 v[76:79], v37 offset:10240
    s_waitcnt lgkmcnt(4)
    v_mfma_f32_16x16x32_bf16 v[144:147], v[64:67], v[84:87], v[144:147]
    ds_read_b128 v[44:47], v30 offset:11264
    v_mfma_f32_16x16x32_bf16 v[148:151], v[64:67], v[88:91], v[148:151]
    ds_read_b128 v[80:83], v37 offset:11264
    s_waitcnt lgkmcnt(5)
    v_mfma_f32_16x16x32_bf16 v[152:155], v[68:71], v[84:87], v[152:155]
    ds_read_b128 v[48:51], v31 offset:10240
    v_mfma_f32_16x16x32_bf16 v[156:159], v[68:71], v[88:91], v[156:159]
    s_waitcnt lgkmcnt(5)
    v_mfma_f32_16x16x32_bf16 v[160:163], v[72:75], v[84:87], v[160:163]
    ds_read_b128 v[52:55], v31 offset:11264
    v_mfma_f32_16x16x32_bf16 v[164:167], v[72:75], v[88:91], v[164:167]
    s_waitcnt lgkmcnt(2)
    v_mfma_f32_16x16x32_bf16 v[96:99], v[40:43], v[76:79], v[96:99]
    ds_read_b128 v[56:59], v32 offset:10240
    v_mfma_f32_16x16x32_bf16 v[100:103], v[40:43], v[80:83], v[100:103]
    v_mfma_f32_16x16x32_bf16 v[104:107], v[44:47], v[76:79], v[104:107]
    ds_read_b128 v[60:63], v32 offset:11264
    v_mfma_f32_16x16x32_bf16 v[108:111], v[44:47], v[80:83], v[108:111]
    s_waitcnt lgkmcnt(3)
    v_mfma_f32_16x16x32_bf16 v[112:115], v[48:51], v[76:79], v[112:115]
    ds_read_b128 v[64:67], v33 offset:10240
    v_mfma_f32_16x16x32_bf16 v[116:119], v[48:51], v[80:83], v[116:119]
    s_waitcnt lgkmcnt(3)
    v_mfma_f32_16x16x32_bf16 v[120:123], v[52:55], v[76:79], v[120:123]
    ds_read_b128 v[68:71], v33 offset:11264
    v_mfma_f32_16x16x32_bf16 v[124:127], v[52:55], v[80:83], v[124:127]
    s_waitcnt lgkmcnt(3)
    v_mfma_f32_16x16x32_bf16 v[128:131], v[56:59], v[76:79], v[128:131]
    ds_read_b128 v[72:75], v34 offset:10240
    v_mfma_f32_16x16x32_bf16 v[132:135], v[56:59], v[80:83], v[132:135]
    s_barrier
    s_waitcnt lgkmcnt(3)
    v_mfma_f32_16x16x32_bf16 v[136:139], v[60:63], v[76:79], v[136:139]
    ds_read_b128 v[40:43], v20 offset:0
    v_mfma_f32_16x16x32_bf16 v[140:143], v[60:63], v[80:83], v[140:143]
    ds_read_b128 v[84:87], v35 offset:0
    s_waitcnt lgkmcnt(4)
    v_mfma_f32_16x16x32_bf16 v[144:147], v[64:67], v[76:79], v[144:147]
    ds_read_b128 v[44:47], v20 offset:1024
    v_mfma_f32_16x16x32_bf16 v[148:151], v[64:67], v[80:83], v[148:151]
    ds_read_b128 v[88:91], v35 offset:1024
    s_waitcnt lgkmcnt(5)
    v_mfma_f32_16x16x32_bf16 v[152:155], v[68:71], v[76:79], v[152:155]
    ds_read_b128 v[48:51], v21 offset:0
    v_mfma_f32_16x16x32_bf16 v[156:159], v[68:71], v[80:83], v[156:159]
    s_waitcnt lgkmcnt(5)
    v_mfma_f32_16x16x32_bf16 v[160:163], v[72:75], v[76:79], v[160:163]
    ds_read_b128 v[52:55], v21 offset:1024
    v_mfma_f32_16x16x32_bf16 v[164:167], v[72:75], v[80:83], v[164:167]
    s_waitcnt lgkmcnt(2)
    v_mfma_f32_16x16x32_bf16 v[96:99], v[40:43], v[84:87], v[96:99]
    ds_read_b128 v[56:59], v22 offset:0
    v_mfma_f32_16x16x32_bf16 v[100:103], v[40:43], v[88:91], v[100:103]
    v_mfma_f32_16x16x32_bf16 v[104:107], v[44:47], v[84:87], v[104:107]
    ds_read_b128 v[60:63], v22 offset:1024
    v_mfma_f32_16x16x32_bf16 v[108:111], v[44:47], v[88:91], v[108:111]
    s_waitcnt lgkmcnt(3)
    v_mfma_f32_16x16x32_bf16 v[112:115], v[48:51], v[84:87], v[112:115]
    ds_read_b128 v[64:67], v23 offset:0
    v_mfma_f32_16x16x32_bf16 v[116:119], v[48:51], v[88:91], v[116:119]
    s_waitcnt lgkmcnt(3)
    v_mfma_f32_16x16x32_bf16 v[120:123], v[52:55], v[84:87], v[120:123]
    ds_read_b128 v[68:71], v23 offset:1024
    v_mfma_f32_16x16x32_bf16 v[124:127], v[52:55], v[88:91], v[124:127]
    s_waitcnt lgkmcnt(3)
    v_mfma_f32_16x16x32_bf16 v[128:131], v[56:59], v[84:87], v[128:131]
    ds_read_b128 v[72:75], v24 offset:0
    v_mfma_f32_16x16x32_bf16 v[132:135], v[56:59], v[88:91], v[132:135]
    s_barrier
    s_waitcnt lgkmcnt(3)
    v_mfma_f32_16x16x32_bf16 v[136:139], v[60:63], v[84:87], v[136:139]
    ds_read_b128 v[40:43], v20 offset:17408
    v_mfma_f32_16x16x32_bf16 v[140:143], v[60:63], v[88:91], v[140:143]
    ds_read_b128 v[76:79], v35 offset:17408
    s_waitcnt lgkmcnt(4)
    v_mfma_f32_16x16x32_bf16 v[144:147], v[64:67], v[84:87], v[144:147]
    ds_read_b128 v[44:47], v20 offset:18432
    v_mfma_f32_16x16x32_bf16 v[148:151], v[64:67], v[88:91], v[148:151]
    ds_read_b128 v[80:83], v35 offset:18432
    s_waitcnt lgkmcnt(5)
    v_mfma_f32_16x16x32_bf16 v[152:155], v[68:71], v[84:87], v[152:155]
    ds_read_b128 v[48:51], v21 offset:17408
    v_mfma_f32_16x16x32_bf16 v[156:159], v[68:71], v[88:91], v[156:159]
    s_waitcnt lgkmcnt(5)
    v_mfma_f32_16x16x32_bf16 v[160:163], v[72:75], v[84:87], v[160:163]
    ds_read_b128 v[52:55], v21 offset:18432
    v_mfma_f32_16x16x32_bf16 v[164:167], v[72:75], v[88:91], v[164:167]
    s_waitcnt lgkmcnt(2)
    v_mfma_f32_16x16x32_bf16 v[96:99], v[40:43], v[76:79], v[96:99]
    ds_read_b128 v[56:59], v22 offset:17408
    v_mfma_f32_16x16x32_bf16 v[100:103], v[40:43], v[80:83], v[100:103]
    v_mfma_f32_16x16x32_bf16 v[104:107], v[44:47], v[76:79], v[104:107]
    ds_read_b128 v[60:63], v22 offset:18432
    v_mfma_f32_16x16x32_bf16 v[108:111], v[44:47], v[80:83], v[108:111]
    s_waitcnt lgkmcnt(3)
    v_mfma_f32_16x16x32_bf16 v[112:115], v[48:51], v[76:79], v[112:115]
    ds_read_b128 v[64:67], v23 offset:17408
    v_mfma_f32_16x16x32_bf16 v[116:119], v[48:51], v[80:83], v[116:119]
    s_waitcnt lgkmcnt(3)
    v_mfma_f32_16x16x32_bf16 v[120:123], v[52:55], v[76:79], v[120:123]
    ds_read_b128 v[68:71], v23 offset:18432
    v_mfma_f32_16x16x32_bf16 v[124:127], v[52:55], v[80:83], v[124:127]
    s_waitcnt lgkmcnt(3)
    v_mfma_f32_16x16x32_bf16 v[128:131], v[56:59], v[76:79], v[128:131]
    ds_read_b128 v[72:75], v24 offset:17408
    v_mfma_f32_16x16x32_bf16 v[132:135], v[56:59], v[80:83], v[132:135]
    s_barrier
    s_waitcnt lgkmcnt(3)
    v_mfma_f32_16x16x32_bf16 v[136:139], v[60:63], v[76:79], v[136:139]
    ds_read_b128 v[40:43], v20 offset:36864
    v_mfma_f32_16x16x32_bf16 v[140:143], v[60:63], v[80:83], v[140:143]
    ds_read_b128 v[84:87], v35 offset:36864
    s_waitcnt lgkmcnt(4)
    v_mfma_f32_16x16x32_bf16 v[144:147], v[64:67], v[76:79], v[144:147]
    ds_read_b128 v[44:47], v20 offset:37888
    v_mfma_f32_16x16x32_bf16 v[148:151], v[64:67], v[80:83], v[148:151]
    ds_read_b128 v[88:91], v35 offset:37888
    s_waitcnt lgkmcnt(5)
    v_mfma_f32_16x16x32_bf16 v[152:155], v[68:71], v[76:79], v[152:155]
    ds_read_b128 v[48:51], v21 offset:36864
    v_mfma_f32_16x16x32_bf16 v[156:159], v[68:71], v[80:83], v[156:159]
    s_waitcnt lgkmcnt(5)
    v_mfma_f32_16x16x32_bf16 v[160:163], v[72:75], v[76:79], v[160:163]
    ds_read_b128 v[52:55], v21 offset:37888
    v_mfma_f32_16x16x32_bf16 v[164:167], v[72:75], v[80:83], v[164:167]
    s_waitcnt lgkmcnt(2)
    v_mfma_f32_16x16x32_bf16 v[96:99], v[40:43], v[84:87], v[96:99]
    ds_read_b128 v[56:59], v22 offset:36864
    v_mfma_f32_16x16x32_bf16 v[100:103], v[40:43], v[88:91], v[100:103]
    v_mfma_f32_16x16x32_bf16 v[104:107], v[44:47], v[84:87], v[104:107]
    ds_read_b128 v[60:63], v22 offset:37888
    v_mfma_f32_16x16x32_bf16 v[108:111], v[44:47], v[88:91], v[108:111]
    s_waitcnt lgkmcnt(3)
    v_mfma_f32_16x16x32_bf16 v[112:115], v[48:51], v[84:87], v[112:115]
    ds_read_b128 v[64:67], v23 offset:36864
    v_mfma_f32_16x16x32_bf16 v[116:119], v[48:51], v[88:91], v[116:119]
    s_waitcnt lgkmcnt(3)
    v_mfma_f32_16x16x32_bf16 v[120:123], v[52:55], v[84:87], v[120:123]
    ds_read_b128 v[68:71], v23 offset:37888
    v_mfma_f32_16x16x32_bf16 v[124:127], v[52:55], v[88:91], v[124:127]
    s_waitcnt lgkmcnt(3)
    v_mfma_f32_16x16x32_bf16 v[128:131], v[56:59], v[84:87], v[128:131]
    ds_read_b128 v[72:75], v24 offset:36864
    v_mfma_f32_16x16x32_bf16 v[132:135], v[56:59], v[88:91], v[132:135]
    s_barrier
    s_waitcnt lgkmcnt(3)
    v_mfma_f32_16x16x32_bf16 v[136:139], v[60:63], v[84:87], v[136:139]
    ds_read_b128 v[40:43], v20 offset:54272
    v_mfma_f32_16x16x32_bf16 v[140:143], v[60:63], v[88:91], v[140:143]
    ds_read_b128 v[76:79], v35 offset:54272
    s_waitcnt lgkmcnt(4)
    v_mfma_f32_16x16x32_bf16 v[144:147], v[64:67], v[84:87], v[144:147]
    ds_read_b128 v[44:47], v20 offset:55296
    v_mfma_f32_16x16x32_bf16 v[148:151], v[64:67], v[88:91], v[148:151]
    ds_read_b128 v[80:83], v35 offset:55296
    s_waitcnt lgkmcnt(5)
    v_mfma_f32_16x16x32_bf16 v[152:155], v[68:71], v[84:87], v[152:155]
    ds_read_b128 v[48:51], v21 offset:54272
    v_mfma_f32_16x16x32_bf16 v[156:159], v[68:71], v[88:91], v[156:159]
    s_waitcnt lgkmcnt(5)
    v_mfma_f32_16x16x32_bf16 v[160:163], v[72:75], v[84:87], v[160:163]
    ds_read_b128 v[52:55], v21 offset:55296
    v_mfma_f32_16x16x32_bf16 v[164:167], v[72:75], v[88:91], v[164:167]
    s_waitcnt lgkmcnt(2)
    v_mfma_f32_16x16x32_bf16 v[96:99], v[40:43], v[76:79], v[96:99]
    ds_read_b128 v[56:59], v22 offset:54272
    v_mfma_f32_16x16x32_bf16 v[100:103], v[40:43], v[80:83], v[100:103]
    v_mfma_f32_16x16x32_bf16 v[104:107], v[44:47], v[76:79], v[104:107]
    ds_read_b128 v[60:63], v22 offset:55296
    v_mfma_f32_16x16x32_bf16 v[108:111], v[44:47], v[80:83], v[108:111]
    s_waitcnt lgkmcnt(3)
    v_mfma_f32_16x16x32_bf16 v[112:115], v[48:51], v[76:79], v[112:115]
    ds_read_b128 v[64:67], v23 offset:54272
    v_mfma_f32_16x16x32_bf16 v[116:119], v[48:51], v[80:83], v[116:119]
    s_waitcnt lgkmcnt(3)
    v_mfma_f32_16x16x32_bf16 v[120:123], v[52:55], v[76:79], v[120:123]
    ds_read_b128 v[68:71], v23 offset:55296
    v_mfma_f32_16x16x32_bf16 v[124:127], v[52:55], v[80:83], v[124:127]
    s_waitcnt lgkmcnt(3)
    v_mfma_f32_16x16x32_bf16 v[128:131], v[56:59], v[76:79], v[128:131]
    ds_read_b128 v[72:75], v24 offset:54272
    v_mfma_f32_16x16x32_bf16 v[132:135], v[56:59], v[80:83], v[132:135]
    s_barrier
    s_waitcnt lgkmcnt(3)
    v_mfma_f32_16x16x32_bf16 v[136:139], v[60:63], v[76:79], v[136:139]
    ds_read_b128 v[40:43], v25 offset:6144
    v_mfma_f32_16x16x32_bf16 v[140:143], v[60:63], v[80:83], v[140:143]
    ds_read_b128 v[84:87], v36 offset:6144
    s_waitcnt lgkmcnt(4)
    v_mfma_f32_16x16x32_bf16 v[144:147], v[64:67], v[76:79], v[144:147]
    ds_read_b128 v[44:47], v25 offset:7168
    v_mfma_f32_16x16x32_bf16 v[148:151], v[64:67], v[80:83], v[148:151]
    ds_read_b128 v[88:91], v36 offset:7168
    s_waitcnt lgkmcnt(5)
    v_mfma_f32_16x16x32_bf16 v[152:155], v[68:71], v[76:79], v[152:155]
    ds_read_b128 v[48:51], v26 offset:6144
    v_mfma_f32_16x16x32_bf16 v[156:159], v[68:71], v[80:83], v[156:159]
    s_waitcnt lgkmcnt(5)
    v_mfma_f32_16x16x32_bf16 v[160:163], v[72:75], v[76:79], v[160:163]
    ds_read_b128 v[52:55], v26 offset:7168
    v_mfma_f32_16x16x32_bf16 v[164:167], v[72:75], v[80:83], v[164:167]
    s_waitcnt lgkmcnt(2)
    v_mfma_f32_16x16x32_bf16 v[96:99], v[40:43], v[84:87], v[96:99]
    ds_read_b128 v[56:59], v27 offset:6144
    v_mfma_f32_16x16x32_bf16 v[100:103], v[40:43], v[88:91], v[100:103]
    v_mfma_f32_16x16x32_bf16 v[104:107], v[44:47], v[84:87], v[104:107]
    ds_read_b128 v[60:63], v27 offset:7168
    v_mfma_f32_16x16x32_bf16 v[108:111], v[44:47], v[88:91], v[108:111]
    s_waitcnt lgkmcnt(3)
    v_mfma_f32_16x16x32_bf16 v[112:115], v[48:51], v[84:87], v[112:115]
    ds_read_b128 v[64:67], v28 offset:6144
    v_mfma_f32_16x16x32_bf16 v[116:119], v[48:51], v[88:91], v[116:119]
    s_waitcnt lgkmcnt(3)
    v_mfma_f32_16x16x32_bf16 v[120:123], v[52:55], v[84:87], v[120:123]
    ds_read_b128 v[68:71], v28 offset:7168
    v_mfma_f32_16x16x32_bf16 v[124:127], v[52:55], v[88:91], v[124:127]
    s_waitcnt lgkmcnt(3)
    v_mfma_f32_16x16x32_bf16 v[128:131], v[56:59], v[84:87], v[128:131]
    ds_read_b128 v[72:75], v29 offset:6144
    v_mfma_f32_16x16x32_bf16 v[132:135], v[56:59], v[88:91], v[132:135]
    s_barrier
    s_waitcnt lgkmcnt(3)
    v_mfma_f32_16x16x32_bf16 v[136:139], v[60:63], v[84:87], v[136:139]
    ds_read_b128 v[40:43], v25 offset:23552
    v_mfma_f32_16x16x32_bf16 v[140:143], v[60:63], v[88:91], v[140:143]
    ds_read_b128 v[76:79], v36 offset:23552
    s_waitcnt lgkmcnt(4)
    v_mfma_f32_16x16x32_bf16 v[144:147], v[64:67], v[84:87], v[144:147]
    ds_read_b128 v[44:47], v25 offset:24576
    v_mfma_f32_16x16x32_bf16 v[148:151], v[64:67], v[88:91], v[148:151]
    ds_read_b128 v[80:83], v36 offset:24576
    s_waitcnt lgkmcnt(5)
    v_mfma_f32_16x16x32_bf16 v[152:155], v[68:71], v[84:87], v[152:155]
    ds_read_b128 v[48:51], v26 offset:23552
    v_mfma_f32_16x16x32_bf16 v[156:159], v[68:71], v[88:91], v[156:159]
    s_waitcnt lgkmcnt(5)
    v_mfma_f32_16x16x32_bf16 v[160:163], v[72:75], v[84:87], v[160:163]
    ds_read_b128 v[52:55], v26 offset:24576
    v_mfma_f32_16x16x32_bf16 v[164:167], v[72:75], v[88:91], v[164:167]
    s_waitcnt lgkmcnt(2)
    v_mfma_f32_16x16x32_bf16 v[96:99], v[40:43], v[76:79], v[96:99]
    ds_read_b128 v[56:59], v27 offset:23552
    v_mfma_f32_16x16x32_bf16 v[100:103], v[40:43], v[80:83], v[100:103]
    v_mfma_f32_16x16x32_bf16 v[104:107], v[44:47], v[76:79], v[104:107]
    ds_read_b128 v[60:63], v27 offset:24576
    v_mfma_f32_16x16x32_bf16 v[108:111], v[44:47], v[80:83], v[108:111]
    s_waitcnt lgkmcnt(3)
    v_mfma_f32_16x16x32_bf16 v[112:115], v[48:51], v[76:79], v[112:115]
    ds_read_b128 v[64:67], v28 offset:23552
    v_mfma_f32_16x16x32_bf16 v[116:119], v[48:51], v[80:83], v[116:119]
    s_waitcnt lgkmcnt(3)
    v_mfma_f32_16x16x32_bf16 v[120:123], v[52:55], v[76:79], v[120:123]
    ds_read_b128 v[68:71], v28 offset:24576
    v_mfma_f32_16x16x32_bf16 v[124:127], v[52:55], v[80:83], v[124:127]
    s_waitcnt lgkmcnt(3)
    v_mfma_f32_16x16x32_bf16 v[128:131], v[56:59], v[76:79], v[128:131]
    ds_read_b128 v[72:75], v29 offset:23552
    v_mfma_f32_16x16x32_bf16 v[132:135], v[56:59], v[80:83], v[132:135]
    s_barrier
    s_waitcnt lgkmcnt(3)
    v_mfma_f32_16x16x32_bf16 v[136:139], v[60:63], v[76:79], v[136:139]
    ds_read_b128 v[40:43], v25 offset:40960
    v_mfma_f32_16x16x32_bf16 v[140:143], v[60:63], v[80:83], v[140:143]
    ds_read_b128 v[84:87], v36 offset:40960
    s_waitcnt lgkmcnt(4)
    v_mfma_f32_16x16x32_bf16 v[144:147], v[64:67], v[76:79], v[144:147]
    ds_read_b128 v[44:47], v25 offset:41984
    v_mfma_f32_16x16x32_bf16 v[148:151], v[64:67], v[80:83], v[148:151]
    ds_read_b128 v[88:91], v36 offset:41984
    s_waitcnt lgkmcnt(5)
    v_mfma_f32_16x16x32_bf16 v[152:155], v[68:71], v[76:79], v[152:155]
    ds_read_b128 v[48:51], v26 offset:40960
    v_mfma_f32_16x16x32_bf16 v[156:159], v[68:71], v[80:83], v[156:159]
    s_waitcnt lgkmcnt(5)
    v_mfma_f32_16x16x32_bf16 v[160:163], v[72:75], v[76:79], v[160:163]
    ds_read_b128 v[52:55], v26 offset:41984
    v_mfma_f32_16x16x32_bf16 v[164:167], v[72:75], v[80:83], v[164:167]
    s_waitcnt lgkmcnt(2)
    v_mfma_f32_16x16x32_bf16 v[96:99], v[40:43], v[84:87], v[96:99]
    ds_read_b128 v[56:59], v27 offset:40960
    v_mfma_f32_16x16x32_bf16 v[100:103], v[40:43], v[88:91], v[100:103]
    buffer_load_dwordx4 v[208:211], v3, s[8:11], s22 offen offset:0 sc1
    v_mfma_f32_16x16x32_bf16 v[104:107], v[44:47], v[84:87], v[104:107]
    ds_read_b128 v[60:63], v27 offset:41984
    v_mfma_f32_16x16x32_bf16 v[108:111], v[44:47], v[88:91], v[108:111]
    buffer_load_dwordx4 v[220:223], v3, s[8:11], s20 offen offset:0 sc1
    s_waitcnt lgkmcnt(3)
    v_mfma_f32_16x16x32_bf16 v[112:115], v[48:51], v[84:87], v[112:115]
    ds_read_b128 v[64:67], v28 offset:40960
    v_mfma_f32_16x16x32_bf16 v[116:119], v[48:51], v[88:91], v[116:119]
    buffer_load_dwordx4 v[212:215], v3, s[8:11], s22 offen offset:1024 sc1
    s_waitcnt lgkmcnt(3)
    v_mfma_f32_16x16x32_bf16 v[120:123], v[52:55], v[84:87], v[120:123]
    ds_read_b128 v[68:71], v28 offset:41984
    v_mfma_f32_16x16x32_bf16 v[124:127], v[52:55], v[88:91], v[124:127]
    buffer_load_dwordx4 v[224:227], v3, s[8:11], s20 offen offset:1024 sc1
    s_waitcnt lgkmcnt(3)
    v_mfma_f32_16x16x32_bf16 v[128:131], v[56:59], v[84:87], v[128:131]
    ds_read_b128 v[72:75], v29 offset:40960
    v_mfma_f32_16x16x32_bf16 v[132:135], v[56:59], v[88:91], v[132:135]
    s_barrier
    s_waitcnt lgkmcnt(3)
    v_mfma_f32_16x16x32_bf16 v[136:139], v[60:63], v[84:87], v[136:139]
    ds_read_b128 v[40:43], v25 offset:58368
    v_mfma_f32_16x16x32_bf16 v[140:143], v[60:63], v[88:91], v[140:143]
    ds_read_b128 v[76:79], v36 offset:58368
    s_waitcnt lgkmcnt(4)
    v_mfma_f32_16x16x32_bf16 v[144:147], v[64:67], v[84:87], v[144:147]
    ds_read_b128 v[44:47], v25 offset:59392
    v_mfma_f32_16x16x32_bf16 v[148:151], v[64:67], v[88:91], v[148:151]
    ds_read_b128 v[80:83], v36 offset:59392
    s_waitcnt lgkmcnt(5)
    v_mfma_f32_16x16x32_bf16 v[152:155], v[68:71], v[84:87], v[152:155]
    ds_read_b128 v[48:51], v26 offset:58368
    v_mfma_f32_16x16x32_bf16 v[156:159], v[68:71], v[88:91], v[156:159]
    buffer_load_dwordx4 v[216:219], v3, s[8:11], s23 offen offset:0 sc1
    s_waitcnt lgkmcnt(5)
    v_mfma_f32_16x16x32_bf16 v[160:163], v[72:75], v[84:87], v[160:163]
    ds_read_b128 v[52:55], v26 offset:59392
    v_mfma_f32_16x16x32_bf16 v[164:167], v[72:75], v[88:91], v[164:167]
    buffer_load_dwordx4 v[228:231], v3, s[8:11], s21 offen offset:0 sc1
    s_waitcnt lgkmcnt(2)
    v_mfma_f32_16x16x32_bf16 v[96:99], v[40:43], v[76:79], v[96:99]
    ds_read_b128 v[56:59], v27 offset:58368
    v_mfma_f32_16x16x32_bf16 v[100:103], v[40:43], v[80:83], v[100:103]
    v_mfma_f32_16x16x32_bf16 v[104:107], v[44:47], v[76:79], v[104:107]
    ds_read_b128 v[60:63], v27 offset:59392
    v_mfma_f32_16x16x32_bf16 v[108:111], v[44:47], v[80:83], v[108:111]
    s_waitcnt lgkmcnt(3)
    v_mfma_f32_16x16x32_bf16 v[112:115], v[48:51], v[76:79], v[112:115]
    ds_read_b128 v[64:67], v28 offset:58368
    v_mfma_f32_16x16x32_bf16 v[116:119], v[48:51], v[80:83], v[116:119]
    s_waitcnt lgkmcnt(3)
    v_mfma_f32_16x16x32_bf16 v[120:123], v[52:55], v[76:79], v[120:123]
    ds_read_b128 v[68:71], v28 offset:59392
    v_mfma_f32_16x16x32_bf16 v[124:127], v[52:55], v[80:83], v[124:127]
    s_waitcnt lgkmcnt(3)
    v_mfma_f32_16x16x32_bf16 v[128:131], v[56:59], v[76:79], v[128:131]
    ds_read_b128 v[72:75], v29 offset:58368
    v_mfma_f32_16x16x32_bf16 v[132:135], v[56:59], v[80:83], v[132:135]
    s_barrier
    s_waitcnt lgkmcnt(3)
    v_mfma_f32_16x16x32_bf16 v[136:139], v[60:63], v[76:79], v[136:139]
    ds_read_b128 v[40:43], v31 offset:10240
    v_mfma_f32_16x16x32_bf16 v[140:143], v[60:63], v[80:83], v[140:143]
    ds_read_b128 v[168:171], v37 offset:10240
    ds_read_b128 v[172:175], v37 offset:11264
    s_waitcnt lgkmcnt(5)
    v_mfma_f32_16x16x32_bf16 v[144:147], v[64:67], v[76:79], v[144:147]
    ds_read_b128 v[44:47], v31 offset:11264
    v_mfma_f32_16x16x32_bf16 v[148:151], v[64:67], v[80:83], v[148:151]
    ds_read_b128 v[176:179], v35 offset:0
    ds_read_b128 v[180:183], v35 offset:1024
    s_waitcnt lgkmcnt(7)
    v_mfma_f32_16x16x32_bf16 v[152:155], v[68:71], v[76:79], v[152:155]
    ds_read_b128 v[48:51], v21 offset:0
    v_mfma_f32_16x16x32_bf16 v[156:159], v[68:71], v[80:83], v[156:159]
    ds_read_b128 v[184:187], v35 offset:17408
    ds_read_b128 v[188:191], v35 offset:18432
    s_waitcnt lgkmcnt(9)
    v_mfma_f32_16x16x32_bf16 v[160:163], v[72:75], v[76:79], v[160:163]
    ds_read_b128 v[52:55], v21 offset:1024
    v_mfma_f32_16x16x32_bf16 v[164:167], v[72:75], v[80:83], v[164:167]
    s_waitcnt lgkmcnt(7)
    v_mfma_f32_16x16x32_bf16 v[112:115], v[40:43], v[168:171], v[112:115]
    ds_read_b128 v[56:59], v21 offset:17408
    v_mfma_f32_16x16x32_bf16 v[116:119], v[40:43], v[172:175], v[116:119]
    s_waitcnt lgkmcnt(7)
    v_mfma_f32_16x16x32_bf16 v[120:123], v[44:47], v[168:171], v[120:123]
    ds_read_b128 v[60:63], v21 offset:18432
    v_mfma_f32_16x16x32_bf16 v[124:127], v[44:47], v[172:175], v[124:127]
    s_waitcnt lgkmcnt(5)
    v_mfma_f32_16x16x32_bf16 v[112:115], v[48:51], v[176:179], v[112:115]
    ds_read_b128 v[64:67], v32 offset:10240
    v_mfma_f32_16x16x32_bf16 v[116:119], v[48:51], v[180:183], v[116:119]
    s_waitcnt lgkmcnt(3)
    v_mfma_f32_16x16x32_bf16 v[120:123], v[52:55], v[176:179], v[120:123]
    ds_read_b128 v[68:71], v32 offset:11264
    v_mfma_f32_16x16x32_bf16 v[124:127], v[52:55], v[180:183], v[124:127]
    s_waitcnt lgkmcnt(3)
    v_mfma_f32_16x16x32_bf16 v[112:115], v[56:59], v[184:187], v[112:115]
    ds_read_b128 v[72:75], v22 offset:0
    v_mfma_f32_16x16x32_bf16 v[116:119], v[56:59], v[188:191], v[116:119]
    s_waitcnt lgkmcnt(3)
    v_mfma_f32_16x16x32_bf16 v[120:123], v[60:63], v[184:187], v[120:123]
    ds_read_b128 v[40:43], v22 offset:1024
    v_mfma_f32_16x16x32_bf16 v[124:127], v[60:63], v[188:191], v[124:127]
    s_waitcnt lgkmcnt(3)
    v_mfma_f32_16x16x32_bf16 v[128:131], v[64:67], v[168:171], v[128:131]
    ds_read_b128 v[44:47], v22 offset:17408
    v_mfma_f32_16x16x32_bf16 v[132:135], v[64:67], v[172:175], v[132:135]
    s_waitcnt lgkmcnt(3)
    v_mfma_f32_16x16x32_bf16 v[136:139], v[68:71], v[168:171], v[136:139]
    ds_read_b128 v[48:51], v22 offset:18432
    v_mfma_f32_16x16x32_bf16 v[140:143], v[68:71], v[172:175], v[140:143]
    v_cvt_pk_bf16_f32 v84, v112, v113
    s_waitcnt lgkmcnt(3)
    v_mfma_f32_16x16x32_bf16 v[128:131], v[72:75], v[176:179], v[128:131]
    ds_read_b128 v[52:55], v33 offset:10240
    v_cvt_pk_bf16_f32 v85, v114, v115
    v_mfma_f32_16x16x32_bf16 v[132:135], v[72:75], v[180:183], v[132:135]
    v_cvt_pk_bf16_f32 v86, v116, v117
    s_waitcnt lgkmcnt(3)
    v_mfma_f32_16x16x32_bf16 v[136:139], v[40:43], v[176:179], v[136:139]
    ds_read_b128 v[56:59], v33 offset:11264
    v_cvt_pk_bf16_f32 v87, v118, v119
    v_mfma_f32_16x16x32_bf16 v[140:143], v[40:43], v[180:183], v[140:143]
    buffer_store_dwordx4 v[84:87], v3, s[8:11], s41 offen offset:0 sc1
    s_waitcnt lgkmcnt(3)
    v_mfma_f32_16x16x32_bf16 v[128:131], v[44:47], v[184:187], v[128:131]
    ds_read_b128 v[60:63], v23 offset:0
    v_cvt_pk_bf16_f32 v88, v120, v121
    v_mfma_f32_16x16x32_bf16 v[132:135], v[44:47], v[188:191], v[132:135]
    v_cvt_pk_bf16_f32 v89, v122, v123
    s_waitcnt lgkmcnt(3)
    v_mfma_f32_16x16x32_bf16 v[136:139], v[48:51], v[184:187], v[136:139]
    ds_read_b128 v[64:67], v23 offset:1024
    v_cvt_pk_bf16_f32 v90, v124, v125
    v_mfma_f32_16x16x32_bf16 v[140:143], v[48:51], v[188:191], v[140:143]
    v_cvt_pk_bf16_f32 v91, v126, v127
    s_waitcnt lgkmcnt(3)
    v_mfma_f32_16x16x32_bf16 v[144:147], v[52:55], v[168:171], v[144:147]
    ds_read_b128 v[68:71], v23 offset:17408
    buffer_store_dwordx4 v[88:91], v3, s[8:11], s41 offen offset:1024 sc1
    v_mfma_f32_16x16x32_bf16 v[148:151], v[52:55], v[172:175], v[148:151]
    v_cvt_pk_bf16_f32 v76, v128, v129
    s_waitcnt lgkmcnt(3)
    v_mfma_f32_16x16x32_bf16 v[152:155], v[56:59], v[168:171], v[152:155]
    ds_read_b128 v[72:75], v23 offset:18432
    v_cvt_pk_bf16_f32 v77, v130, v131
    v_mfma_f32_16x16x32_bf16 v[156:159], v[56:59], v[172:175], v[156:159]
    v_cvt_pk_bf16_f32 v78, v132, v133
    s_waitcnt lgkmcnt(3)
    v_mfma_f32_16x16x32_bf16 v[144:147], v[60:63], v[176:179], v[144:147]
    ds_read_b128 v[40:43], v34 offset:10240
    v_cvt_pk_bf16_f32 v79, v134, v135
    v_mfma_f32_16x16x32_bf16 v[148:151], v[60:63], v[180:183], v[148:151]
    buffer_store_dwordx4 v[76:79], v3, s[8:11], s42 offen offset:0 sc1
    s_waitcnt lgkmcnt(3)
    v_mfma_f32_16x16x32_bf16 v[152:155], v[64:67], v[176:179], v[152:155]
    ds_read_b128 v[44:47], v24 offset:0
    v_cvt_pk_bf16_f32 v80, v136, v137
    v_mfma_f32_16x16x32_bf16 v[156:159], v[64:67], v[180:183], v[156:159]
    v_cvt_pk_bf16_f32 v81, v138, v139
    s_waitcnt lgkmcnt(3)
    v_mfma_f32_16x16x32_bf16 v[144:147], v[68:71], v[184:187], v[144:147]
    ds_read_b128 v[48:51], v24 offset:17408
    v_cvt_pk_bf16_f32 v82, v140, v141
    v_mfma_f32_16x16x32_bf16 v[148:151], v[68:71], v[188:191], v[148:151]
    v_cvt_pk_bf16_f32 v83, v142, v143
    s_waitcnt lgkmcnt(3)
    v_mfma_f32_16x16x32_bf16 v[152:155], v[72:75], v[184:187], v[152:155]
    ds_read_b128 v[52:55], v30 offset:10240
    buffer_store_dwordx4 v[80:83], v3, s[8:11], s42 offen offset:1024 sc1
    v_mfma_f32_16x16x32_bf16 v[156:159], v[72:75], v[188:191], v[156:159]
    s_waitcnt lgkmcnt(3)
    v_mfma_f32_16x16x32_bf16 v[160:163], v[40:43], v[168:171], v[160:163]
    ds_read_b128 v[56:59], v30 offset:11264
    v_mfma_f32_16x16x32_bf16 v[164:167], v[40:43], v[172:175], v[164:167]
    s_waitcnt lgkmcnt(3)
    v_mfma_f32_16x16x32_bf16 v[160:163], v[44:47], v[176:179], v[160:163]
    ds_read_b128 v[60:63], v20 offset:0
    v_mfma_f32_16x16x32_bf16 v[164:167], v[44:47], v[180:183], v[164:167]
    v_cvt_pk_bf16_f32 v84, v144, v145
    s_waitcnt lgkmcnt(3)
    v_mfma_f32_16x16x32_bf16 v[160:163], v[48:51], v[184:187], v[160:163]
    ds_read_b128 v[64:67], v20 offset:1024
    v_cvt_pk_bf16_f32 v85, v146, v147
    v_mfma_f32_16x16x32_bf16 v[164:167], v[48:51], v[188:191], v[164:167]
    v_cvt_pk_bf16_f32 v86, v148, v149
    s_waitcnt lgkmcnt(3)
    v_mfma_f32_16x16x32_bf16 v[96:99], v[52:55], v[168:171], v[96:99]
    ds_read_b128 v[68:71], v20 offset:17408
    v_cvt_pk_bf16_f32 v87, v150, v151
    v_mfma_f32_16x16x32_bf16 v[100:103], v[52:55], v[172:175], v[100:103]
    buffer_store_dwordx4 v[84:87], v3, s[8:11], s43 offen offset:0 sc1
    s_waitcnt lgkmcnt(3)
    v_mfma_f32_16x16x32_bf16 v[104:107], v[56:59], v[168:171], v[104:107]
    ds_read_b128 v[72:75], v20 offset:18432
    v_cvt_pk_bf16_f32 v88, v152, v153
    v_mfma_f32_16x16x32_bf16 v[108:111], v[56:59], v[172:175], v[108:111]
    v_cvt_pk_bf16_f32 v89, v154, v155
    s_waitcnt lgkmcnt(3)
    v_mfma_f32_16x16x32_bf16 v[96:99], v[60:63], v[176:179], v[96:99]
    v_cvt_pk_bf16_f32 v90, v156, v157
    v_mfma_f32_16x16x32_bf16 v[100:103], v[60:63], v[180:183], v[100:103]
    v_cvt_pk_bf16_f32 v91, v158, v159
    s_waitcnt lgkmcnt(2)
    v_mfma_f32_16x16x32_bf16 v[104:107], v[64:67], v[176:179], v[104:107]
    buffer_store_dwordx4 v[88:91], v3, s[8:11], s43 offen offset:1024 sc1
    v_mfma_f32_16x16x32_bf16 v[108:111], v[64:67], v[180:183], v[108:111]
    v_cvt_pk_bf16_f32 v76, v160, v161
    s_waitcnt lgkmcnt(1)
    v_mfma_f32_16x16x32_bf16 v[96:99], v[68:71], v[184:187], v[96:99]
    v_cvt_pk_bf16_f32 v77, v162, v163
    v_mfma_f32_16x16x32_bf16 v[100:103], v[68:71], v[188:191], v[100:103]
    v_cvt_pk_bf16_f32 v78, v164, v165
    s_waitcnt lgkmcnt(0)
    v_mfma_f32_16x16x32_bf16 v[104:107], v[72:75], v[184:187], v[104:107]
    v_cvt_pk_bf16_f32 v79, v166, v167
    v_mfma_f32_16x16x32_bf16 v[108:111], v[72:75], v[188:191], v[108:111]
    s_cmp_eq_u32 s24, s26
    s_cbranch_scc1 Lh_0_86
    buffer_store_dwordx4 v[76:79], v3, s[8:11], s44 offen offset:2048 sc1
Lh_0_86:
    s_waitcnt vmcnt(6)
    v_permlane16_swap_b32 v208, v210
    v_permlane16_swap_b32 v209, v211
    v_permlane16_swap_b32 v220, v222
    v_permlane16_swap_b32 v221, v223
    v_permlane16_swap_b32 v212, v214
    v_permlane16_swap_b32 v213, v215
    v_permlane16_swap_b32 v224, v226
    v_permlane16_swap_b32 v225, v227
    v_permlane16_swap_b32 v216, v218
    v_permlane16_swap_b32 v217, v219
    v_permlane16_swap_b32 v228, v230
    v_permlane16_swap_b32 v229, v231
    v_dot2_f32_bf16 v232, v208, s34, 0
    v_dot2_f32_bf16 v233, v208, s35, 0
    v_dot2_f32_bf16 v234, v209, s34, 0
    v_dot2_f32_bf16 v235, v209, s35, 0
    v_dot2_f32_bf16 v236, v210, s34, 0
    v_dot2_f32_bf16 v237, v210, s35, 0
    v_dot2_f32_bf16 v238, v211, s34, 0
    v_dot2_f32_bf16 v239, v211, s35, 0
    v_dot2_f32_bf16 v240, v212, s34, 0
    v_dot2_f32_bf16 v241, v212, s35, 0
    v_dot2_f32_bf16 v242, v213, s34, 0
    v_dot2_f32_bf16 v243, v213, s35, 0
    v_dot2_f32_bf16 v244, v214, s34, 0
    v_dot2_f32_bf16 v245, v214, s35, 0
    v_dot2_f32_bf16 v246, v215, s34, 0
    v_dot2_f32_bf16 v247, v215, s35, 0
    v_dot2_f32_bf16 v248, v216, s34, 0
    v_dot2_f32_bf16 v249, v216, s35, 0
    v_dot2_f32_bf16 v250, v217, s34, 0
    v_dot2_f32_bf16 v251, v217, s35, 0
    v_dot2_f32_bf16 v252, v218, s34, 0
    v_dot2_f32_bf16 v253, v218, s35, 0
    v_dot2_f32_bf16 v254, v219, s34, 0
    v_dot2_f32_bf16 v255, v219, s35, 0
    v_dot2_f32_bf16 v232, v220, s34, v232
    v_dot2_f32_bf16 v233, v220, s35, v233
    v_dot2_f32_bf16 v234, v221, s34, v234
    v_dot2_f32_bf16 v235, v221, s35, v235
    v_dot2_f32_bf16 v236, v222, s34, v236
    v_dot2_f32_bf16 v237, v222, s35, v237
    v_dot2_f32_bf16 v238, v223, s34, v238
    v_dot2_f32_bf16 v239, v223, s35, v239
    v_dot2_f32_bf16 v240, v224, s34, v240
    v_dot2_f32_bf16 v241, v224, s35, v241
    v_dot2_f32_bf16 v242, v225, s34, v242
    v_dot2_f32_bf16 v243, v225, s35, v243
    v_dot2_f32_bf16 v244, v226, s34, v244
    v_dot2_f32_bf16 v245, v226, s35, v245
    v_dot2_f32_bf16 v246, v227, s34, v246
    v_dot2_f32_bf16 v247, v227, s35, v247
    v_dot2_f32_bf16 v248, v228, s34, v248
    v_dot2_f32_bf16 v249, v228, s35, v249
    v_dot2_f32_bf16 v250, v229, s34, v250
    v_dot2_f32_bf16 v251, v229, s35, v251
    v_dot2_f32_bf16 v252, v230, s34, v252
    v_dot2_f32_bf16 v253, v230, s35, v253
    v_dot2_f32_bf16 v254, v231, s34, v254
    v_dot2_f32_bf16 v255, v231, s35, v255
    s_waitcnt vmcnt(0)
    s_lshl_b32 s3, s2, 3
    s_add_u32 s3, s3, s45
    s_lshl_b32 s3, s3, 8
    v_mov_b32 v8, 32768
    v_mov_b32 v9, 1
    s_mov_b64 exec, 1
    buffer_store_dword v9, v8, s[8:11], s3 offen offset:128 sc1
    s_mov_b64 exec, -1
Lpo_0_89:
    buffer_load_dword v11, v10, s[8:11], 0 offen sc1
    s_sub_u32 s38, s38, 1
    s_cmp_lt_i32 s38, 0
    s_cbranch_scc1 Lpx_0_90
    s_waitcnt vmcnt(0)
    v_cmp_eq_u32 vcc, 0, v11
    s_nop 0
    s_cbranch_vccz Lpx_0_90
    s_sleep 0
    s_branch Lpo_0_89
Lpx_0_90:
    s_waitcnt vmcnt(0)
    buffer_load_dwordx4 v[40:43], v3, s[8:11], s33 offen offset:0 sc1
    buffer_load_dwordx4 v[44:47], v3, s[8:11], s33 offen offset:1024 sc1
    buffer_load_dwordx4 v[52:55], v3, s[8:11], s31 offen offset:0 sc1
    buffer_load_dwordx4 v[56:59], v3, s[8:11], s31 offen offset:1024 sc1
    buffer_load_dwordx4 v[64:67], v3, s[8:11], s32 offen offset:0 sc1
    buffer_load_dwordx4 v[68:71], v3, s[8:11], s32 offen offset:1024 sc1
    s_cmp_lg_u32 s24, s26
    s_cbranch_scc1 Lh_0_87
    buffer_load_dwordx4 v[48:51], v3, s[8:11], s33 offen offset:2048 sc1
    buffer_load_dwordx4 v[60:63], v3, s[8:11], s31 offen offset:2048 sc1
    buffer_load_dwordx4 v[72:75], v3, s[8:11], s32 offen offset:2048 sc1
Lh_0_87:
    s_waitcnt vmcnt(0)
    v_dot2_f32_bf16 v96, v40, s34, v96
    v_dot2_f32_bf16 v97, v40, s35, v97
    v_dot2_f32_bf16 v98, v41, s34, v98
    v_dot2_f32_bf16 v99, v41, s35, v99
    v_dot2_f32_bf16 v100, v42, s34, v100
    v_dot2_f32_bf16 v101, v42, s35, v101
    v_dot2_f32_bf16 v102, v43, s34, v102
    v_dot2_f32_bf16 v103, v43, s35, v103
    v_dot2_f32_bf16 v96, v52, s34, v96
    v_dot2_f32_bf16 v97, v52, s35, v97
    v_dot2_f32_bf16 v98, v53, s34, v98
    v_dot2_f32_bf16 v99, v53, s35, v99
    v_dot2_f32_bf16 v100, v54, s34, v100
    v_dot2_f32_bf16 v101, v54, s35, v101
    v_dot2_f32_bf16 v102, v55, s34, v102
    v_dot2_f32_bf16 v103, v55, s35, v103
    v_dot2_f32_bf16 v96, v64, s34, v96
    v_dot2_f32_bf16 v97, v64, s35, v97
    v_dot2_f32_bf16 v98, v65, s34, v98
    v_dot2_f32_bf16 v99, v65, s35, v99
    v_dot2_f32_bf16 v100, v66, s34, v100
    v_dot2_f32_bf16 v101, v66, s35, v101
    v_dot2_f32_bf16 v102, v67, s34, v102
    v_dot2_f32_bf16 v103, v67, s35, v103
    v_fma_f32 v96, v96, v12, v232
    v_fma_f32 v97, v97, v12, v233
    v_fma_f32 v98, v98, v12, v234
    v_fma_f32 v99, v99, v12, v235
    v_fma_f32 v100, v100, v13, v236
    v_fma_f32 v101, v101, v13, v237
    v_fma_f32 v102, v102, v13, v238
    v_fma_f32 v103, v103, v13, v239
    v_cvt_pk_bf16_f32 v96, v96, v97
    v_cvt_pk_bf16_f32 v97, v98, v99
    v_cvt_pk_bf16_f32 v98, v100, v101
    v_cvt_pk_bf16_f32 v99, v102, v103
    s_nop 0
    v_permlane16_swap_b32 v96, v98
    v_permlane16_swap_b32 v97, v99
    buffer_store_dwordx4 v[96:99], v14, s[48:51], s19 offen offset:0
    v_dot2_f32_bf16 v104, v44, s34, v104
    v_dot2_f32_bf16 v105, v44, s35, v105
    v_dot2_f32_bf16 v106, v45, s34, v106
    v_dot2_f32_bf16 v107, v45, s35, v107
    v_dot2_f32_bf16 v108, v46, s34, v108
    v_dot2_f32_bf16 v109, v46, s35, v109
    v_dot2_f32_bf16 v110, v47, s34, v110
    v_dot2_f32_bf16 v111, v47, s35, v111
    v_dot2_f32_bf16 v104, v56, s34, v104
    v_dot2_f32_bf16 v105, v56, s35, v105
    v_dot2_f32_bf16 v106, v57, s34, v106
    v_dot2_f32_bf16 v107, v57, s35, v107
    v_dot2_f32_bf16 v108, v58, s34, v108
    v_dot2_f32_bf16 v109, v58, s35, v109
    v_dot2_f32_bf16 v110, v59, s34, v110
    v_dot2_f32_bf16 v111, v59, s35, v111
    v_dot2_f32_bf16 v104, v68, s34, v104
    v_dot2_f32_bf16 v105, v68, s35, v105
    v_dot2_f32_bf16 v106, v69, s34, v106
    v_dot2_f32_bf16 v107, v69, s35, v107
    v_dot2_f32_bf16 v108, v70, s34, v108
    v_dot2_f32_bf16 v109, v70, s35, v109
    v_dot2_f32_bf16 v110, v71, s34, v110
    v_dot2_f32_bf16 v111, v71, s35, v111
    v_fma_f32 v104, v104, v12, v240
    v_fma_f32 v105, v105, v12, v241
    v_fma_f32 v106, v106, v12, v242
    v_fma_f32 v107, v107, v12, v243
    v_fma_f32 v108, v108, v13, v244
    v_fma_f32 v109, v109, v13, v245
    v_fma_f32 v110, v110, v13, v246
    v_fma_f32 v111, v111, v13, v247
    v_cvt_pk_bf16_f32 v104, v104, v105
    v_cvt_pk_bf16_f32 v105, v106, v107
    v_cvt_pk_bf16_f32 v106, v108, v109
    v_cvt_pk_bf16_f32 v107, v110, v111
    s_nop 0
    v_permlane16_swap_b32 v104, v106
    v_permlane16_swap_b32 v105, v107
    buffer_store_dwordx4 v[104:107], v14, s[48:51], s19 offen offset:32
    s_cmp_lg_u32 s24, s26
    s_cbranch_scc1 Lh_0_88
    v_dot2_f32_bf16 v160, v48, s34, v160
    v_dot2_f32_bf16 v161, v48, s35, v161
    v_dot2_f32_bf16 v162, v49, s34, v162
    v_dot2_f32_bf16 v163, v49, s35, v163
    v_dot2_f32_bf16 v164, v50, s34, v164
    v_dot2_f32_bf16 v165, v50, s35, v165
    v_dot2_f32_bf16 v166, v51, s34, v166
    v_dot2_f32_bf16 v167, v51, s35, v167
    v_dot2_f32_bf16 v160, v60, s34, v160
    v_dot2_f32_bf16 v161, v60, s35, v161
    v_dot2_f32_bf16 v162, v61, s34, v162
    v_dot2_f32_bf16 v163, v61, s35, v163
    v_dot2_f32_bf16 v164, v62, s34, v164
    v_dot2_f32_bf16 v165, v62, s35, v165
    v_dot2_f32_bf16 v166, v63, s34, v166
    v_dot2_f32_bf16 v167, v63, s35, v167
    v_dot2_f32_bf16 v160, v72, s34, v160
    v_dot2_f32_bf16 v161, v72, s35, v161
    v_dot2_f32_bf16 v162, v73, s34, v162
    v_dot2_f32_bf16 v163, v73, s35, v163
    v_dot2_f32_bf16 v164, v74, s34, v164
    v_dot2_f32_bf16 v165, v74, s35, v165
    v_dot2_f32_bf16 v166, v75, s34, v166
    v_dot2_f32_bf16 v167, v75, s35, v167
    v_fma_f32 v160, v160, v12, v248
    v_fma_f32 v161, v161, v12, v249
    v_fma_f32 v162, v162, v12, v250
    v_fma_f32 v163, v163, v12, v251
    v_fma_f32 v164, v164, v13, v252
    v_fma_f32 v165, v165, v13, v253
    v_fma_f32 v166, v166, v13, v254
    v_fma_f32 v167, v167, v13, v255
    v_cvt_pk_bf16_f32 v160, v160, v161
    v_cvt_pk_bf16_f32 v161, v162, v163
    v_cvt_pk_bf16_f32 v162, v164, v165
    v_cvt_pk_bf16_f32 v163, v166, v167
    s_nop 0
    v_permlane16_swap_b32 v160, v162
    v_permlane16_swap_b32 v161, v163
    buffer_store_dwordx4 v[160:163], v14, s[48:51], s18 offen offset:0
Lh_0_88:
    s_branch Lfin_0_5
LLd_0_4:
    s_and_b32 s60, s2, 3
    s_lshl_b32 s60, s60, 2
    s_bfe_u32 s61, s2, 0x20005
    s_add_u32 s60, s60, s61
    s_mul_i32 s60, s60, 331776
    s_sub_u32 s62, s24, 4
    s_sub_u32 s61, s62, s61
    s_and_b32 s61, s61, 3
    s_mul_i32 s61, s61, 9216
    s_mul_i32 s62, s62, 9216
    s_add_u32 s60, s60, s62
    s_add_u32 s60, s60, 9551872
    s_and_b32 s25, s24, 3
    s_lshl_b32 s16, s12, 2
    s_add_u32 s16, s16, s25
    v_and_b32 v4, 31, v1
    v_lshrrev_b32 v5, 5, v1
    v_lshrrev_b32 v7, 4, v4
    v_lshlrev_b32 v7, 10, v7
    v_lshl_add_u32 v7, v5, 8, v7
    v_and_b32 v8, 15, v1
    v_lshl_add_u32 v7, v8, 4, v7
    s_mul_i32 s21, s12, 1179648
    s_mul_i32 s22, s13, 73728
    s_add_u32 s21, s21, s22
    s_lshl_b32 s22, s25, 11
    s_add_u32 s21, s21, s22
    s_add_u32 s21, s21, 30101504
    v_lshlrev_b32 v9, 4, v5
    v_add_u32 v9, 147456, v9
    s_add_u32 s22, s22, 148736
    v_add_u32 v10, s22, v3
    s_mul_i32 s19, s13, 1152
    s_add_u32 s19, s19, 20168704
    v_subrev_u32 v11, 256, v0
    v_lshlrev_b32 v11, 3, v11
    s_lshl_b32 s18, s16, 12
    s_add_u32 s18, s18, 29773824
    v_lshlrev_b32 v6, 11, v5
    v_lshl_add_u32 v6, v4, 3, v6
    buffer_load_dwordx2 v[64:65], v11, s[8:11], s19 offen sc1
    s_add_u32 s19, s19, 18432
    buffer_load_dwordx2 v[66:67], v11, s[8:11], s19 offen sc1
    s_add_u32 s19, s19, 18432
    buffer_load_dwordx2 v[68:69], v11, s[8:11], s19 offen sc1
    s_add_u32 s19, s19, 18432
    buffer_load_dwordx2 v[70:71], v11, s[8:11], s19 offen sc1
    s_add_u32 s19, s19, 18432
    buffer_load_dwordx2 v[72:73], v11, s[8:11], s19 offen sc1
    s_add_u32 s19, s19, 18432
    buffer_load_dwordx2 v[74:75], v11, s[8:11], s19 offen sc1
    s_add_u32 s19, s19, 18432
    buffer_load_dwordx2 v[76:77], v11, s[8:11], s19 offen sc1
    s_add_u32 s19, s19, 18432
    buffer_load_dwordx2 v[78:79], v11, s[8:11], s19 offen sc1
    s_add_u32 s19, s19, 18432
    buffer_load_dwordx2 v[80:81], v11, s[8:11], s19 offen sc1
    s_lshl_b32 s28, s25, 11
    s_mul_i32 s29, s27, 1327104
    s_mul_i32 s17, s26, 331776
    s_add_u32 s29, s29, s17
    s_add_u32 s29, s29, 14860288
    s_mul_i32 s30, s12, 1179648
    s_mul_i32 s17, s26, 294912
    s_add_u32 s30, s30, s17
    s_add_u32 s30, s30, s28
    s_add_u32 s30, s30, 30101504
    v_add_u32 v16, s28, v3
    v_add_u32 v17, 8192, v3
    s_add_u32 s32, s28, 9216
    s_andn2_b32 s22, s2, 0x60
    s_lshl_b32 s22, s22, 11
    s_add_u32 s22, s22, 33280
    v_and_b32 v23, 3, v1
    v_lshl_add_u32 v23, v23, 16, s22
    v_add_u32 v24, 256, v23
    v_add_u32 v25, 512, v23
    s_add_u32 s17, s27, 0
    s_and_b32 s17, s17, 3
    s_mul_i32 s44, s17, 82944
    s_add_u32 s44, s44, s29
    s_mul_i32 s52, s17, 73728
    s_add_u32 s52, s52, s30
    s_add_u32 s17, s27, 1
    s_and_b32 s17, s17, 3
    s_mul_i32 s45, s17, 82944
    s_add_u32 s45, s45, s29
    s_mul_i32 s53, s17, 73728
    s_add_u32 s53, s53, s30
    s_add_u32 s17, s27, 2
    s_and_b32 s17, s17, 3
    s_mul_i32 s46, s17, 82944
    s_add_u32 s46, s46, s29
    s_mul_i32 s54, s17, 73728
    s_add_u32 s54, s54, s30
    s_add_u32 s17, s27, 3
    s_and_b32 s17, s17, 3
    s_mul_i32 s47, s17, 82944
    s_add_u32 s47, s47, s29
    s_mul_i32 s55, s17, 73728
    s_add_u32 s55, s55, s30
    s_barrier
    buffer_load_dwordx2 v[44:45], v6, s[8:11], s18 offen offset:0 sc1
    buffer_load_dwordx2 v[46:47], v6, s[8:11], s18 offen offset:256 sc1
    buffer_load_dwordx2 v[48:49], v6, s[8:11], s18 offen offset:512 sc1
    buffer_load_dwordx2 v[50:51], v6, s[8:11], s18 offen offset:768 sc1
    buffer_load_dwordx2 v[52:53], v6, s[8:11], s18 offen offset:1024 sc1
    buffer_load_dwordx2 v[54:55], v6, s[8:11], s18 offen offset:1280 sc1
    buffer_load_dwordx2 v[56:57], v6, s[8:11], s18 offen offset:1536 sc1
    buffer_load_dwordx2 v[58:59], v6, s[8:11], s18 offen offset:1792 sc1
    s_waitcnt vmcnt(0)
    v_add_f32 v44, v44, v46
    v_add_f32 v45, v45, v47
    v_add_f32 v44, v44, v48
    v_add_f32 v45, v45, v49
    v_add_f32 v44, v44, v50
    v_add_f32 v45, v45, v51
    v_add_f32 v44, v44, v52
    v_add_f32 v45, v45, v53
    v_add_f32 v44, v44, v54
    v_add_f32 v45, v45, v55
    v_add_f32 v44, v44, v56
    v_add_f32 v45, v45, v57
    v_add_f32 v44, v44, v58
    v_add_f32 v45, v45, v59
    v_mov_b32 v46, v44
    v_mov_b32 v47, v45
    s_nop 0
    v_permlane32_swap_b32 v44, v46
    v_permlane32_swap_b32 v45, v47
    v_add_f32 v44, v44, v46
    v_add_f32 v45, v45, v47
    v_mul_f32 v44, 0x3ae38e39, v44
    v_mul_f32 v45, 0x3ae38e39, v45
    v_fma_f32 v45, -v44, v44, v45
    v_max_f32 v45, 0, v45
    v_cvt_pk_bf16_f32 v44, v44, v44
    v_and_b32 v44, 0xffff0000, v44
    v_cvt_pk_bf16_f32 v45, v45, v45
    v_and_b32 v45, 0xffff0000, v45
    v_add_f32 v45, 0x3727c5ac, v45
    v_cvt_pk_bf16_f32 v45, v45, v45
    v_and_b32 v45, 0xffff0000, v45
    v_sqrt_f32 v45, v45
    s_nop 0
    v_cvt_pk_bf16_f32 v45, v45, v45
    v_and_b32 v45, 0xffff0000, v45
    v_rcp_f32 v15, v45
    v_sub_f32 v12, 0, v44
    v_mul_f32 v13, 0xc0135761, v15
    v_mul_f32 v14, v15, v15
    v_mul_f32 v14, v14, v15
    v_mul_f32 v14, 0xbdd2d3e8, v14
    v_add_f32 v64, v64, v66
    v_add_f32 v65, v65, v67
    v_add_f32 v64, v64, v68
    v_add_f32 v65, v65, v69
    v_add_f32 v64, v64, v70
    v_add_f32 v65, v65, v71
    v_add_f32 v64, v64, v72
    v_add_f32 v65, v65, v73
    v_add_f32 v64, v64, v74
    v_add_f32 v65, v65, v75
    v_add_f32 v64, v64, v76
    v_add_f32 v65, v65, v77
    v_add_f32 v64, v64, v78
    v_add_f32 v65, v65, v79
    v_add_f32 v64, v64, v80
    v_add_f32 v65, v65, v81
    v_add_u32 v11, 147456, v11
    v_cmp_gt_u32 vcc, 148608, v11
    s_nop 0
    s_and_saveexec_b64 s[40:41], vcc
    ds_write_b64 v11, v[64:65]
    s_mov_b64 exec, s[40:41]
    ds_write_b128 v10, v[12:15]
    s_waitcnt lgkmcnt(0)
    s_add_u32 m0, s61, 110592
    s_add_u32 s62, s60, 110592
    buffer_load_dwordx4 v3, s[8:11], s62 offen offset:0 sc1 lds
    buffer_load_dwordx4 v3, s[8:11], s62 offen offset:1024 sc1 lds
    buffer_load_dwordx4 v3, s[8:11], s62 offen offset:2048 sc1 lds
    buffer_load_dwordx4 v3, s[8:11], s62 offen offset:3072 sc1 lds
    s_add_u32 m0, s61, 114688
    s_add_u32 s62, s60, 114688
    buffer_load_dwordx4 v3, s[8:11], s62 offen offset:0 sc1 lds
    buffer_load_dwordx4 v3, s[8:11], s62 offen offset:1024 sc1 lds
    buffer_load_dwordx4 v3, s[8:11], s62 offen offset:2048 sc1 lds
    buffer_load_dwordx4 v3, s[8:11], s62 offen offset:3072 sc1 lds
    s_add_u32 m0, s61, 118784
    s_add_u32 s62, s60, 118784
    buffer_load_dwordx4 v3, s[8:11], s62 offen offset:0 sc1 lds
    s_barrier
    s_barrier
    ds_read_b128 v[64:67], v10
    ds_read_b128 v[68:71], v10 offset:1024
    ds_read_b128 v[80:83], v9 offset:64
    ds_read_b128 v[84:87], v9 offset:96
    s_waitcnt lgkmcnt(0)
    s_barrier
    s_add_u32 m0, s61, 0
    s_add_u32 s62, s60, 147456
    buffer_load_dwordx4 v3, s[8:11], s62 offen offset:0 sc1 lds
    v_fmac_f32 v64, v12, v80
    v_fmac_f32 v65, v12, v81
    v_fmac_f32 v66, v12, v82
    buffer_load_dwordx4 v3, s[8:11], s62 offen offset:1024 sc1 lds
    v_fmac_f32 v67, v12, v83
    v_fmac_f32 v68, v12, v84
    v_fmac_f32 v69, v12, v85
    buffer_load_dwordx4 v3, s[8:11], s62 offen offset:2048 sc1 lds
    v_fmac_f32 v70, v12, v86
    v_fmac_f32 v71, v12, v87
    v_mul_f32 v72, v64, v64
    buffer_load_dwordx4 v3, s[8:11], s62 offen offset:3072 sc1 lds
    v_mul_f32 v73, v65, v65
    v_mul_f32 v74, v66, v66
    v_mul_f32 v75, v67, v67
    s_add_u32 m0, s61, 4096
    s_add_u32 s62, s60, 151552
    buffer_load_dwordx4 v3, s[8:11], s62 offen offset:0 sc1 lds
    v_mul_f32 v76, v68, v68
    v_mul_f32 v77, v69, v69
    v_mul_f32 v78, v70, v70
    buffer_load_dwordx4 v3, s[8:11], s62 offen offset:1024 sc1 lds
    v_mul_f32 v79, v71, v71
    v_fma_f32 v72, v72, v14, v13
    v_fma_f32 v73, v73, v14, v13
    buffer_load_dwordx4 v3, s[8:11], s62 offen offset:2048 sc1 lds
    v_fma_f32 v74, v74, v14, v13
    v_fma_f32 v75, v75, v14, v13
    v_fma_f32 v76, v76, v14, v13
    buffer_load_dwordx4 v3, s[8:11], s62 offen offset:3072 sc1 lds
    v_fma_f32 v77, v77, v14, v13
    v_fma_f32 v78, v78, v14, v13
    v_fma_f32 v79, v79, v14, v13
    s_add_u32 m0, s61, 8192
    s_add_u32 s62, s60, 155648
    buffer_load_dwordx4 v3, s[8:11], s62 offen offset:0 sc1 lds
    v_mul_f32 v72, v72, v64
    v_mul_f32 v73, v73, v65
    v_mul_f32 v74, v74, v66
    v_mul_f32 v75, v75, v67
    v_mul_f32 v76, v76, v68
    v_mul_f32 v77, v77, v69
    v_mul_f32 v78, v78, v70
    v_mul_f32 v79, v79, v71
    v_exp_f32 v72, v72
    v_exp_f32 v73, v73
    v_exp_f32 v74, v74
    v_exp_f32 v75, v75
    v_exp_f32 v76, v76
    v_exp_f32 v77, v77
    v_exp_f32 v78, v78
    v_exp_f32 v79, v79
    v_add_f32 v72, 1.0, v72
    v_add_f32 v73, 1.0, v73
    v_add_f32 v74, 1.0, v74
    v_add_f32 v75, 1.0, v75
    v_add_f32 v76, 1.0, v76
    v_add_f32 v77, 1.0, v77
    v_add_f32 v78, 1.0, v78
    v_add_f32 v79, 1.0, v79
    v_rcp_f32 v72, v72
    v_rcp_f32 v73, v73
    v_rcp_f32 v74, v74
    v_rcp_f32 v75, v75
    v_rcp_f32 v76, v76
    v_rcp_f32 v77, v77
    v_rcp_f32 v78, v78
    v_rcp_f32 v79, v79
    v_mul_f32 v72, v72, v64
    v_mul_f32 v73, v73, v65
    v_mul_f32 v74, v74, v66
    v_mul_f32 v75, v75, v67
    v_mul_f32 v76, v76, v68
    v_mul_f32 v77, v77, v69
    v_mul_f32 v78, v78, v70
    v_mul_f32 v79, v79, v71
    v_cvt_pk_bf16_f32 v88, v72, v73
    v_cvt_pk_bf16_f32 v89, v74, v75
    v_cvt_pk_bf16_f32 v90, v76, v77
    v_cvt_pk_bf16_f32 v91, v78, v79
    s_add_u32 s23, s21, 0
    buffer_store_dwordx4 v[88:91], v7, s[8:11], s23 offen offset:512 sc1
    s_waitcnt vmcnt(10)
    s_barrier
    ds_read_b128 v[64:67], v10
    ds_read_b128 v[68:71], v10 offset:1024
    ds_read_b128 v[80:83], v9 offset:192
    ds_read_b128 v[84:87], v9 offset:224
    s_waitcnt lgkmcnt(0)
    s_barrier
    s_add_u32 m0, s61, 36864
    s_add_u32 s62, s60, 184320
    buffer_load_dwordx4 v3, s[8:11], s62 offen offset:0 sc1 lds
    v_fmac_f32 v64, v12, v80
    v_fmac_f32 v65, v12, v81
    v_fmac_f32 v66, v12, v82
    buffer_load_dwordx4 v3, s[8:11], s62 offen offset:1024 sc1 lds
    v_fmac_f32 v67, v12, v83
    v_fmac_f32 v68, v12, v84
    v_fmac_f32 v69, v12, v85
    buffer_load_dwordx4 v3, s[8:11], s62 offen offset:2048 sc1 lds
    v_fmac_f32 v70, v12, v86
    v_fmac_f32 v71, v12, v87
    v_mul_f32 v72, v64, v64
    buffer_load_dwordx4 v3, s[8:11], s62 offen offset:3072 sc1 lds
    v_mul_f32 v73, v65, v65
    v_mul_f32 v74, v66, v66
    v_mul_f32 v75, v67, v67
    s_add_u32 m0, s61, 40960
    s_add_u32 s62, s60, 188416
    buffer_load_dwordx4 v3, s[8:11], s62 offen offset:0 sc1 lds
    v_mul_f32 v76, v68, v68
    v_mul_f32 v77, v69, v69
    v_mul_f32 v78, v70, v70
    buffer_load_dwordx4 v3, s[8:11], s62 offen offset:1024 sc1 lds
    v_mul_f32 v79, v71, v71
    v_fma_f32 v72, v72, v14, v13
    v_fma_f32 v73, v73, v14, v13
    buffer_load_dwordx4 v3, s[8:11], s62 offen offset:2048 sc1 lds
    v_fma_f32 v74, v74, v14, v13
    v_fma_f32 v75, v75, v14, v13
    v_fma_f32 v76, v76, v14, v13
    buffer_load_dwordx4 v3, s[8:11], s62 offen offset:3072 sc1 lds
    v_fma_f32 v77, v77, v14, v13
    v_fma_f32 v78, v78, v14, v13
    v_fma_f32 v79, v79, v14, v13
    s_add_u32 m0, s61, 45056
    s_add_u32 s62, s60, 192512
    buffer_load_dwordx4 v3, s[8:11], s62 offen offset:0 sc1 lds
    v_mul_f32 v72, v72, v64
    v_mul_f32 v73, v73, v65
    v_mul_f32 v74, v74, v66
    v_mul_f32 v75, v75, v67
    v_mul_f32 v76, v76, v68
    v_mul_f32 v77, v77, v69
    v_mul_f32 v78, v78, v70
    v_mul_f32 v79, v79, v71
    v_exp_f32 v72, v72
    v_exp_f32 v73, v73
    v_exp_f32 v74, v74
    v_exp_f32 v75, v75
    v_exp_f32 v76, v76
    v_exp_f32 v77, v77
    v_exp_f32 v78, v78
    v_exp_f32 v79, v79
    v_add_f32 v72, 1.0, v72
    v_add_f32 v73, 1.0, v73
    v_add_f32 v74, 1.0, v74
    v_add_f32 v75, 1.0, v75
    v_add_f32 v76, 1.0, v76
    v_add_f32 v77, 1.0, v77
    v_add_f32 v78, 1.0, v78
    v_add_f32 v79, 1.0, v79
    v_rcp_f32 v72, v72
    v_rcp_f32 v73, v73
    v_rcp_f32 v74, v74
    v_rcp_f32 v75, v75
    v_rcp_f32 v76, v76
    v_rcp_f32 v77, v77
    v_rcp_f32 v78, v78
    v_rcp_f32 v79, v79
    v_mul_f32 v72, v72, v64
    v_mul_f32 v73, v73, v65
    v_mul_f32 v74, v74, v66
    v_mul_f32 v75, v75, v67
    v_mul_f32 v76, v76, v68
    v_mul_f32 v77, v77, v69
    v_mul_f32 v78, v78, v70
    v_mul_f32 v79, v79, v71
    v_cvt_pk_bf16_f32 v88, v72, v73
    v_cvt_pk_bf16_f32 v89, v74, v75
    v_cvt_pk_bf16_f32 v90, v76, v77
    v_cvt_pk_bf16_f32 v91, v78, v79
    s_add_u32 s23, s21, 8192
    buffer_store_dwordx4 v[88:91], v7, s[8:11], s23 offen offset:512 sc1
    s_waitcnt vmcnt(11)
    s_barrier
    ds_read_b128 v[64:67], v10
    ds_read_b128 v[68:71], v10 offset:1024
    ds_read_b128 v[80:83], v9 offset:320
    ds_read_b128 v[84:87], v9 offset:352
    s_waitcnt lgkmcnt(0)
    s_barrier
    s_add_u32 m0, s61, 73728
    s_add_u32 s62, s60, 221184
    buffer_load_dwordx4 v3, s[8:11], s62 offen offset:0 sc1 lds
    v_fmac_f32 v64, v12, v80
    v_fmac_f32 v65, v12, v81
    v_fmac_f32 v66, v12, v82
    buffer_load_dwordx4 v3, s[8:11], s62 offen offset:1024 sc1 lds
    v_fmac_f32 v67, v12, v83
    v_fmac_f32 v68, v12, v84
    v_fmac_f32 v69, v12, v85
    buffer_load_dwordx4 v3, s[8:11], s62 offen offset:2048 sc1 lds
    v_fmac_f32 v70, v12, v86
    v_fmac_f32 v71, v12, v87
    v_mul_f32 v72, v64, v64
    buffer_load_dwordx4 v3, s[8:11], s62 offen offset:3072 sc1 lds
    v_mul_f32 v73, v65, v65
    v_mul_f32 v74, v66, v66
    v_mul_f32 v75, v67, v67
    s_add_u32 m0, s61, 77824
    s_add_u32 s62, s60, 225280
    buffer_load_dwordx4 v3, s[8:11], s62 offen offset:0 sc1 lds
    v_mul_f32 v76, v68, v68
    v_mul_f32 v77, v69, v69
    v_mul_f32 v78, v70, v70
    buffer_load_dwordx4 v3, s[8:11], s62 offen offset:1024 sc1 lds
    v_mul_f32 v79, v71, v71
    v_fma_f32 v72, v72, v14, v13
    v_fma_f32 v73, v73, v14, v13
    buffer_load_dwordx4 v3, s[8:11], s62 offen offset:2048 sc1 lds
    v_fma_f32 v74, v74, v14, v13
    v_fma_f32 v75, v75, v14, v13
    v_fma_f32 v76, v76, v14, v13
    buffer_load_dwordx4 v3, s[8:11], s62 offen offset:3072 sc1 lds
    v_fma_f32 v77, v77, v14, v13
    v_fma_f32 v78, v78, v14, v13
    v_fma_f32 v79, v79, v14, v13
    s_add_u32 m0, s61, 81920
    s_add_u32 s62, s60, 229376
    buffer_load_dwordx4 v3, s[8:11], s62 offen offset:0 sc1 lds
    v_mul_f32 v72, v72, v64
    v_mul_f32 v73, v73, v65
    v_mul_f32 v74, v74, v66
    s_mul_i32 s63, s27, 1327104
    s_mul_i32 s64, s26, 331776
    s_add_u32 s63, s63, s64
    s_lshl_b32 s64, s14, 2
    s_add_u32 s64, s64, s25
    s_mul_i32 s64, s64, 10368
    s_add_u32 s63, s63, s64
    s_add_u32 s63, s63, 14860288
    buffer_load_dwordx4 v[112:115], v3, s[8:11], s63 offen offset:0 sc1
    v_mul_f32 v75, v75, v67
    v_mul_f32 v76, v76, v68
    v_mul_f32 v77, v77, v69
    buffer_load_dwordx4 v[116:119], v3, s[8:11], s63 offen offset:1024 sc1
    v_mul_f32 v78, v78, v70
    v_mul_f32 v79, v79, v71
    v_exp_f32 v72, v72
    buffer_load_dwordx4 v[120:123], v3, s[8:11], s63 offen offset:2048 sc1
    v_exp_f32 v73, v73
    v_exp_f32 v74, v74
    v_exp_f32 v75, v75
    s_add_u32 s63, s63, 3072
    v_exp_f32 v76, v76
    v_exp_f32 v77, v77
    v_exp_f32 v78, v78
    v_exp_f32 v79, v79
    v_add_f32 v72, 1.0, v72
    v_add_f32 v73, 1.0, v73
    v_add_f32 v74, 1.0, v74
    v_add_f32 v75, 1.0, v75
    v_add_f32 v76, 1.0, v76
    v_add_f32 v77, 1.0, v77
    v_add_f32 v78, 1.0, v78
    v_add_f32 v79, 1.0, v79
    v_rcp_f32 v72, v72
    v_rcp_f32 v73, v73
    v_rcp_f32 v74, v74
    v_rcp_f32 v75, v75
    v_rcp_f32 v76, v76
    v_rcp_f32 v77, v77
    v_rcp_f32 v78, v78
    v_rcp_f32 v79, v79
    v_mul_f32 v72, v72, v64
    v_mul_f32 v73, v73, v65
    v_mul_f32 v74, v74, v66
    v_mul_f32 v75, v75, v67
    v_mul_f32 v76, v76, v68
    v_mul_f32 v77, v77, v69
    v_mul_f32 v78, v78, v70
    v_mul_f32 v79, v79, v71
    v_cvt_pk_bf16_f32 v88, v72, v73
    v_cvt_pk_bf16_f32 v89, v74, v75
    v_cvt_pk_bf16_f32 v90, v76, v77
    v_cvt_pk_bf16_f32 v91, v78, v79
    s_add_u32 s23, s21, 16384
    buffer_store_dwordx4 v[88:91], v7, s[8:11], s23 offen offset:512 sc1
    s_waitcnt vmcnt(14)
    s_barrier
    ds_read_b128 v[64:67], v10
    ds_read_b128 v[68:71], v10 offset:1024
    ds_read_b128 v[80:83], v9 offset:448
    ds_read_b128 v[84:87], v9 offset:480
    s_waitcnt lgkmcnt(0)
    s_barrier
    s_add_u32 m0, s61, 110592
    s_add_u32 s62, s60, 258048
    buffer_load_dwordx4 v3, s[8:11], s62 offen offset:0 sc1 lds
    v_fmac_f32 v64, v12, v80
    v_fmac_f32 v65, v12, v81
    v_fmac_f32 v66, v12, v82
    buffer_load_dwordx4 v3, s[8:11], s62 offen offset:1024 sc1 lds
    v_fmac_f32 v67, v12, v83
    v_fmac_f32 v68, v12, v84
    v_fmac_f32 v69, v12, v85
    buffer_load_dwordx4 v3, s[8:11], s62 offen offset:2048 sc1 lds
    v_fmac_f32 v70, v12, v86
    v_fmac_f32 v71, v12, v87
    v_mul_f32 v72, v64, v64
    buffer_load_dwordx4 v3, s[8:11], s62 offen offset:3072 sc1 lds
    v_mul_f32 v73, v65, v65
    v_mul_f32 v74, v66, v66
    v_mul_f32 v75, v67, v67
    s_add_u32 m0, s61, 114688
    s_add_u32 s62, s60, 262144
    buffer_load_dwordx4 v3, s[8:11], s62 offen offset:0 sc1 lds
    v_mul_f32 v76, v68, v68
    v_mul_f32 v77, v69, v69
    v_mul_f32 v78, v70, v70
    buffer_load_dwordx4 v3, s[8:11], s62 offen offset:1024 sc1 lds
    v_mul_f32 v79, v71, v71
    v_fma_f32 v72, v72, v14, v13
    v_fma_f32 v73, v73, v14, v13
    buffer_load_dwordx4 v3, s[8:11], s62 offen offset:2048 sc1 lds
    v_fma_f32 v74, v74, v14, v13
    v_fma_f32 v75, v75, v14, v13
    v_fma_f32 v76, v76, v14, v13
    buffer_load_dwordx4 v3, s[8:11], s62 offen offset:3072 sc1 lds
    v_fma_f32 v77, v77, v14, v13
    v_fma_f32 v78, v78, v14, v13
    v_fma_f32 v79, v79, v14, v13
    s_add_u32 m0, s61, 118784
    s_add_u32 s62, s60, 266240
    buffer_load_dwordx4 v3, s[8:11], s62 offen offset:0 sc1 lds
    v_mul_f32 v72, v72, v64
    v_mul_f32 v73, v73, v65
    v_mul_f32 v74, v74, v66
    buffer_load_dwordx4 v[124:127], v3, s[8:11], s63 offen offset:0 sc1
    v_mul_f32 v75, v75, v67
    v_mul_f32 v76, v76, v68
    v_mul_f32 v77, v77, v69
    buffer_load_dwordx4 v[128:131], v3, s[8:11], s63 offen offset:1024 sc1
    v_mul_f32 v78, v78, v70
    v_mul_f32 v79, v79, v71
    v_exp_f32 v72, v72
    buffer_load_dwordx4 v[132:135], v3, s[8:11], s63 offen offset:2048 sc1
    v_exp_f32 v73, v73
    v_exp_f32 v74, v74
    v_exp_f32 v75, v75
    s_add_u32 s63, s63, 3072
    v_exp_f32 v76, v76
    v_exp_f32 v77, v77
    v_exp_f32 v78, v78
    v_exp_f32 v79, v79
    v_add_f32 v72, 1.0, v72
    v_add_f32 v73, 1.0, v73
    v_add_f32 v74, 1.0, v74
    v_add_f32 v75, 1.0, v75
    v_add_f32 v76, 1.0, v76
    v_add_f32 v77, 1.0, v77
    v_add_f32 v78, 1.0, v78
    v_add_f32 v79, 1.0, v79
    v_rcp_f32 v72, v72
    v_rcp_f32 v73, v73
    v_rcp_f32 v74, v74
    v_rcp_f32 v75, v75
    v_rcp_f32 v76, v76
    v_rcp_f32 v77, v77
    v_rcp_f32 v78, v78
    v_rcp_f32 v79, v79
    v_mul_f32 v72, v72, v64
    v_mul_f32 v73, v73, v65
    v_mul_f32 v74, v74, v66
    v_mul_f32 v75, v75, v67
    v_mul_f32 v76, v76, v68
    v_mul_f32 v77, v77, v69
    v_mul_f32 v78, v78, v70
    v_mul_f32 v79, v79, v71
    v_cvt_pk_bf16_f32 v88, v72, v73
    v_cvt_pk_bf16_f32 v89, v74, v75
    v_cvt_pk_bf16_f32 v90, v76, v77
    v_cvt_pk_bf16_f32 v91, v78, v79
    s_add_u32 s23, s21, 24576
    buffer_store_dwordx4 v[88:91], v7, s[8:11], s23 offen offset:512 sc1
    s_waitcnt vmcnt(17)
    s_barrier
    ds_read_b128 v[64:67], v10
    ds_read_b128 v[68:71], v10 offset:1024
    ds_read_b128 v[80:83], v9 offset:576
    ds_read_b128 v[84:87], v9 offset:608
    s_waitcnt lgkmcnt(0)
    s_barrier
    s_add_u32 m0, s61, 0
    s_add_u32 s62, s60, 294912
    buffer_load_dwordx4 v3, s[8:11], s62 offen offset:0 sc1 lds
    v_fmac_f32 v64, v12, v80
    v_fmac_f32 v65, v12, v81
    v_fmac_f32 v66, v12, v82
    buffer_load_dwordx4 v3, s[8:11], s62 offen offset:1024 sc1 lds
    v_fmac_f32 v67, v12, v83
    v_fmac_f32 v68, v12, v84
    v_fmac_f32 v69, v12, v85
    buffer_load_dwordx4 v3, s[8:11], s62 offen offset:2048 sc1 lds
    v_fmac_f32 v70, v12, v86
    v_fmac_f32 v71, v12, v87
    v_mul_f32 v72, v64, v64
    buffer_load_dwordx4 v3, s[8:11], s62 offen offset:3072 sc1 lds
    v_mul_f32 v73, v65, v65
    v_mul_f32 v74, v66, v66
    v_mul_f32 v75, v67, v67
    s_add_u32 m0, s61, 4096
    s_add_u32 s62, s60, 299008
    buffer_load_dwordx4 v3, s[8:11], s62 offen offset:0 sc1 lds
    v_mul_f32 v76, v68, v68
    v_mul_f32 v77, v69, v69
    v_mul_f32 v78, v70, v70
    buffer_load_dwordx4 v3, s[8:11], s62 offen offset:1024 sc1 lds
    v_mul_f32 v79, v71, v71
    v_fma_f32 v72, v72, v14, v13
    v_fma_f32 v73, v73, v14, v13
    buffer_load_dwordx4 v3, s[8:11], s62 offen offset:2048 sc1 lds
    v_fma_f32 v74, v74, v14, v13
    v_fma_f32 v75, v75, v14, v13
    v_fma_f32 v76, v76, v14, v13
    buffer_load_dwordx4 v3, s[8:11], s62 offen offset:3072 sc1 lds
    v_fma_f32 v77, v77, v14, v13
    v_fma_f32 v78, v78, v14, v13
    v_fma_f32 v79, v79, v14, v13
    s_add_u32 m0, s61, 8192
    s_add_u32 s62, s60, 303104
    buffer_load_dwordx4 v3, s[8:11], s62 offen offset:0 sc1 lds
    v_mul_f32 v72, v72, v64
    v_mul_f32 v73, v73, v65
    v_mul_f32 v74, v74, v66
    buffer_load_dwordx4 v[136:139], v3, s[8:11], s63 offen offset:0 sc1
    v_mul_f32 v75, v75, v67
    v_mul_f32 v76, v76, v68
    v_mul_f32 v77, v77, v69
    buffer_load_dwordx4 v[140:143], v3, s[8:11], s63 offen offset:1024 sc1
    v_mul_f32 v78, v78, v70
    v_mul_f32 v79, v79, v71
    v_exp_f32 v72, v72
    buffer_load_dwordx4 v[144:147], v3, s[8:11], s63 offen offset:2048 sc1
    v_exp_f32 v73, v73
    v_exp_f32 v74, v74
    v_exp_f32 v75, v75
    s_add_u32 s63, s63, 3072
    v_exp_f32 v76, v76
    v_exp_f32 v77, v77
    v_exp_f32 v78, v78
    v_exp_f32 v79, v79
    v_add_f32 v72, 1.0, v72
    v_add_f32 v73, 1.0, v73
    v_add_f32 v74, 1.0, v74
    v_add_f32 v75, 1.0, v75
    v_add_f32 v76, 1.0, v76
    v_add_f32 v77, 1.0, v77
    v_add_f32 v78, 1.0, v78
    v_add_f32 v79, 1.0, v79
    v_rcp_f32 v72, v72
    v_rcp_f32 v73, v73
    v_rcp_f32 v74, v74
    v_rcp_f32 v75, v75
    v_rcp_f32 v76, v76
    v_rcp_f32 v77, v77
    v_rcp_f32 v78, v78
    v_rcp_f32 v79, v79
    v_mul_f32 v72, v72, v64
    v_mul_f32 v73, v73, v65
    v_mul_f32 v74, v74, v66
    v_mul_f32 v75, v75, v67
    v_mul_f32 v76, v76, v68
    v_mul_f32 v77, v77, v69
    v_mul_f32 v78, v78, v70
    v_mul_f32 v79, v79, v71
    v_cvt_pk_bf16_f32 v88, v72, v73
    v_cvt_pk_bf16_f32 v89, v74, v75
    v_cvt_pk_bf16_f32 v90, v76, v77
    v_cvt_pk_bf16_f32 v91, v78, v79
    s_add_u32 s23, s21, 32768
    buffer_store_dwordx4 v[88:91], v7, s[8:11], s23 offen offset:512 sc1
    s_waitcnt vmcnt(17)
    s_barrier
    ds_read_b128 v[64:67], v10
    ds_read_b128 v[68:71], v10 offset:1024
    ds_read_b128 v[80:83], v9 offset:704
    ds_read_b128 v[84:87], v9 offset:736
    s_waitcnt lgkmcnt(0)
    s_barrier
    buffer_load_dwordx4 v[148:151], v3, s[8:11], s63 offen offset:0 sc1
    v_fmac_f32 v64, v12, v80
    v_fmac_f32 v65, v12, v81
    v_fmac_f32 v66, v12, v82
    buffer_load_dwordx4 v[152:155], v3, s[8:11], s63 offen offset:1024 sc1
    v_fmac_f32 v67, v12, v83
    v_fmac_f32 v68, v12, v84
    v_fmac_f32 v69, v12, v85
    buffer_load_dwordx4 v[156:159], v3, s[8:11], s63 offen offset:2048 sc1
    v_fmac_f32 v70, v12, v86
    v_fmac_f32 v71, v12, v87
    v_mul_f32 v72, v64, v64
    s_add_u32 s63, s63, 3072
    v_mul_f32 v73, v65, v65
    v_mul_f32 v74, v66, v66
    v_mul_f32 v75, v67, v67
    v_mul_f32 v76, v68, v68
    v_mul_f32 v77, v69, v69
    v_mul_f32 v78, v70, v70
    v_mul_f32 v79, v71, v71
    v_fma_f32 v72, v72, v14, v13
    v_fma_f32 v73, v73, v14, v13
    v_fma_f32 v74, v74, v14, v13
    v_fma_f32 v75, v75, v14, v13
    v_fma_f32 v76, v76, v14, v13
    v_fma_f32 v77, v77, v14, v13
    v_fma_f32 v78, v78, v14, v13
    v_fma_f32 v79, v79, v14, v13
    v_mul_f32 v72, v72, v64
    v_mul_f32 v73, v73, v65
    v_mul_f32 v74, v74, v66
    v_mul_f32 v75, v75, v67
    v_mul_f32 v76, v76, v68
    v_mul_f32 v77, v77, v69
    v_mul_f32 v78, v78, v70
    v_mul_f32 v79, v79, v71
    v_exp_f32 v72, v72
    v_exp_f32 v73, v73
    v_exp_f32 v74, v74
    v_exp_f32 v75, v75
    v_exp_f32 v76, v76
    v_exp_f32 v77, v77
    v_exp_f32 v78, v78
    v_exp_f32 v79, v79
    v_add_f32 v72, 1.0, v72
    v_add_f32 v73, 1.0, v73
    v_add_f32 v74, 1.0, v74
    v_add_f32 v75, 1.0, v75
    v_add_f32 v76, 1.0, v76
    v_add_f32 v77, 1.0, v77
    v_add_f32 v78, 1.0, v78
    v_add_f32 v79, 1.0, v79
    v_rcp_f32 v72, v72
    v_rcp_f32 v73, v73
    v_rcp_f32 v74, v74
    v_rcp_f32 v75, v75
    v_rcp_f32 v76, v76
    v_rcp_f32 v77, v77
    v_rcp_f32 v78, v78
    v_rcp_f32 v79, v79
    v_mul_f32 v72, v72, v64
    v_mul_f32 v73, v73, v65
    v_mul_f32 v74, v74, v66
    v_mul_f32 v75, v75, v67
    v_mul_f32 v76, v76, v68
    v_mul_f32 v77, v77, v69
    v_mul_f32 v78, v78, v70
    v_mul_f32 v79, v79, v71
    v_cvt_pk_bf16_f32 v88, v72, v73
    v_cvt_pk_bf16_f32 v89, v74, v75
    v_cvt_pk_bf16_f32 v90, v76, v77
    v_cvt_pk_bf16_f32 v91, v78, v79
    s_add_u32 s23, s21, 40960
    buffer_store_dwordx4 v[88:91], v7, s[8:11], s23 offen offset:512 sc1
    s_waitcnt vmcnt(8)
    s_barrier
    ds_read_b128 v[64:67], v10
    ds_read_b128 v[68:71], v10 offset:1024
    ds_read_b128 v[80:83], v9 offset:832
    ds_read_b128 v[84:87], v9 offset:864
    s_waitcnt lgkmcnt(0)
    s_barrier
    s_cmp_lg_u32 s24, 7
    s_cbranch_scc1 Lfl_0_91
    s_lshl_b32 s3, s2, 3
    s_add_u32 s3, s3, 4
    s_lshl_b32 s3, s3, 8
    v_mov_b32 v20, 32768
    v_mov_b32 v21, 1
    s_mov_b64 exec, 1
    buffer_store_dword v21, v20, s[8:11], s3 offen offset:0 sc1
    s_mov_b64 exec, -1
Lfl_0_91:
    s_mov_b32 s33, s44
    s_mov_b32 s34, 0
    s_mov_b32 s35, 45056
    s_cmp_eq_u32 s25, 1
    s_cselect_b32 s33, s44, s33
    s_cselect_b32 s34, 9216, s34
    s_cselect_b32 s35, 62464, s35
    s_cmp_eq_u32 s25, 2
    s_cselect_b32 s33, s44, s33
    s_cselect_b32 s34, 18432, s34
    s_cselect_b32 s35, 79872, s35
    s_cmp_eq_u32 s25, 3
    s_cselect_b32 s33, s44, s33
    s_cselect_b32 s34, 27648, s34
    s_cselect_b32 s35, 97280, s35
    s_mov_b32 m0, s35
    s_add_u32 s33, s33, s34
    buffer_load_dwordx4 v17, s[8:11], s33 offen sc1 lds
    v_fmac_f32 v64, v12, v80
    v_fmac_f32 v65, v12, v81
    v_fmac_f32 v66, v12, v82
    s_add_u32 m0, s28, 36864
    s_add_u32 s20, s44, 0
    buffer_load_dwordx4 v16, s[8:11], s20 offen sc1 lds
    v_fmac_f32 v67, v12, v83
    v_fmac_f32 v68, v12, v84
    v_fmac_f32 v69, v12, v85
    buffer_load_dwordx4 v16, s[8:11], s20 offen offset:1024 sc1 lds
    v_fmac_f32 v70, v12, v86
    v_fmac_f32 v71, v12, v87
    v_mul_f32 v72, v64, v64
    s_add_u32 m0, s32, 36864
    s_add_u32 s20, s52, 0
    buffer_load_dwordx4 v3, s[8:11], s20 offen sc1 lds
    v_mul_f32 v73, v65, v65
    v_mul_f32 v74, v66, v66
    v_mul_f32 v75, v67, v67
    buffer_load_dwordx4 v3, s[8:11], s20 offen offset:1024 sc1 lds
    v_mul_f32 v76, v68, v68
    v_mul_f32 v77, v69, v69
    v_mul_f32 v78, v70, v70
    s_add_u32 m0, s28, 54272
    s_add_u32 s20, s44, 9216
    buffer_load_dwordx4 v16, s[8:11], s20 offen sc1 lds
    v_mul_f32 v79, v71, v71
    v_fma_f32 v72, v72, v14, v13
    v_fma_f32 v73, v73, v14, v13
    buffer_load_dwordx4 v16, s[8:11], s20 offen offset:1024 sc1 lds
    v_fma_f32 v74, v74, v14, v13
    v_fma_f32 v75, v75, v14, v13
    v_fma_f32 v76, v76, v14, v13
    s_add_u32 m0, s32, 54272
    s_add_u32 s20, s52, 8192
    buffer_load_dwordx4 v3, s[8:11], s20 offen sc1 lds
    v_fma_f32 v77, v77, v14, v13
    v_fma_f32 v78, v78, v14, v13
    v_fma_f32 v79, v79, v14, v13
    buffer_load_dwordx4 v3, s[8:11], s20 offen offset:1024 sc1 lds
    v_mul_f32 v72, v72, v64
    v_mul_f32 v73, v73, v65
    v_mul_f32 v74, v74, v66
    s_add_u32 m0, s28, 71680
    s_add_u32 s20, s44, 18432
    buffer_load_dwordx4 v16, s[8:11], s20 offen sc1 lds
    v_mul_f32 v75, v75, v67
    v_mul_f32 v76, v76, v68
    v_mul_f32 v77, v77, v69
    buffer_load_dwordx4 v16, s[8:11], s20 offen offset:1024 sc1 lds
    v_mul_f32 v78, v78, v70
    v_mul_f32 v79, v79, v71
    v_exp_f32 v72, v72
    s_add_u32 m0, s32, 71680
    s_add_u32 s20, s52, 16384
    buffer_load_dwordx4 v3, s[8:11], s20 offen sc1 lds
    v_exp_f32 v73, v73
    v_exp_f32 v74, v74
    v_exp_f32 v75, v75
    buffer_load_dwordx4 v3, s[8:11], s20 offen offset:1024 sc1 lds
    v_exp_f32 v76, v76
    v_exp_f32 v77, v77
    v_exp_f32 v78, v78
    s_add_u32 m0, s28, 89088
    s_add_u32 s20, s44, 27648
    buffer_load_dwordx4 v16, s[8:11], s20 offen sc1 lds
    v_exp_f32 v79, v79
    v_add_f32 v72, 1.0, v72
    v_add_f32 v73, 1.0, v73
    buffer_load_dwordx4 v16, s[8:11], s20 offen offset:1024 sc1 lds
    v_add_f32 v74, 1.0, v74
    v_add_f32 v75, 1.0, v75
    v_add_f32 v76, 1.0, v76
    s_add_u32 m0, s32, 89088
    s_add_u32 s20, s52, 24576
    buffer_load_dwordx4 v3, s[8:11], s20 offen sc1 lds
    v_add_f32 v77, 1.0, v77
    v_add_f32 v78, 1.0, v78
    v_add_f32 v79, 1.0, v79
    buffer_load_dwordx4 v3, s[8:11], s20 offen offset:1024 sc1 lds
    v_rcp_f32 v72, v72
    v_rcp_f32 v73, v73
    v_rcp_f32 v74, v74
    v_rcp_f32 v75, v75
    v_rcp_f32 v76, v76
    v_rcp_f32 v77, v77
    v_rcp_f32 v78, v78
    v_rcp_f32 v79, v79
    v_mul_f32 v72, v72, v64
    v_mul_f32 v73, v73, v65
    v_mul_f32 v74, v74, v66
    v_mul_f32 v75, v75, v67
    v_mul_f32 v76, v76, v68
    v_mul_f32 v77, v77, v69
    v_mul_f32 v78, v78, v70
    v_mul_f32 v79, v79, v71
    v_cvt_pk_bf16_f32 v88, v72, v73
    v_cvt_pk_bf16_f32 v89, v74, v75
    v_cvt_pk_bf16_f32 v90, v76, v77
    v_cvt_pk_bf16_f32 v91, v78, v79
    s_add_u32 s23, s21, 49152
    buffer_store_dwordx4 v[88:91], v7, s[8:11], s23 offen offset:512 sc1
    s_waitcnt vmcnt(18)
    s_barrier
    ds_read_b128 v[64:67], v10
    ds_read_b128 v[68:71], v10 offset:1024
    ds_read_b128 v[80:83], v9 offset:960
    ds_read_b128 v[84:87], v9 offset:992
    s_waitcnt lgkmcnt(0)
    s_barrier
    s_mov_b32 s33, s44
    s_mov_b32 s34, 36864
    s_mov_b32 s35, 114688
    s_cmp_eq_u32 s25, 1
    s_cselect_b32 s33, s44, s33
    s_cselect_b32 s34, 46080, s34
    s_cselect_b32 s35, 132096, s35
    s_cmp_eq_u32 s25, 2
    s_cselect_b32 s33, s44, s33
    s_cselect_b32 s34, 36864, s34
    s_cselect_b32 s35, 114688, s35
    s_cmp_eq_u32 s25, 3
    s_cselect_b32 s33, s44, s33
    s_cselect_b32 s34, 46080, s34
    s_cselect_b32 s35, 132096, s35
    s_mov_b32 m0, s35
    s_add_u32 s33, s33, s34
    buffer_load_dwordx4 v17, s[8:11], s33 offen sc1 lds
    v_fmac_f32 v64, v12, v80
    v_fmac_f32 v65, v12, v81
    v_fmac_f32 v66, v12, v82
    s_add_u32 m0, s28, 106496
    s_add_u32 s20, s44, 36864
    buffer_load_dwordx4 v16, s[8:11], s20 offen sc1 lds
    v_fmac_f32 v67, v12, v83
    v_fmac_f32 v68, v12, v84
    v_fmac_f32 v69, v12, v85
    buffer_load_dwordx4 v16, s[8:11], s20 offen offset:1024 sc1 lds
    v_fmac_f32 v70, v12, v86
    v_fmac_f32 v71, v12, v87
    v_mul_f32 v72, v64, v64
    s_add_u32 m0, s32, 106496
    s_add_u32 s20, s52, 32768
    buffer_load_dwordx4 v3, s[8:11], s20 offen sc1 lds
    v_mul_f32 v73, v65, v65
    v_mul_f32 v74, v66, v66
    v_mul_f32 v75, v67, v67
    buffer_load_dwordx4 v3, s[8:11], s20 offen offset:1024 sc1 lds
    v_mul_f32 v76, v68, v68
    v_mul_f32 v77, v69, v69
    v_mul_f32 v78, v70, v70
    s_add_u32 m0, s28, 123904
    s_add_u32 s20, s44, 46080
    buffer_load_dwordx4 v16, s[8:11], s20 offen sc1 lds
    v_mul_f32 v79, v71, v71
    v_fma_f32 v72, v72, v14, v13
    v_fma_f32 v73, v73, v14, v13
    buffer_load_dwordx4 v16, s[8:11], s20 offen offset:1024 sc1 lds
    v_fma_f32 v74, v74, v14, v13
    v_fma_f32 v75, v75, v14, v13
    v_fma_f32 v76, v76, v14, v13
    s_add_u32 m0, s32, 123904
    s_add_u32 s20, s52, 40960
    buffer_load_dwordx4 v3, s[8:11], s20 offen sc1 lds
    v_fma_f32 v77, v77, v14, v13
    v_fma_f32 v78, v78, v14, v13
    v_fma_f32 v79, v79, v14, v13
    buffer_load_dwordx4 v3, s[8:11], s20 offen offset:1024 sc1 lds
    v_mul_f32 v72, v72, v64
    v_mul_f32 v73, v73, v65
    v_mul_f32 v74, v74, v66
    v_mul_f32 v75, v75, v67
    v_mul_f32 v76, v76, v68
    v_mul_f32 v77, v77, v69
    v_mul_f32 v78, v78, v70
    v_mul_f32 v79, v79, v71
    v_exp_f32 v72, v72
    v_exp_f32 v73, v73
    v_exp_f32 v74, v74
    v_exp_f32 v75, v75
    v_exp_f32 v76, v76
    v_exp_f32 v77, v77
    v_exp_f32 v78, v78
    v_exp_f32 v79, v79
    v_add_f32 v72, 1.0, v72
    v_add_f32 v73, 1.0, v73
    v_add_f32 v74, 1.0, v74
    v_add_f32 v75, 1.0, v75
    v_add_f32 v76, 1.0, v76
    v_add_f32 v77, 1.0, v77
    v_add_f32 v78, 1.0, v78
    v_add_f32 v79, 1.0, v79
    v_rcp_f32 v72, v72
    v_rcp_f32 v73, v73
    v_rcp_f32 v74, v74
    v_rcp_f32 v75, v75
    v_rcp_f32 v76, v76
    v_rcp_f32 v77, v77
    v_rcp_f32 v78, v78
    v_rcp_f32 v79, v79
    v_mul_f32 v72, v72, v64
    v_mul_f32 v73, v73, v65
    v_mul_f32 v74, v74, v66
    v_mul_f32 v75, v75, v67
    v_mul_f32 v76, v76, v68
    v_mul_f32 v77, v77, v69
    v_mul_f32 v78, v78, v70
    v_mul_f32 v79, v79, v71
    v_cvt_pk_bf16_f32 v88, v72, v73
    v_cvt_pk_bf16_f32 v89, v74, v75
    v_cvt_pk_bf16_f32 v90, v76, v77
    v_cvt_pk_bf16_f32 v91, v78, v79
    s_add_u32 s23, s21, 57344
    buffer_store_dwordx4 v[88:91], v7, s[8:11], s23 offen offset:512 sc1
    s_barrier
    ds_read_b128 v[64:67], v10
    ds_read_b128 v[68:71], v10 offset:1024
    ds_read_b128 v[80:83], v9 offset:1088
    ds_read_b128 v[84:87], v9 offset:1120
    s_waitcnt lgkmcnt(0)
    buffer_load_dword v22, v25, s[8:11], 0 offen sc1
    v_fmac_f32 v64, v12, v80
    v_fmac_f32 v65, v12, v81
    v_fmac_f32 v66, v12, v82
    v_fmac_f32 v67, v12, v83
    v_fmac_f32 v68, v12, v84
    v_fmac_f32 v69, v12, v85
    v_fmac_f32 v70, v12, v86
    v_fmac_f32 v71, v12, v87
    v_mul_f32 v72, v64, v64
    v_mul_f32 v73, v65, v65
    v_mul_f32 v74, v66, v66
    v_mul_f32 v75, v67, v67
    v_mul_f32 v76, v68, v68
    v_mul_f32 v77, v69, v69
    v_mul_f32 v78, v70, v70
    v_mul_f32 v79, v71, v71
    v_fma_f32 v72, v72, v14, v13
    v_fma_f32 v73, v73, v14, v13
    v_fma_f32 v74, v74, v14, v13
    v_fma_f32 v75, v75, v14, v13
    v_fma_f32 v76, v76, v14, v13
    v_fma_f32 v77, v77, v14, v13
    v_fma_f32 v78, v78, v14, v13
    v_fma_f32 v79, v79, v14, v13
    v_mul_f32 v72, v72, v64
    v_mul_f32 v73, v73, v65
    v_mul_f32 v74, v74, v66
    v_mul_f32 v75, v75, v67
    v_mul_f32 v76, v76, v68
    v_mul_f32 v77, v77, v69
    v_mul_f32 v78, v78, v70
    v_mul_f32 v79, v79, v71
    v_exp_f32 v72, v72
    v_exp_f32 v73, v73
    v_exp_f32 v74, v74
    v_exp_f32 v75, v75
    v_exp_f32 v76, v76
    v_exp_f32 v77, v77
    v_exp_f32 v78, v78
    v_exp_f32 v79, v79
    v_add_f32 v72, 1.0, v72
    v_add_f32 v73, 1.0, v73
    v_add_f32 v74, 1.0, v74
    v_add_f32 v75, 1.0, v75
    v_add_f32 v76, 1.0, v76
    v_add_f32 v77, 1.0, v77
    v_add_f32 v78, 1.0, v78
    v_add_f32 v79, 1.0, v79
    v_rcp_f32 v72, v72
    v_rcp_f32 v73, v73
    v_rcp_f32 v74, v74
    v_rcp_f32 v75, v75
    v_rcp_f32 v76, v76
    v_rcp_f32 v77, v77
    v_rcp_f32 v78, v78
    v_rcp_f32 v79, v79
    v_mul_f32 v72, v72, v64
    v_mul_f32 v73, v73, v65
    v_mul_f32 v74, v74, v66
    v_mul_f32 v75, v75, v67
    v_mul_f32 v76, v76, v68
    v_mul_f32 v77, v77, v69
    v_mul_f32 v78, v78, v70
    v_mul_f32 v79, v79, v71
    v_cvt_pk_bf16_f32 v88, v72, v73
    v_cvt_pk_bf16_f32 v89, v74, v75
    v_cvt_pk_bf16_f32 v90, v76, v77
    v_cvt_pk_bf16_f32 v91, v78, v79
    s_add_u32 s23, s21, 65536
    buffer_store_dwordx4 v[88:91], v7, s[8:11], s23 offen offset:512 sc1
    s_waitcnt vmcnt(3)
    s_barrier
    s_cmp_lg_u32 s24, 4
    s_cbranch_scc1 Lgl_0_92
    s_lshl_b32 s3, s2, 3
    s_add_u32 s3, s3, 2
    s_lshl_b32 s3, s3, 8
    v_mov_b32 v20, 32768
    v_mov_b32 v21, 1
    s_mov_b64 exec, 1
    buffer_store_dword v21, v20, s[8:11], s3 offen offset:0 sc1
    s_mov_b64 exec, -1
Lgl_0_92:
    s_add_u32 m0, s28, 141312
    s_add_u32 s20, s44, 55296
    buffer_load_dwordx4 v16, s[8:11], s20 offen sc1 lds
    buffer_load_dwordx4 v16, s[8:11], s20 offen offset:1024 sc1 lds
    s_add_u32 m0, s32, 141312
    s_add_u32 s20, s52, 49152
    buffer_load_dwordx4 v3, s[8:11], s20 offen sc1 lds
    buffer_load_dwordx4 v3, s[8:11], s20 offen offset:1024 sc1 lds
    s_barrier
    s_mov_b32 s33, s44
    s_mov_b32 s34, 55296
    s_mov_b32 s35, 149504
    s_cmp_eq_u32 s25, 1
    s_cselect_b32 s33, s45, s33
    s_cselect_b32 s34, 0, s34
    s_cselect_b32 s35, 8192, s35
    s_cmp_eq_u32 s25, 2
    s_cselect_b32 s33, s45, s33
    s_cselect_b32 s34, 9216, s34
    s_cselect_b32 s35, 25600, s35
    s_cmp_eq_u32 s25, 3
    s_cselect_b32 s33, s45, s33
    s_cselect_b32 s34, 18432, s34
    s_cselect_b32 s35, 45056, s35
    s_mov_b32 m0, s35
    s_add_u32 s33, s33, s34
    buffer_load_dwordx4 v17, s[8:11], s33 offen sc1 lds
    s_waitcnt vmcnt(6)
    v_cmp_eq_u32 vcc, 0, v22
    s_nop 0
    s_cbranch_vccz Lgl_0_93
Lpo_0_94:
    buffer_load_dword v22, v25, s[8:11], 0 offen sc1
    s_sub_u32 s38, s38, 1
    s_cmp_lt_i32 s38, 0
    s_cbranch_scc1 Lpx_0_95
    s_waitcnt vmcnt(0)
    v_cmp_eq_u32 vcc, 0, v22
    s_nop 0
    s_cbranch_vccz Lpx_0_95
    s_sleep 1
    s_branch Lpo_0_94
Lpx_0_95:
    s_waitcnt vmcnt(0)
Lgl_0_93:
    s_add_u32 m0, s28, 0
    s_add_u32 s20, s45, 0
    buffer_load_dwordx4 v16, s[8:11], s20 offen sc1 lds
    buffer_load_dwordx4 v16, s[8:11], s20 offen offset:1024 sc1 lds
    s_add_u32 m0, s32, 0
    s_add_u32 s20, s53, 0
    buffer_load_dwordx4 v3, s[8:11], s20 offen sc1 lds
    buffer_load_dwordx4 v3, s[8:11], s20 offen offset:1024 sc1 lds
    s_barrier
    s_add_u32 m0, s28, 17408
    s_add_u32 s20, s45, 9216
    buffer_load_dwordx4 v16, s[8:11], s20 offen sc1 lds
    buffer_load_dwordx4 v16, s[8:11], s20 offen offset:1024 sc1 lds
    s_add_u32 m0, s32, 17408
    s_add_u32 s20, s53, 8192
    buffer_load_dwordx4 v3, s[8:11], s20 offen sc1 lds
    buffer_load_dwordx4 v3, s[8:11], s20 offen offset:1024 sc1 lds
    s_barrier
    s_add_u32 m0, s28, 36864
    s_add_u32 s20, s45, 18432
    buffer_load_dwordx4 v16, s[8:11], s20 offen sc1 lds
    buffer_load_dwordx4 v16, s[8:11], s20 offen offset:1024 sc1 lds
    s_add_u32 m0, s32, 36864
    s_add_u32 s20, s53, 16384
    buffer_load_dwordx4 v3, s[8:11], s20 offen sc1 lds
    buffer_load_dwordx4 v3, s[8:11], s20 offen offset:1024 sc1 lds
    s_waitcnt vmcnt(12)
    s_barrier
    s_mov_b32 s33, s45
    s_mov_b32 s34, 27648
    s_mov_b32 s35, 62464
    s_cmp_eq_u32 s25, 1
    s_cselect_b32 s33, s46, s33
    s_cselect_b32 s34, 0, s34
    s_cselect_b32 s35, 79872, s35
    s_cmp_eq_u32 s25, 2
    s_cselect_b32 s33, s46, s33
    s_cselect_b32 s34, 9216, s34
    s_cselect_b32 s35, 97280, s35
    s_cmp_eq_u32 s25, 3
    s_cselect_b32 s33, s46, s33
    s_cselect_b32 s34, 18432, s34
    s_cselect_b32 s35, 114688, s35
    s_mov_b32 m0, s35
    s_add_u32 s33, s33, s34
    buffer_load_dwordx4 v17, s[8:11], s33 offen sc1 lds
    s_add_u32 m0, s28, 54272
    s_add_u32 s20, s45, 27648
    buffer_load_dwordx4 v16, s[8:11], s20 offen sc1 lds
    buffer_load_dwordx4 v16, s[8:11], s20 offen offset:1024 sc1 lds
    s_add_u32 m0, s32, 54272
    s_add_u32 s20, s53, 24576
    buffer_load_dwordx4 v3, s[8:11], s20 offen sc1 lds
    buffer_load_dwordx4 v3, s[8:11], s20 offen offset:1024 sc1 lds
    s_waitcnt vmcnt(13)
    s_barrier
    s_cmp_lg_u32 s24, 5
    s_cbranch_scc1 Lgl_0_96
    s_lshl_b32 s3, s2, 3
    s_add_u32 s3, s3, 3
    s_lshl_b32 s3, s3, 8
    v_mov_b32 v20, 32768
    v_mov_b32 v21, 1
    s_mov_b64 exec, 1
    buffer_store_dword v21, v20, s[8:11], s3 offen offset:0 sc1
    s_mov_b64 exec, -1
Lgl_0_96:
    s_add_u32 m0, s28, 71680
    s_add_u32 s20, s46, 0
    buffer_load_dwordx4 v16, s[8:11], s20 offen sc1 lds
    buffer_load_dwordx4 v16, s[8:11], s20 offen offset:1024 sc1 lds
    s_add_u32 m0, s32, 71680
    s_add_u32 s20, s54, 0
    buffer_load_dwordx4 v3, s[8:11], s20 offen sc1 lds
    buffer_load_dwordx4 v3, s[8:11], s20 offen offset:1024 sc1 lds
    s_waitcnt vmcnt(13)
    s_barrier
    s_add_u32 m0, s28, 89088
    s_add_u32 s20, s46, 9216
    buffer_load_dwordx4 v16, s[8:11], s20 offen sc1 lds
    buffer_load_dwordx4 v16, s[8:11], s20 offen offset:1024 sc1 lds
    s_add_u32 m0, s32, 89088
    s_add_u32 s20, s54, 8192
    buffer_load_dwordx4 v3, s[8:11], s20 offen sc1 lds
    buffer_load_dwordx4 v3, s[8:11], s20 offen offset:1024 sc1 lds
    s_waitcnt vmcnt(13)
    s_barrier
    s_add_u32 m0, s28, 106496
    s_add_u32 s20, s46, 18432
    buffer_load_dwordx4 v16, s[8:11], s20 offen sc1 lds
    buffer_load_dwordx4 v16, s[8:11], s20 offen offset:1024 sc1 lds
    s_add_u32 m0, s32, 106496
    s_add_u32 s20, s54, 16384
    buffer_load_dwordx4 v3, s[8:11], s20 offen sc1 lds
    buffer_load_dwordx4 v3, s[8:11], s20 offen offset:1024 sc1 lds
    s_waitcnt vmcnt(12)
    s_barrier
    s_mov_b32 s33, s46
    s_mov_b32 s34, 27648
    s_mov_b32 s35, 132096
    s_cmp_eq_u32 s25, 1
    s_cselect_b32 s33, s47, s33
    s_cselect_b32 s34, 0, s34
    s_cselect_b32 s35, 149504, s35
    s_cmp_eq_u32 s25, 2
    s_cselect_b32 s33, s47, s33
    s_cselect_b32 s34, 9216, s34
    s_cselect_b32 s35, 8192, s35
    s_cmp_eq_u32 s25, 3
    s_cselect_b32 s33, s47, s33
    s_cselect_b32 s34, 18432, s34
    s_cselect_b32 s35, 25600, s35
    s_mov_b32 m0, s35
    s_add_u32 s33, s33, s34
    buffer_load_dwordx4 v17, s[8:11], s33 offen sc1 lds
    s_add_u32 m0, s28, 123904
    s_add_u32 s20, s46, 27648
    buffer_load_dwordx4 v16, s[8:11], s20 offen sc1 lds
    buffer_load_dwordx4 v16, s[8:11], s20 offen offset:1024 sc1 lds
    s_add_u32 m0, s32, 123904
    s_add_u32 s20, s54, 24576
    buffer_load_dwordx4 v3, s[8:11], s20 offen sc1 lds
    buffer_load_dwordx4 v3, s[8:11], s20 offen offset:1024 sc1 lds
    s_waitcnt vmcnt(13)
    s_barrier
    buffer_load_dword v22, v23, s[8:11], 0 offen sc1
    s_add_u32 m0, s28, 141312
    s_add_u32 s20, s47, 0
    buffer_load_dwordx4 v16, s[8:11], s20 offen sc1 lds
    buffer_load_dwordx4 v16, s[8:11], s20 offen offset:1024 sc1 lds
    s_add_u32 m0, s32, 141312
    s_add_u32 s20, s55, 0
    buffer_load_dwordx4 v3, s[8:11], s20 offen sc1 lds
    buffer_load_dwordx4 v3, s[8:11], s20 offen offset:1024 sc1 lds
    s_waitcnt vmcnt(14)
    s_barrier
    s_add_u32 m0, s28, 0
    s_add_u32 s20, s47, 9216
    buffer_load_dwordx4 v16, s[8:11], s20 offen sc1 lds
    buffer_load_dwordx4 v16, s[8:11], s20 offen offset:1024 sc1 lds
    s_add_u32 m0, s32, 0
    s_add_u32 s20, s55, 8192
    buffer_load_dwordx4 v3, s[8:11], s20 offen sc1 lds
    buffer_load_dwordx4 v3, s[8:11], s20 offen offset:1024 sc1 lds
    s_waitcnt vmcnt(14)
    s_barrier
    s_add_u32 m0, s28, 17408
    s_add_u32 s20, s47, 18432
    buffer_load_dwordx4 v16, s[8:11], s20 offen sc1 lds
    buffer_load_dwordx4 v16, s[8:11], s20 offen offset:1024 sc1 lds
    s_add_u32 m0, s32, 17408
    s_add_u32 s20, s55, 16384
    buffer_load_dwordx4 v3, s[8:11], s20 offen sc1 lds
    buffer_load_dwordx4 v3, s[8:11], s20 offen offset:1024 sc1 lds
    s_waitcnt vmcnt(13)
    s_barrier
    s_mov_b32 s33, s47
    s_mov_b32 s34, 27648
    s_mov_b32 s35, 45056
    s_cmp_eq_u32 s25, 1
    s_cselect_b32 s33, s45, s33
    s_cselect_b32 s34, 36864, s34
    s_cselect_b32 s35, 62464, s35
    s_cmp_eq_u32 s25, 2
    s_cselect_b32 s33, s45, s33
    s_cselect_b32 s34, 46080, s34
    s_cselect_b32 s35, 79872, s35
    s_cmp_eq_u32 s25, 3
    s_cselect_b32 s33, s45, s33
    s_cselect_b32 s34, 55296, s34
    s_cselect_b32 s35, 97280, s35
    s_mov_b32 m0, s35
    s_add_u32 s33, s33, s34
    buffer_load_dwordx4 v17, s[8:11], s33 offen sc1 lds
    s_add_u32 m0, s28, 36864
    s_add_u32 s20, s47, 27648
    buffer_load_dwordx4 v16, s[8:11], s20 offen sc1 lds
    buffer_load_dwordx4 v16, s[8:11], s20 offen offset:1024 sc1 lds
    s_add_u32 m0, s32, 36864
    s_add_u32 s20, s55, 24576
    buffer_load_dwordx4 v3, s[8:11], s20 offen sc1 lds
    buffer_load_dwordx4 v3, s[8:11], s20 offen offset:1024 sc1 lds
    s_waitcnt vmcnt(13)
    s_barrier
    v_cmp_eq_u32 vcc, 0, v22
    s_nop 0
    s_cbranch_vccz Lgl_0_97
Lpo_0_98:
    buffer_load_dword v22, v23, s[8:11], 0 offen sc1
    s_sub_u32 s38, s38, 1
    s_cmp_lt_i32 s38, 0
    s_cbranch_scc1 Lpx_0_99
    s_waitcnt vmcnt(0)
    v_cmp_eq_u32 vcc, 0, v22
    s_nop 0
    s_cbranch_vccz Lpx_0_99
    s_sleep 1
    s_branch Lpo_0_98
Lpx_0_99:
    s_waitcnt vmcnt(0)
Lgl_0_97:
    s_add_u32 m0, s28, 54272
    s_add_u32 s20, s45, 36864
    buffer_load_dwordx4 v16, s[8:11], s20 offen sc1 lds
    buffer_load_dwordx4 v16, s[8:11], s20 offen offset:1024 sc1 lds
    s_add_u32 m0, s32, 54272
    s_add_u32 s20, s53, 32768
    buffer_load_dwordx4 v3, s[8:11], s20 offen sc1 lds
    buffer_load_dwordx4 v3, s[8:11], s20 offen offset:1024 sc1 lds
    s_waitcnt vmcnt(13)
    s_barrier
    s_add_u32 m0, s28, 71680
    s_add_u32 s20, s45, 46080
    buffer_load_dwordx4 v16, s[8:11], s20 offen sc1 lds
    buffer_load_dwordx4 v16, s[8:11], s20 offen offset:1024 sc1 lds
    s_add_u32 m0, s32, 71680
    s_add_u32 s20, s53, 40960
    buffer_load_dwordx4 v3, s[8:11], s20 offen sc1 lds
    buffer_load_dwordx4 v3, s[8:11], s20 offen offset:1024 sc1 lds
    s_waitcnt vmcnt(13)
    s_barrier
    s_add_u32 m0, s28, 89088
    s_add_u32 s20, s45, 55296
    buffer_load_dwordx4 v16, s[8:11], s20 offen sc1 lds
    buffer_load_dwordx4 v16, s[8:11], s20 offen offset:1024 sc1 lds
    s_add_u32 m0, s32, 89088
    s_add_u32 s20, s53, 49152
    buffer_load_dwordx4 v3, s[8:11], s20 offen sc1 lds
    buffer_load_dwordx4 v3, s[8:11], s20 offen offset:1024 sc1 lds
    s_waitcnt vmcnt(12)
    s_barrier
    s_mov_b32 s33, s46
    s_mov_b32 s34, 36864
    s_mov_b32 s35, 114688
    s_cmp_eq_u32 s25, 1
    s_cselect_b32 s33, s46, s33
    s_cselect_b32 s34, 46080, s34
    s_cselect_b32 s35, 132096, s35
    s_cmp_eq_u32 s25, 2
    s_cselect_b32 s33, s46, s33
    s_cselect_b32 s34, 55296, s34
    s_cselect_b32 s35, 149504, s35
    s_cmp_eq_u32 s25, 3
    s_cselect_b32 s33, s47, s33
    s_cselect_b32 s34, 36864, s34
    s_cselect_b32 s35, 8192, s35
    s_mov_b32 m0, s35
    s_add_u32 s33, s33, s34
    buffer_load_dwordx4 v17, s[8:11], s33 offen sc1 lds
    s_add_u32 m0, s28, 106496
    s_add_u32 s20, s46, 36864
    buffer_load_dwordx4 v16, s[8:11], s20 offen sc1 lds
    buffer_load_dwordx4 v16, s[8:11], s20 offen offset:1024 sc1 lds
    s_add_u32 m0, s32, 106496
    s_add_u32 s20, s54, 32768
    buffer_load_dwordx4 v3, s[8:11], s20 offen sc1 lds
    buffer_load_dwordx4 v3, s[8:11], s20 offen offset:1024 sc1 lds
    s_waitcnt vmcnt(13)
    s_barrier
    s_add_u32 m0, s28, 123904
    s_add_u32 s20, s46, 46080
    buffer_load_dwordx4 v16, s[8:11], s20 offen sc1 lds
    buffer_load_dwordx4 v16, s[8:11], s20 offen offset:1024 sc1 lds
    s_add_u32 m0, s32, 123904
    s_add_u32 s20, s54, 40960
    buffer_load_dwordx4 v3, s[8:11], s20 offen sc1 lds
    buffer_load_dwordx4 v3, s[8:11], s20 offen offset:1024 sc1 lds
    s_waitcnt vmcnt(13)
    s_barrier
    s_add_u32 m0, s28, 141312
    s_add_u32 s20, s46, 55296
    buffer_load_dwordx4 v16, s[8:11], s20 offen sc1 lds
    buffer_load_dwordx4 v16, s[8:11], s20 offen offset:1024 sc1 lds
    s_add_u32 m0, s32, 141312
    s_add_u32 s20, s54, 49152
    buffer_load_dwordx4 v3, s[8:11], s20 offen sc1 lds
    buffer_load_dwordx4 v3, s[8:11], s20 offen offset:1024 sc1 lds
    s_waitcnt vmcnt(13)
    s_barrier
    s_add_u32 m0, s28, 0
    s_add_u32 s20, s47, 36864
    buffer_load_dwordx4 v16, s[8:11], s20 offen sc1 lds
    buffer_load_dwordx4 v16, s[8:11], s20 offen offset:1024 sc1 lds
    s_add_u32 m0, s32, 0
    s_add_u32 s20, s55, 32768
    buffer_load_dwordx4 v3, s[8:11], s20 offen sc1 lds
    buffer_load_dwordx4 v3, s[8:11], s20 offen offset:1024 sc1 lds
    s_waitcnt vmcnt(12)
    s_barrier
    s_waitcnt vmcnt(8)
    s_barrier
    s_mov_b32 s33, s47
    s_mov_b32 s34, 46080
    s_mov_b32 s35, 25600
    s_cmp_eq_u32 s25, 1
    s_cselect_b32 s33, s47, s33
    s_cselect_b32 s34, 55296, s34
    s_cselect_b32 s35, 45056, s35
    s_cmp_eq_u32 s25, 2
    s_cselect_b32 s33, s44, s33
    s_cselect_b32 s34, 64512, s34
    s_cselect_b32 s35, 62464, s35
    s_cmp_eq_u32 s25, 3
    s_cselect_b32 s33, s44, s33
    s_cselect_b32 s34, 73728, s34
    s_cselect_b32 s35, 79872, s35
    s_mov_b32 m0, s35
    s_add_u32 s33, s33, s34
    buffer_load_dwordx4 v17, s[8:11], s33 offen sc1 lds
    buffer_load_dword v22, v24, s[8:11], 0 offen sc1
    s_add_u32 m0, s28, 17408
    s_add_u32 s20, s47, 46080
    buffer_load_dwordx4 v16, s[8:11], s20 offen sc1 lds
    buffer_load_dwordx4 v16, s[8:11], s20 offen offset:1024 sc1 lds
    s_add_u32 m0, s32, 17408
    s_add_u32 s20, s55, 40960
    buffer_load_dwordx4 v3, s[8:11], s20 offen sc1 lds
    buffer_load_dwordx4 v3, s[8:11], s20 offen offset:1024 sc1 lds
    s_waitcnt vmcnt(10)
    s_barrier
    s_add_u32 m0, s28, 36864
    s_add_u32 s20, s47, 55296
    buffer_load_dwordx4 v16, s[8:11], s20 offen sc1 lds
    buffer_load_dwordx4 v16, s[8:11], s20 offen offset:1024 sc1 lds
    s_add_u32 m0, s32, 36864
    s_add_u32 s20, s55, 49152
    buffer_load_dwordx4 v3, s[8:11], s20 offen sc1 lds
    buffer_load_dwordx4 v3, s[8:11], s20 offen offset:1024 sc1 lds
    s_waitcnt vmcnt(10)
    s_barrier
    s_add_u32 m0, s28, 54272
    s_add_u32 s20, s44, 64512
    buffer_load_dwordx4 v16, s[8:11], s20 offen sc1 lds
    buffer_load_dwordx4 v16, s[8:11], s20 offen offset:1024 sc1 lds
    s_add_u32 m0, s32, 54272
    s_add_u32 s20, s52, 57344
    buffer_load_dwordx4 v3, s[8:11], s20 offen sc1 lds
    buffer_load_dwordx4 v3, s[8:11], s20 offen offset:1024 sc1 lds
    s_waitcnt vmcnt(8)
    s_barrier
    s_mov_b32 s33, s45
    s_mov_b32 s34, 64512
    s_mov_b32 s35, 97280
    s_cmp_eq_u32 s25, 1
    s_cselect_b32 s33, s45, s33
    s_cselect_b32 s34, 73728, s34
    s_cselect_b32 s35, 114688, s35
    s_cmp_eq_u32 s25, 2
    s_cselect_b32 s33, s46, s33
    s_cselect_b32 s34, 64512, s34
    s_cselect_b32 s35, 132096, s35
    s_cmp_eq_u32 s25, 3
    s_cselect_b32 s33, s46, s33
    s_cselect_b32 s34, 73728, s34
    s_cselect_b32 s35, 149504, s35
    s_mov_b32 m0, s35
    s_add_u32 s33, s33, s34
    buffer_load_dwordx4 v17, s[8:11], s33 offen sc1 lds
    s_add_u32 m0, s28, 71680
    s_add_u32 s20, s44, 73728
    buffer_load_dwordx4 v16, s[8:11], s20 offen sc1 lds
    buffer_load_dwordx4 v16, s[8:11], s20 offen offset:1024 sc1 lds
    s_add_u32 m0, s32, 71680
    s_add_u32 s20, s52, 65536
    buffer_load_dwordx4 v3, s[8:11], s20 offen sc1 lds
    buffer_load_dwordx4 v3, s[8:11], s20 offen offset:1024 sc1 lds
    s_waitcnt vmcnt(9)
    s_barrier
    v_cmp_eq_u32 vcc, 0, v22
    s_nop 0
    s_cbranch_vccz Lgl_0_100
Lpo_0_101:
    buffer_load_dword v22, v24, s[8:11], 0 offen sc1
    s_sub_u32 s38, s38, 1
    s_cmp_lt_i32 s38, 0
    s_cbranch_scc1 Lpx_0_102
    s_waitcnt vmcnt(0)
    v_cmp_eq_u32 vcc, 0, v22
    s_nop 0
    s_cbranch_vccz Lpx_0_102
    s_sleep 1
    s_branch Lpo_0_101
Lpx_0_102:
    s_waitcnt vmcnt(0)
Lgl_0_100:
    s_add_u32 m0, s28, 89088
    s_add_u32 s20, s45, 64512
    buffer_load_dwordx4 v16, s[8:11], s20 offen sc1 lds
    buffer_load_dwordx4 v16, s[8:11], s20 offen offset:1024 sc1 lds
    s_add_u32 m0, s32, 89088
    s_add_u32 s20, s53, 57344
    buffer_load_dwordx4 v3, s[8:11], s20 offen sc1 lds
    buffer_load_dwordx4 v3, s[8:11], s20 offen offset:1024 sc1 lds
    s_waitcnt vmcnt(9)
    s_barrier
    s_add_u32 m0, s28, 106496
    s_add_u32 s20, s45, 73728
    buffer_load_dwordx4 v16, s[8:11], s20 offen sc1 lds
    buffer_load_dwordx4 v16, s[8:11], s20 offen offset:1024 sc1 lds
    s_add_u32 m0, s32, 106496
    s_add_u32 s20, s53, 65536
    buffer_load_dwordx4 v3, s[8:11], s20 offen sc1 lds
    buffer_load_dwordx4 v3, s[8:11], s20 offen offset:1024 sc1 lds
    s_waitcnt vmcnt(8)
    s_barrier
    s_add_u32 m0, s28, 123904
    s_add_u32 s20, s46, 64512
    buffer_load_dwordx4 v16, s[8:11], s20 offen sc1 lds
    buffer_load_dwordx4 v16, s[8:11], s20 offen offset:1024 sc1 lds
    s_add_u32 m0, s32, 123904
    s_add_u32 s20, s54, 57344
    buffer_load_dwordx4 v3, s[8:11], s20 offen sc1 lds
    buffer_load_dwordx4 v3, s[8:11], s20 offen offset:1024 sc1 lds
    s_waitcnt vmcnt(8)
    s_barrier
    s_mov_b32 s33, s47
    s_mov_b32 s34, 64512
    s_mov_b32 s35, 8192
    s_cmp_eq_u32 s25, 1
    s_cselect_b32 s33, s47, s33
    s_cselect_b32 s34, 73728, s34
    s_cselect_b32 s35, 25600, s35
    s_cmp_eq_u32 s25, 2
    s_cselect_b32 s33, s47, s33
    s_cselect_b32 s34, 73728, s34
    s_cselect_b32 s35, 25600, s35
    s_cmp_eq_u32 s25, 3
    s_cselect_b32 s33, s47, s33
    s_cselect_b32 s34, 73728, s34
    s_cselect_b32 s35, 25600, s35
    s_mov_b32 m0, s35
    s_add_u32 s33, s33, s34
    buffer_load_dwordx4 v17, s[8:11], s33 offen sc1 lds
    s_add_u32 m0, s28, 141312
    s_add_u32 s20, s46, 73728
    buffer_load_dwordx4 v16, s[8:11], s20 offen sc1 lds
    buffer_load_dwordx4 v16, s[8:11], s20 offen offset:1024 sc1 lds
    s_add_u32 m0, s32, 141312
    s_add_u32 s20, s54, 65536
    buffer_load_dwordx4 v3, s[8:11], s20 offen sc1 lds
    buffer_load_dwordx4 v3, s[8:11], s20 offen offset:1024 sc1 lds
    s_waitcnt vmcnt(9)
    s_barrier
    s_add_u32 m0, s28, 0
    s_add_u32 s20, s47, 64512
    buffer_load_dwordx4 v16, s[8:11], s20 offen sc1 lds
    buffer_load_dwordx4 v16, s[8:11], s20 offen offset:1024 sc1 lds
    s_add_u32 m0, s32, 0
    s_add_u32 s20, s55, 57344
    buffer_load_dwordx4 v3, s[8:11], s20 offen sc1 lds
    buffer_load_dwordx4 v3, s[8:11], s20 offen offset:1024 sc1 lds
    s_waitcnt vmcnt(9)
    s_barrier
    s_add_u32 m0, s28, 17408
    s_add_u32 s20, s47, 73728
    buffer_load_dwordx4 v16, s[8:11], s20 offen sc1 lds
    buffer_load_dwordx4 v16, s[8:11], s20 offen offset:1024 sc1 lds
    s_add_u32 m0, s32, 17408
    s_add_u32 s20, s55, 65536
    buffer_load_dwordx4 v3, s[8:11], s20 offen sc1 lds
    buffer_load_dwordx4 v3, s[8:11], s20 offen offset:1024 sc1 lds
    s_waitcnt vmcnt(0)
    s_barrier
Lfin_0_5:
    s_endpgm
Lend_0_1:
    s_endpgm
Lcode_end:

.section .rodata,"a"
.p2align 6
.amdhsa_kernel sequential_preLN__ssm_conv_s4__mixer_s_mlp__prompt_kernel
  .amdhsa_next_free_vgpr 256
  .amdhsa_next_free_sgpr 72
  .amdhsa_accum_offset 256
  .amdhsa_group_segment_fixed_size 0
  .amdhsa_kernarg_size 136
  .amdhsa_user_sgpr_count 2
  .amdhsa_user_sgpr_kernarg_segment_ptr 1
  .amdhsa_system_sgpr_workgroup_id_x 1
.end_amdhsa_kernel
```
